```python
import torch

def _softmax(x, axis=-1):
    return torch.softmax(x, dim=axis)
def _gelu(x):
    return torch.nn.functional.gelu(x, approximate="tanh")
def _silu(x):
    return torch.nn.functional.silu(x)
def _sigmoid(x):
    return torch.sigmoid(x)
def _layernorm(x, axis=-1, eps=1e-5):
    m = x.mean(dim=axis, keepdim=True)
    v = x.var(dim=axis, keepdim=True, unbiased=False)
    return (x - m) / torch.sqrt(v + eps)
def _scatter_add(tgt, idx, src, axis=0):
    return tgt.clone().index_add_(axis, idx, src)
def _segment_sum(src, seg, n):
    out = torch.zeros((n,) + src.shape[1:], dtype=src.dtype)
    return out.index_add_(0, seg, src)
def _pad(x, pw):
    flat = tuple(v for pair in reversed(pw) for v in pair)
    return torch.nn.functional.pad(x, flat)

kernel_name = 'concat_heads__gqa_block_cached__mha_block_cached__near_ridge'

def setup_inputs():

    _w = (lambda a: (lambda t: t.to(torch.bfloat16) if t.is_floating_point() else t)(torch.as_tensor(a)))
    def _A_setup():
        B, Sq, D = 8, 80, 512
        Hq, Hkv, Sk, Dh = 32, 8, 2048, 128
        assert Hq % Hkv == 0, (Hq, Hkv)
        return {
            "x": _w((lambda *s: torch.randn(*s, dtype=torch.bfloat16) * 0.8)(B, Sq, D)),
            "k_cache": _w((lambda *s: torch.randn(*s, dtype=torch.bfloat16) * 0.8)(B, Hkv, Sk, Dh)),
            "v_cache": _w((lambda *s: torch.randn(*s, dtype=torch.bfloat16) * 0.05)(B, Hkv, Sk, Dh)),
            "wq": _w((lambda *s: torch.randn(*s, dtype=torch.bfloat16) * 0.8)(D, Hq * Dh) * (D ** -0.5)),
            "wo": _w((lambda *s: torch.randn(*s, dtype=torch.bfloat16) * 0.05)(Hq * Dh, D) * ((Hq * Dh) ** -0.5)),
        }
    _A_in = _A_setup()

    def _B_setup():
        B, Sq, D = 8, 80, 512
        H, Sk, Dh = 32, 2048, 128
        return {
            "x": _w((lambda *s: torch.randn(*s, dtype=torch.bfloat16) * 0.8)(B, Sq, D)),
            "k_cache": _w((lambda *s: torch.randn(*s, dtype=torch.bfloat16) * 0.8)(B, H, Sk, Dh)),
            "v_cache": _w((lambda *s: torch.randn(*s, dtype=torch.bfloat16) * 0.05)(B, H, Sk, Dh)),
            "wq": _w((lambda *s: torch.randn(*s, dtype=torch.bfloat16) * 0.8)(D, H * Dh) * (D ** -0.5)),
            "wo": _w((lambda *s: torch.randn(*s, dtype=torch.bfloat16) * 0.05)(H * Dh, D) * ((H * Dh) ** -0.5)),
        }
    _B_in = _B_setup()

    return {
        "A_x": _A_in["x"],
        "A_k_cache": _A_in["k_cache"],
        "A_v_cache": _A_in["v_cache"],
        "A_wq": _A_in["wq"],
        "A_wo": _A_in["wo"],
        "B_x": _B_in["x"],
        "B_k_cache": _B_in["k_cache"],
        "B_v_cache": _B_in["v_cache"],
        "B_wq": _B_in["wq"],
        "B_wo": _B_in["wo"],
    }

def reference(A_x, A_k_cache, A_v_cache, A_wq, A_wo, B_x, B_k_cache, B_v_cache, B_wq, B_wo):
    def _A_ref(x, k_cache, v_cache, wq, wo):
        B, Sq, D = x.shape
        Hq, Dh = 32, 128
        Hkv = k_cache.shape[1]
        rep = Hq // Hkv
        q = (lambda x, *d: x.permute(*d))((x @ wq).reshape(B, Sq, Hq, Dh), 0, 2, 1, 3)
        k = (lambda x, n, axis: torch.repeat_interleave(x, n, dim=axis))(k_cache, rep, axis=1)
        v = (lambda x, n, axis: torch.repeat_interleave(x, n, dim=axis))(v_cache, rep, axis=1)
        scores = torch.einsum("bhqd,bhkd->bhqk", q, k) * (Dh ** -0.5)
        p = _softmax(scores, axis=-1)
        o = torch.einsum("bhqk,bhkd->bhqd", p, v)
        return (lambda x, *d: x.permute(*d))(o, 0, 2, 1, 3).reshape(B, Sq, Hq * Dh) @ wo

    def _B_ref(x, k_cache, v_cache, wq, wo):
        B, Sq, D = x.shape
        H, Dh = 32, 128
        q = (lambda x, *d: x.permute(*d))((x @ wq).reshape(B, Sq, H, Dh), 0, 2, 1, 3)
        scores = torch.einsum("bhqd,bhkd->bhqk", q, k_cache) * (Dh ** -0.5)
        p = _softmax(scores, axis=-1)
        o = torch.einsum("bhqk,bhkd->bhqd", p, v_cache)
        return (lambda x, *d: x.permute(*d))(o, 0, 2, 1, 3).reshape(B, Sq, H * Dh) @ wo

    a = _A_ref(A_x, A_k_cache, A_v_cache, A_wq, A_wo)
    b = _B_ref(B_x, B_k_cache, B_v_cache, B_wq, B_wo)
    return torch.concatenate([a, b], axis=-1)
```

```asm
; @launch grid=(256,1,1) block=(256,1,1) lds=163840
.amdgcn_target "amdgcn-amd-amdhsa--gfx950"
.text
.globl concat_heads__gqa_block_cached__mha_block_cached__near_ridge_kernel
.p2align 8
.type concat_heads__gqa_block_cached__mha_block_cached__near_ridge_kernel,@function
concat_heads__gqa_block_cached__mha_block_cached__near_ridge_kernel:
  s_cmp_ge_u32 s2, 256
  s_cbranch_scc1 L1_end
  s_load_dwordx16 s[8:23], s[0:1], 0
  s_load_dwordx8 s[24:31], s[0:1], 64
  s_load_dwordx2 s[32:33], s[0:1], 96
  s_mov_b32 s100, s2
  v_lshrrev_b32 v1, 6, v0
  v_and_b32 v0, 63, v0
  s_nop 0
  v_readfirstlane_b32 s34, v1
  s_and_b32 s37, s2, 7
  s_lshr_b32 s65, s2, 3
  s_lshr_b32 s35, s65, 2
  s_and_b32 s38, s65, 3
  s_lshl_b32 s36, s37, 2
  s_add_u32 s36, s36, s38
  s_getpc_b64 s[92:93]
L_pc:
  s_sub_u32 s92, s92, L_pc-concat_heads__gqa_block_cached__mha_block_cached__near_ridge_kernel
  s_subb_u32 s93, s93, 0
  s_lshr_b32 s66, s2, 3
  s_mul_i32 s66, s66, 12
  v_add_u32 v95, s66, v0
  v_lshlrev_b32 v95, 7, v95
  s_mov_b32 s66, L_textend-concat_heads__gqa_block_cached__mha_block_cached__near_ridge_kernel
  v_cmp_gt_u32 vcc, s66, v95
  v_cmp_gt_u32 s[90:91], 12, v0
  s_nop 1
  s_and_b64 vcc, vcc, s[90:91]
  v_mov_b32 v93, s93
  v_add_co_u32 v92, s[88:89], s92, v95
  s_nop 1
  v_addc_co_u32 v93, s[88:89], 0, v93, s[88:89]
  s_cmp_eq_u32 s34, 3
  s_cbranch_scc0 L_nowarm
  s_and_saveexec_b64 s[90:91], vcc
  s_cbranch_execz L_nowarm1
  global_load_dword v95, v[92:93], off
L_nowarm1:
  s_mov_b64 exec, s[90:91]
L_nowarm:
  s_mul_i32 s64, s34, 40960
  s_lshl_b32 s72, s34, 13
  s_add_u32 s65, s35, s38
  s_add_u32 s41, s65, 0
  s_and_b32 s41, s41, 3
  s_add_u32 s42, s65, 1
  s_and_b32 s42, s42, 3
  s_add_u32 s43, s65, 2
  s_and_b32 s43, s43, 3
  s_add_u32 s3, s65, 3
  s_and_b32 s3, s3, 3
  v_lshrrev_b32 v2, 4, v0
  v_and_b32 v3, 15, v0
  v_lshrrev_b32 v4, 2, v3
  v_and_b32 v5, 3, v0
  v_lshlrev_b32 v35, 4, v0
  v_lshlrev_b32 v6, 10, v3
  v_lshl_add_u32 v6, v2, 4, v6
  s_lshl_b32 s65, s34, 8
  v_add_u32 v34, s65, v6
  v_add_u32 v6, 0, v2
  v_lshlrev_b32 v6, 1, v6
  v_xor_b32 v6, v6, v3
  v_lshlrev_b32 v6, 4, v6
  v_lshl_add_u32 v28, v2, 13, v6
  v_add_u32 v6, 4, v2
  v_lshlrev_b32 v6, 1, v6
  v_xor_b32 v6, v6, v3
  v_lshlrev_b32 v6, 4, v6
  v_lshl_add_u32 v29, v2, 13, v6
  s_cmp_lt_u32 s35, 4
  s_cselect_b32 s40, 1, 0
  s_xor_b32 s39, s40, 1
  s_waitcnt lgkmcnt(0)
  s_lshl_b32 s65, s100, 7
  s_add_u32 s65, s65, 33554432
  s_add_u32 s60, s32, s65
  s_addc_u32 s61, s33, 0
  s_and_b32 s61, s61, 0xffff
  s_mov_b32 s62, 128
  s_mov_b32 s63, 0x20000
  v_mov_b32 v6, 0
  v_lshlrev_b32 v7, 2, v0
  s_cmp_eq_u32 s34, 0
  s_cbranch_scc0 L_nozero
  buffer_store_dword v6, v7, s[60:63], 0 offen sc1
L_nozero:
  s_cmp_eq_u32 s40, 0
  s_cselect_b32 s44, s8, s18
  s_cselect_b32 s45, s9, s19
  s_cselect_b32 s48, s14, s24
  s_cselect_b32 s49, s15, s25
  s_mul_i32 s65, s35, 81920
  s_add_u32 s44, s44, s65
  s_addc_u32 s45, s45, 0
  s_and_b32 s45, s45, 0xffff
  s_mov_b32 s46, 81920
  s_mov_b32 s47, 0x20000
  s_lshl_b32 s65, s36, 8
  s_add_u32 s48, s48, s65
  s_addc_u32 s49, s49, 0
  s_and_b32 s49, s49, 0xffff
  s_mov_b32 s50, 4186368
  s_mov_b32 s51, 0x20000
  v_add_u32 v6, 0, v2
  v_xor_b32 v6, v6, v3
  v_lshlrev_b32 v6, 4, v6
  v_lshl_add_u32 v22, v2, 8, v6
  v_add_u32 v6, 4, v2
  v_xor_b32 v6, v6, v3
  v_lshlrev_b32 v6, 4, v6
  v_lshl_add_u32 v23, v2, 8, v6
  v_add_u32 v6, 8, v2
  v_xor_b32 v6, v6, v3
  v_lshlrev_b32 v6, 4, v6
  v_lshl_add_u32 v24, v2, 8, v6
  v_add_u32 v6, 12, v2
  v_xor_b32 v6, v6, v3
  v_lshlrev_b32 v6, 4, v6
  v_lshl_add_u32 v25, v2, 8, v6
  v_lshrrev_b32 v44, 4, v0
  v_mul_u32_u24 v44, 0x300, v44
  s_lshl_b32 s67, s34, 8
  v_add_u32 v44, s67, v44
  v_add_u32 v40, v22, v44
  v_add_u32 v41, v23, v44
  v_add_u32 v42, v24, v44
  v_add_u32 v43, v25, v44
  s_add_u32 s67, s38, 0
  s_cmp_ge_u32 s67, 5
  s_cselect_b32 s68, 5, 0
  s_sub_u32 s67, s67, s68
  s_lshl_b32 s98, s67, 12
  s_add_u32 s98, s98, s64
  s_lshl_b32 s67, s67, 14
  s_add_u32 m0, s98, 16384
  s_add_u32 s68, s67, 0
  buffer_load_dwordx4 v40, s[44:47], s68 offen lds
  s_add_u32 m0, s98, 17408
  s_add_u32 s68, s67, 4096
  buffer_load_dwordx4 v41, s[44:47], s68 offen lds
  s_add_u32 m0, s98, 18432
  s_add_u32 s68, s67, 8192
  buffer_load_dwordx4 v42, s[44:47], s68 offen lds
  s_add_u32 m0, s98, 19456
  s_add_u32 s68, s67, 12288
  buffer_load_dwordx4 v43, s[44:47], s68 offen lds
  s_add_u32 s67, s38, 1
  s_cmp_ge_u32 s67, 5
  s_cselect_b32 s68, 5, 0
  s_sub_u32 s67, s67, s68
  s_lshl_b32 s98, s67, 12
  s_add_u32 s98, s98, s64
  s_lshl_b32 s67, s67, 14
  s_add_u32 m0, s98, 16384
  s_add_u32 s68, s67, 0
  buffer_load_dwordx4 v40, s[44:47], s68 offen lds
  s_add_u32 m0, s98, 17408
  s_add_u32 s68, s67, 4096
  buffer_load_dwordx4 v41, s[44:47], s68 offen lds
  s_add_u32 m0, s98, 18432
  s_add_u32 s68, s67, 8192
  buffer_load_dwordx4 v42, s[44:47], s68 offen lds
  s_add_u32 m0, s98, 19456
  s_add_u32 s68, s67, 12288
  buffer_load_dwordx4 v43, s[44:47], s68 offen lds
  s_add_u32 s67, s38, 2
  s_cmp_ge_u32 s67, 5
  s_cselect_b32 s68, 5, 0
  s_sub_u32 s67, s67, s68
  s_lshl_b32 s98, s67, 12
  s_add_u32 s98, s98, s64
  s_lshl_b32 s67, s67, 14
  s_add_u32 m0, s98, 16384
  s_add_u32 s68, s67, 0
  buffer_load_dwordx4 v40, s[44:47], s68 offen lds
  s_add_u32 m0, s98, 17408
  s_add_u32 s68, s67, 4096
  buffer_load_dwordx4 v41, s[44:47], s68 offen lds
  s_add_u32 m0, s98, 18432
  s_add_u32 s68, s67, 8192
  buffer_load_dwordx4 v42, s[44:47], s68 offen lds
  s_add_u32 m0, s98, 19456
  s_add_u32 s68, s67, 12288
  buffer_load_dwordx4 v43, s[44:47], s68 offen lds
  s_add_u32 s67, s38, 3
  s_cmp_ge_u32 s67, 5
  s_cselect_b32 s68, 5, 0
  s_sub_u32 s67, s67, s68
  s_lshl_b32 s98, s67, 12
  s_add_u32 s98, s98, s64
  s_lshl_b32 s67, s67, 14
  s_add_u32 m0, s98, 16384
  s_add_u32 s68, s67, 0
  buffer_load_dwordx4 v40, s[44:47], s68 offen lds
  s_add_u32 m0, s98, 17408
  s_add_u32 s68, s67, 4096
  buffer_load_dwordx4 v41, s[44:47], s68 offen lds
  s_add_u32 m0, s98, 18432
  s_add_u32 s68, s67, 8192
  buffer_load_dwordx4 v42, s[44:47], s68 offen lds
  s_add_u32 m0, s98, 19456
  s_add_u32 s68, s67, 12288
  buffer_load_dwordx4 v43, s[44:47], s68 offen lds
  s_add_u32 s67, s38, 4
  s_cmp_ge_u32 s67, 5
  s_cselect_b32 s68, 5, 0
  s_sub_u32 s67, s67, s68
  s_lshl_b32 s98, s67, 12
  s_add_u32 s98, s98, s64
  s_lshl_b32 s67, s67, 14
  s_add_u32 m0, s98, 16384
  s_add_u32 s68, s67, 0
  buffer_load_dwordx4 v40, s[44:47], s68 offen lds
  s_add_u32 m0, s98, 17408
  s_add_u32 s68, s67, 4096
  buffer_load_dwordx4 v41, s[44:47], s68 offen lds
  s_add_u32 m0, s98, 18432
  s_add_u32 s68, s67, 8192
  buffer_load_dwordx4 v42, s[44:47], s68 offen lds
  s_add_u32 m0, s98, 19456
  s_add_u32 s68, s67, 12288
  buffer_load_dwordx4 v43, s[44:47], s68 offen lds
  s_lshl_b32 s98, s34, 20
  s_lshl_b32 s68, s41, 18
  s_add_u32 s98, s98, s68
  s_add_u32 m0, s64, 0
  s_add_u32 s68, s98, 0
  buffer_load_dwordx4 v28, s[48:51], s68 offen lds
  s_add_u32 m0, s64, 1024
  s_add_u32 s68, s98, 32768
  buffer_load_dwordx4 v28, s[48:51], s68 offen lds
  s_add_u32 m0, s64, 2048
  s_add_u32 s68, s98, 65536
  buffer_load_dwordx4 v29, s[48:51], s68 offen lds
  s_add_u32 m0, s64, 3072
  s_add_u32 s68, s98, 98304
  buffer_load_dwordx4 v29, s[48:51], s68 offen lds
  s_add_u32 m0, s64, 4096
  s_add_u32 s68, s98, 131072
  buffer_load_dwordx4 v28, s[48:51], s68 offen lds
  s_add_u32 m0, s64, 5120
  s_add_u32 s68, s98, 163840
  buffer_load_dwordx4 v28, s[48:51], s68 offen lds
  s_add_u32 m0, s64, 6144
  s_add_u32 s68, s98, 196608
  buffer_load_dwordx4 v29, s[48:51], s68 offen lds
  s_add_u32 m0, s64, 7168
  s_add_u32 s68, s98, 229376
  buffer_load_dwordx4 v29, s[48:51], s68 offen lds
  s_lshl_b32 s98, s34, 20
  s_lshl_b32 s68, s42, 18
  s_add_u32 s98, s98, s68
  s_add_u32 m0, s64, 8192
  s_add_u32 s68, s98, 0
  buffer_load_dwordx4 v28, s[48:51], s68 offen lds
  s_add_u32 m0, s64, 9216
  s_add_u32 s68, s98, 32768
  buffer_load_dwordx4 v28, s[48:51], s68 offen lds
  s_add_u32 m0, s64, 10240
  s_add_u32 s68, s98, 65536
  buffer_load_dwordx4 v29, s[48:51], s68 offen lds
  s_add_u32 m0, s64, 11264
  s_add_u32 s68, s98, 98304
  buffer_load_dwordx4 v29, s[48:51], s68 offen lds
  s_add_u32 m0, s64, 12288
  s_add_u32 s68, s98, 131072
  buffer_load_dwordx4 v28, s[48:51], s68 offen lds
  s_add_u32 m0, s64, 13312
  s_add_u32 s68, s98, 163840
  buffer_load_dwordx4 v28, s[48:51], s68 offen lds
  s_add_u32 m0, s64, 14336
  s_add_u32 s68, s98, 196608
  buffer_load_dwordx4 v29, s[48:51], s68 offen lds
  s_add_u32 m0, s64, 15360
  s_add_u32 s68, s98, 229376
  buffer_load_dwordx4 v29, s[48:51], s68 offen lds
  s_cmp_eq_u32 s40, 0
  s_cselect_b32 s52, s10, s20
  s_cselect_b32 s53, s11, s21
  s_cselect_b32 s56, s12, s22
  s_cselect_b32 s57, s13, s23
  s_lshl_b32 s65, s35, 3
  s_add_u32 s65, s65, s37
  s_lshl_b32 s66, s35, 5
  s_add_u32 s66, s66, s36
  s_cmp_eq_u32 s40, 0
  s_cselect_b32 s65, s65, s66
  s_lshr_b32 s66, s65, 13
  s_lshl_b32 s65, s65, 19
  s_add_u32 s52, s52, s65
  s_addc_u32 s53, s53, s66
  s_and_b32 s53, s53, 0xffff
  s_mov_b32 s54, 524288
  s_mov_b32 s55, 0x20000
  s_add_u32 s56, s56, s65
  s_addc_u32 s57, s57, s66
  s_and_b32 s57, s57, 0xffff
  s_mov_b32 s58, 524288
  s_mov_b32 s59, 0x20000
  s_mov_b32 s69, s72
  s_mov_b32 s70, s72
  s_add_u32 s4, s30, 0
  s_addc_u32 s5, s31, 0
  s_and_b32 s5, s5, 0xffff
  s_mov_b32 s6, 256
  s_mov_b32 s7, 0x20000
  v_xor_b32 v6, v2, v3
  v_lshlrev_b32 v6, 4, v6
  v_lshl_add_u32 v6, v3, 8, v6
  v_add_u32 v6, s64, v6
  v_xor_b32 v10, 0, v6
  v_xor_b32 v11, 64, v6
  v_xor_b32 v12, 128, v6
  v_xor_b32 v13, 192, v6
  v_lshl_add_u32 v6, v2, 2, v4
  v_and_b32 v7, 7, v6
  v_lshlrev_b32 v7, 5, v7
  v_lshl_add_u32 v7, v5, 3, v7
  v_lshl_add_u32 v7, v6, 8, v7
  s_lshl_b32 s65, s34, 1
  s_add_u32 s65, s65, 0
  s_and_b32 s65, s65, 7
  s_lshl_b32 s65, s65, 5
  v_xor_b32 v14, s65, v7
  v_add_u32 v14, s64, v14
  s_lshl_b32 s65, s34, 1
  s_add_u32 s65, s65, 1
  s_and_b32 s65, s65, 7
  s_lshl_b32 s65, s65, 5
  v_xor_b32 v15, s65, v7
  v_add_u32 v15, s64, v15
  s_lshl_b32 s65, s34, 1
  s_add_u32 s65, s65, 2
  s_and_b32 s65, s65, 7
  s_lshl_b32 s65, s65, 5
  v_xor_b32 v16, s65, v7
  v_add_u32 v16, s64, v16
  s_lshl_b32 s65, s34, 1
  s_add_u32 s65, s65, 3
  s_and_b32 s65, s65, 7
  s_lshl_b32 s65, s65, 5
  v_xor_b32 v17, s65, v7
  v_add_u32 v17, s64, v17
  s_lshl_b32 s65, s34, 1
  s_add_u32 s65, s65, 4
  s_and_b32 s65, s65, 7
  s_lshl_b32 s65, s65, 5
  v_xor_b32 v18, s65, v7
  v_add_u32 v18, s64, v18
  s_lshl_b32 s65, s34, 1
  s_add_u32 s65, s65, 5
  s_and_b32 s65, s65, 7
  s_lshl_b32 s65, s65, 5
  v_xor_b32 v19, s65, v7
  v_add_u32 v19, s64, v19
  s_lshl_b32 s65, s34, 1
  s_add_u32 s65, s65, 6
  s_and_b32 s65, s65, 7
  s_lshl_b32 s65, s65, 5
  v_xor_b32 v20, s65, v7
  v_add_u32 v20, s64, v20
  s_lshl_b32 s65, s34, 1
  s_add_u32 s65, s65, 7
  s_and_b32 s65, s65, 7
  s_lshl_b32 s65, s65, 5
  v_xor_b32 v21, s65, v7
  v_add_u32 v21, s64, v21
  v_add_u32 v6, 0, v2
  v_lshlrev_b32 v6, 1, v6
  v_xor_b32 v6, v6, v3
  v_lshlrev_b32 v6, 4, v6
  v_lshl_add_u32 v26, v2, 8, v6
  v_lshl_add_u32 v36, v2, 10, v6
  v_add_u32 v6, 4, v2
  v_lshlrev_b32 v6, 1, v6
  v_xor_b32 v6, v6, v3
  v_lshlrev_b32 v6, 4, v6
  v_lshl_add_u32 v27, v2, 8, v6
  v_lshl_add_u32 v37, v2, 10, v6
  v_and_b32 v6, 1, v2
  v_lshl_add_u32 v6, v6, 2, v4
  v_lshlrev_b32 v6, 1, v6
  v_xor_b32 v6, v6, v5
  v_lshlrev_b32 v6, 4, v6
  v_lshl_add_u32 v7, v2, 3, v4
  v_lshl_add_u32 v6, v7, 8, v6
  s_add_u32 s65, s34, 0
  s_and_b32 s65, s65, 3
  s_lshl_b32 s65, s65, 6
  v_xor_b32 v30, s65, v6
  v_add_u32 v30, s64, v30
  s_add_u32 s65, s34, 1
  s_and_b32 s65, s65, 3
  s_lshl_b32 s65, s65, 6
  v_xor_b32 v31, s65, v6
  v_add_u32 v31, s64, v31
  s_add_u32 s65, s34, 2
  s_and_b32 s65, s65, 3
  s_lshl_b32 s65, s65, 6
  v_xor_b32 v32, s65, v6
  v_add_u32 v32, s64, v32
  s_add_u32 s65, s34, 3
  s_and_b32 s65, s65, 3
  s_lshl_b32 s65, s65, 6
  v_xor_b32 v33, s65, v6
  v_add_u32 v33, s64, v33
  v_mov_b32 v6, 0x3f803f80
  v_accvgpr_write_b32 a244, v6
  v_accvgpr_write_b32 a245, v6
  v_accvgpr_write_b32 a246, v6
  v_accvgpr_write_b32 a247, v6
  v_lshlrev_b32 v6, 2, v2
  v_sub_u32 v6, v3, v6
  v_mov_b32 v7, 0x3f80
  v_mov_b32 v8, 0x3f800000
  v_cmp_eq_u32 vcc, 0, v6
  s_nop 1
  v_cndmask_b32 v9, 0, v7, vcc
  v_cmp_eq_u32 vcc, 1, v6
  s_nop 1
  v_cndmask_b32 v9, v9, v8, vcc
  v_accvgpr_write_b32 a248, v9
  v_cmp_eq_u32 vcc, 2, v6
  s_nop 1
  v_cndmask_b32 v9, 0, v7, vcc
  v_cmp_eq_u32 vcc, 3, v6
  s_nop 1
  v_cndmask_b32 v9, v9, v8, vcc
  v_accvgpr_write_b32 a249, v9
  s_waitcnt vmcnt(16)
  s_lshl_b32 s67, s41, 6
  v_xor_b32 v40, s67, v10
  s_lshl_b32 s67, s42, 6
  v_xor_b32 v41, s67, v10
  s_lshl_b32 s67, s43, 6
  v_xor_b32 v42, s67, v10
  s_lshl_b32 s67, s3, 6
  v_xor_b32 v43, s67, v10
  ds_read_b128 a[80:83], v40 offset:16384
  ds_read_b128 a[84:87], v41 offset:16384
  ds_read_b128 a[88:91], v42 offset:16384
  ds_read_b128 a[92:95], v43 offset:16384
  ds_read_b128 a[96:99], v40 offset:20480
  ds_read_b128 a[100:103], v41 offset:20480
  ds_read_b128 a[104:107], v42 offset:20480
  ds_read_b128 a[108:111], v43 offset:20480
  ds_read_b128 a[112:115], v40 offset:24576
  ds_read_b128 a[116:119], v41 offset:24576
  ds_read_b128 a[120:123], v42 offset:24576
  ds_read_b128 a[124:127], v43 offset:24576
  ds_read_b128 a[128:131], v40 offset:28672
  ds_read_b128 a[132:135], v41 offset:28672
  ds_read_b128 a[136:139], v42 offset:28672
  ds_read_b128 a[140:143], v43 offset:28672
  ds_read_b128 a[144:147], v40 offset:32768
  ds_read_b128 a[148:151], v41 offset:32768
  ds_read_b128 a[152:155], v42 offset:32768
  ds_read_b128 a[156:159], v43 offset:32768
  s_waitcnt lgkmcnt(0)
  s_lshl_b32 s98, s34, 20
  s_lshl_b32 s68, s43, 18
  s_add_u32 s98, s98, s68
  s_add_u32 m0, s64, 16384
  s_add_u32 s68, s98, 0
  buffer_load_dwordx4 v28, s[48:51], s68 offen lds
  s_add_u32 m0, s64, 17408
  s_add_u32 s68, s98, 32768
  buffer_load_dwordx4 v28, s[48:51], s68 offen lds
  s_add_u32 m0, s64, 18432
  s_add_u32 s68, s98, 65536
  buffer_load_dwordx4 v29, s[48:51], s68 offen lds
  s_add_u32 m0, s64, 19456
  s_add_u32 s68, s98, 98304
  buffer_load_dwordx4 v29, s[48:51], s68 offen lds
  s_add_u32 m0, s64, 20480
  s_add_u32 s68, s98, 131072
  buffer_load_dwordx4 v28, s[48:51], s68 offen lds
  s_add_u32 m0, s64, 21504
  s_add_u32 s68, s98, 163840
  buffer_load_dwordx4 v28, s[48:51], s68 offen lds
  s_add_u32 m0, s64, 22528
  s_add_u32 s68, s98, 196608
  buffer_load_dwordx4 v29, s[48:51], s68 offen lds
  s_add_u32 m0, s64, 23552
  s_add_u32 s68, s98, 229376
  buffer_load_dwordx4 v29, s[48:51], s68 offen lds
  s_lshl_b32 s98, s34, 20
  s_lshl_b32 s68, s3, 18
  s_add_u32 s98, s98, s68
  s_add_u32 m0, s64, 24576
  s_add_u32 s68, s98, 0
  buffer_load_dwordx4 v28, s[48:51], s68 offen lds
  s_add_u32 m0, s64, 25600
  s_add_u32 s68, s98, 32768
  buffer_load_dwordx4 v28, s[48:51], s68 offen lds
  s_add_u32 m0, s64, 26624
  s_add_u32 s68, s98, 65536
  buffer_load_dwordx4 v29, s[48:51], s68 offen lds
  s_add_u32 m0, s64, 27648
  s_add_u32 s68, s98, 98304
  buffer_load_dwordx4 v29, s[48:51], s68 offen lds
  s_add_u32 m0, s64, 28672
  s_add_u32 s68, s98, 131072
  buffer_load_dwordx4 v28, s[48:51], s68 offen lds
  s_add_u32 m0, s64, 29696
  s_add_u32 s68, s98, 163840
  buffer_load_dwordx4 v28, s[48:51], s68 offen lds
  s_add_u32 m0, s64, 30720
  s_add_u32 s68, s98, 196608
  buffer_load_dwordx4 v29, s[48:51], s68 offen lds
  s_add_u32 m0, s64, 31744
  s_add_u32 s68, s98, 229376
  buffer_load_dwordx4 v29, s[48:51], s68 offen lds
  s_waitcnt vmcnt(24)
  ds_read_b64_tr_b16 a[192:193], v30 offset:0
  ds_read_b64_tr_b16 a[194:195], v30 offset:1024
  ds_read_b64_tr_b16 a[196:197], v30 offset:8
  ds_read_b64_tr_b16 a[198:199], v30 offset:1032
  ds_read_b64_tr_b16 a[200:201], v31 offset:0
  ds_read_b64_tr_b16 a[202:203], v31 offset:1024
  ds_read_b64_tr_b16 a[204:205], v31 offset:8
  ds_read_b64_tr_b16 a[206:207], v31 offset:1032
  ds_read_b64_tr_b16 a[208:209], v32 offset:0
  ds_read_b64_tr_b16 a[210:211], v32 offset:1024
  ds_read_b64_tr_b16 a[212:213], v32 offset:8
  ds_read_b64_tr_b16 a[214:215], v32 offset:1032
  ds_read_b64_tr_b16 a[216:217], v33 offset:0
  ds_read_b64_tr_b16 a[218:219], v33 offset:1024
  ds_read_b64_tr_b16 a[220:221], v33 offset:8
  ds_read_b64_tr_b16 a[222:223], v33 offset:1032
  s_waitcnt lgkmcnt(0)
  v_mfma_f32_16x16x32_bf16 v[96:99], a[192:195], a[80:83], 0
  v_mfma_f32_16x16x32_bf16 v[100:103], a[192:195], a[96:99], 0
  v_mfma_f32_16x16x32_bf16 v[104:107], a[192:195], a[112:115], 0
  v_mfma_f32_16x16x32_bf16 v[108:111], a[192:195], a[128:131], 0
  v_mfma_f32_16x16x32_bf16 v[112:115], a[192:195], a[144:147], 0
  v_mfma_f32_16x16x32_bf16 v[116:119], a[196:199], a[80:83], 0
  v_mfma_f32_16x16x32_bf16 v[120:123], a[196:199], a[96:99], 0
  v_mfma_f32_16x16x32_bf16 v[124:127], a[196:199], a[112:115], 0
  v_mfma_f32_16x16x32_bf16 v[128:131], a[196:199], a[128:131], 0
  v_mfma_f32_16x16x32_bf16 v[132:135], a[196:199], a[144:147], 0
  v_mfma_f32_16x16x32_bf16 v[136:139], a[200:203], a[80:83], 0
  v_mfma_f32_16x16x32_bf16 v[140:143], a[200:203], a[96:99], 0
  v_mfma_f32_16x16x32_bf16 v[144:147], a[200:203], a[112:115], 0
  v_mfma_f32_16x16x32_bf16 v[148:151], a[200:203], a[128:131], 0
  v_mfma_f32_16x16x32_bf16 v[152:155], a[200:203], a[144:147], 0
  v_mfma_f32_16x16x32_bf16 v[156:159], a[204:207], a[80:83], 0
  v_mfma_f32_16x16x32_bf16 v[160:163], a[204:207], a[96:99], 0
  v_mfma_f32_16x16x32_bf16 v[164:167], a[204:207], a[112:115], 0
  v_mfma_f32_16x16x32_bf16 v[168:171], a[204:207], a[128:131], 0
  v_mfma_f32_16x16x32_bf16 v[172:175], a[204:207], a[144:147], 0
  s_waitcnt vmcnt(16)
  v_mfma_f32_16x16x32_bf16 v[176:179], a[208:211], a[80:83], 0
  ds_read_b64_tr_b16 a[160:161], v30 offset:8192
  v_mfma_f32_16x16x32_bf16 v[180:183], a[208:211], a[96:99], 0
  ds_read_b64_tr_b16 a[162:163], v30 offset:9216
  v_mfma_f32_16x16x32_bf16 v[184:187], a[208:211], a[112:115], 0
  ds_read_b64_tr_b16 a[164:165], v30 offset:8200
  v_mfma_f32_16x16x32_bf16 v[188:191], a[208:211], a[128:131], 0
  ds_read_b64_tr_b16 a[166:167], v30 offset:9224
  v_mfma_f32_16x16x32_bf16 v[192:195], a[208:211], a[144:147], 0
  v_mfma_f32_16x16x32_bf16 v[196:199], a[212:215], a[80:83], 0
  ds_read_b64_tr_b16 a[168:169], v31 offset:8192
  v_mfma_f32_16x16x32_bf16 v[200:203], a[212:215], a[96:99], 0
  ds_read_b64_tr_b16 a[170:171], v31 offset:9216
  v_mfma_f32_16x16x32_bf16 v[204:207], a[212:215], a[112:115], 0
  ds_read_b64_tr_b16 a[172:173], v31 offset:8200
  v_mfma_f32_16x16x32_bf16 v[208:211], a[212:215], a[128:131], 0
  ds_read_b64_tr_b16 a[174:175], v31 offset:9224
  v_mfma_f32_16x16x32_bf16 v[212:215], a[212:215], a[144:147], 0
  v_mfma_f32_16x16x32_bf16 v[216:219], a[216:219], a[80:83], 0
  ds_read_b64_tr_b16 a[176:177], v32 offset:8192
  v_mfma_f32_16x16x32_bf16 v[220:223], a[216:219], a[96:99], 0
  ds_read_b64_tr_b16 a[178:179], v32 offset:9216
  v_mfma_f32_16x16x32_bf16 v[224:227], a[216:219], a[112:115], 0
  ds_read_b64_tr_b16 a[180:181], v32 offset:8200
  v_mfma_f32_16x16x32_bf16 v[228:231], a[216:219], a[128:131], 0
  ds_read_b64_tr_b16 a[182:183], v32 offset:9224
  v_mfma_f32_16x16x32_bf16 v[232:235], a[216:219], a[144:147], 0
  v_mfma_f32_16x16x32_bf16 v[236:239], a[220:223], a[80:83], 0
  ds_read_b64_tr_b16 a[184:185], v33 offset:8192
  v_mfma_f32_16x16x32_bf16 v[240:243], a[220:223], a[96:99], 0
  ds_read_b64_tr_b16 a[186:187], v33 offset:9216
  v_mfma_f32_16x16x32_bf16 v[244:247], a[220:223], a[112:115], 0
  ds_read_b64_tr_b16 a[188:189], v33 offset:8200
  v_mfma_f32_16x16x32_bf16 v[248:251], a[220:223], a[128:131], 0
  ds_read_b64_tr_b16 a[190:191], v33 offset:9224
  v_mfma_f32_16x16x32_bf16 v[252:255], a[220:223], a[144:147], 0
  s_waitcnt lgkmcnt(0)
  v_mfma_f32_16x16x32_bf16 v[96:99], a[160:163], a[84:87], v[96:99]
  s_add_u32 m0, s64, 0
  v_mfma_f32_16x16x32_bf16 v[100:103], a[160:163], a[100:103], v[100:103]
  s_add_u32 s65, s69, 0
  v_mfma_f32_16x16x32_bf16 v[104:107], a[160:163], a[116:119], v[104:107]
  v_mfma_f32_16x16x32_bf16 v[108:111], a[160:163], a[132:135], v[108:111]
  buffer_load_dwordx4 v22, s[52:55], s65 offen offset:0 lds
  v_mfma_f32_16x16x32_bf16 v[112:115], a[160:163], a[148:151], v[112:115]
  buffer_load_dwordx4 v23, s[52:55], s65 offen offset:1024 lds
  v_mfma_f32_16x16x32_bf16 v[116:119], a[164:167], a[84:87], v[116:119]
  v_mfma_f32_16x16x32_bf16 v[120:123], a[164:167], a[100:103], v[120:123]
  buffer_load_dwordx4 v24, s[52:55], s65 offen offset:2048 lds
  v_mfma_f32_16x16x32_bf16 v[124:127], a[164:167], a[116:119], v[124:127]
  buffer_load_dwordx4 v25, s[52:55], s65 offen offset:3072 lds
  v_mfma_f32_16x16x32_bf16 v[128:131], a[164:167], a[132:135], v[128:131]
  v_mfma_f32_16x16x32_bf16 v[132:135], a[164:167], a[148:151], v[132:135]
  s_add_u32 m0, s64, 4096
  v_mfma_f32_16x16x32_bf16 v[136:139], a[168:171], a[84:87], v[136:139]
  s_add_u32 s65, s69, 4096
  v_mfma_f32_16x16x32_bf16 v[140:143], a[168:171], a[100:103], v[140:143]
  v_mfma_f32_16x16x32_bf16 v[144:147], a[168:171], a[116:119], v[144:147]
  buffer_load_dwordx4 v22, s[52:55], s65 offen offset:0 lds
  v_mfma_f32_16x16x32_bf16 v[148:151], a[168:171], a[132:135], v[148:151]
  buffer_load_dwordx4 v23, s[52:55], s65 offen offset:1024 lds
  v_mfma_f32_16x16x32_bf16 v[152:155], a[168:171], a[148:151], v[152:155]
  v_mfma_f32_16x16x32_bf16 v[156:159], a[172:175], a[84:87], v[156:159]
  buffer_load_dwordx4 v24, s[52:55], s65 offen offset:2048 lds
  v_mfma_f32_16x16x32_bf16 v[160:163], a[172:175], a[100:103], v[160:163]
  buffer_load_dwordx4 v25, s[52:55], s65 offen offset:3072 lds
  v_mfma_f32_16x16x32_bf16 v[164:167], a[172:175], a[116:119], v[164:167]
  v_mfma_f32_16x16x32_bf16 v[168:171], a[172:175], a[132:135], v[168:171]
  s_add_u32 s69, s69, 32768
  v_mfma_f32_16x16x32_bf16 v[172:175], a[172:175], a[148:151], v[172:175]
  s_waitcnt vmcnt(16)
  v_mfma_f32_16x16x32_bf16 v[176:179], a[176:179], a[84:87], v[176:179]
  ds_read_b64_tr_b16 a[192:193], v30 offset:16384
  v_mfma_f32_16x16x32_bf16 v[180:183], a[176:179], a[100:103], v[180:183]
  ds_read_b64_tr_b16 a[194:195], v30 offset:17408
  v_mfma_f32_16x16x32_bf16 v[184:187], a[176:179], a[116:119], v[184:187]
  ds_read_b64_tr_b16 a[196:197], v30 offset:16392
  v_mfma_f32_16x16x32_bf16 v[188:191], a[176:179], a[132:135], v[188:191]
  ds_read_b64_tr_b16 a[198:199], v30 offset:17416
  v_mfma_f32_16x16x32_bf16 v[192:195], a[176:179], a[148:151], v[192:195]
  v_mfma_f32_16x16x32_bf16 v[196:199], a[180:183], a[84:87], v[196:199]
  ds_read_b64_tr_b16 a[200:201], v31 offset:16384
  v_mfma_f32_16x16x32_bf16 v[200:203], a[180:183], a[100:103], v[200:203]
  ds_read_b64_tr_b16 a[202:203], v31 offset:17408
  v_mfma_f32_16x16x32_bf16 v[204:207], a[180:183], a[116:119], v[204:207]
  ds_read_b64_tr_b16 a[204:205], v31 offset:16392
  v_mfma_f32_16x16x32_bf16 v[208:211], a[180:183], a[132:135], v[208:211]
  ds_read_b64_tr_b16 a[206:207], v31 offset:17416
  v_mfma_f32_16x16x32_bf16 v[212:215], a[180:183], a[148:151], v[212:215]
  v_mfma_f32_16x16x32_bf16 v[216:219], a[184:187], a[84:87], v[216:219]
  ds_read_b64_tr_b16 a[208:209], v32 offset:16384
  v_mfma_f32_16x16x32_bf16 v[220:223], a[184:187], a[100:103], v[220:223]
  ds_read_b64_tr_b16 a[210:211], v32 offset:17408
  v_mfma_f32_16x16x32_bf16 v[224:227], a[184:187], a[116:119], v[224:227]
  ds_read_b64_tr_b16 a[212:213], v32 offset:16392
  v_mfma_f32_16x16x32_bf16 v[228:231], a[184:187], a[132:135], v[228:231]
  ds_read_b64_tr_b16 a[214:215], v32 offset:17416
  v_mfma_f32_16x16x32_bf16 v[232:235], a[184:187], a[148:151], v[232:235]
  v_mfma_f32_16x16x32_bf16 v[236:239], a[188:191], a[84:87], v[236:239]
  ds_read_b64_tr_b16 a[216:217], v33 offset:16384
  v_mfma_f32_16x16x32_bf16 v[240:243], a[188:191], a[100:103], v[240:243]
  ds_read_b64_tr_b16 a[218:219], v33 offset:17408
  v_mfma_f32_16x16x32_bf16 v[244:247], a[188:191], a[116:119], v[244:247]
  ds_read_b64_tr_b16 a[220:221], v33 offset:16392
  v_mfma_f32_16x16x32_bf16 v[248:251], a[188:191], a[132:135], v[248:251]
  ds_read_b64_tr_b16 a[222:223], v33 offset:17416
  v_mfma_f32_16x16x32_bf16 v[252:255], a[188:191], a[148:151], v[252:255]
  s_waitcnt lgkmcnt(0)
  v_mfma_f32_16x16x32_bf16 v[96:99], a[192:195], a[88:91], v[96:99]
  s_add_u32 m0, s64, 8192
  v_mfma_f32_16x16x32_bf16 v[100:103], a[192:195], a[104:107], v[100:103]
  s_add_u32 s66, s70, 0
  v_mfma_f32_16x16x32_bf16 v[104:107], a[192:195], a[120:123], v[104:107]
  v_mfma_f32_16x16x32_bf16 v[108:111], a[192:195], a[136:139], v[108:111]
  buffer_load_dwordx4 v26, s[56:59], s66 offen offset:0 lds
  v_mfma_f32_16x16x32_bf16 v[112:115], a[192:195], a[152:155], v[112:115]
  buffer_load_dwordx4 v27, s[56:59], s66 offen offset:1024 lds
  v_mfma_f32_16x16x32_bf16 v[116:119], a[196:199], a[88:91], v[116:119]
  v_mfma_f32_16x16x32_bf16 v[120:123], a[196:199], a[104:107], v[120:123]
  buffer_load_dwordx4 v26, s[56:59], s66 offen offset:2048 lds
  v_mfma_f32_16x16x32_bf16 v[124:127], a[196:199], a[120:123], v[124:127]
  buffer_load_dwordx4 v27, s[56:59], s66 offen offset:3072 lds
  v_mfma_f32_16x16x32_bf16 v[128:131], a[196:199], a[136:139], v[128:131]
  v_mfma_f32_16x16x32_bf16 v[132:135], a[196:199], a[152:155], v[132:135]
  s_add_u32 m0, s64, 12288
  v_mfma_f32_16x16x32_bf16 v[136:139], a[200:203], a[88:91], v[136:139]
  s_add_u32 s66, s70, 4096
  v_mfma_f32_16x16x32_bf16 v[140:143], a[200:203], a[104:107], v[140:143]
  v_mfma_f32_16x16x32_bf16 v[144:147], a[200:203], a[120:123], v[144:147]
  buffer_load_dwordx4 v26, s[56:59], s66 offen offset:0 lds
  v_mfma_f32_16x16x32_bf16 v[148:151], a[200:203], a[136:139], v[148:151]
  buffer_load_dwordx4 v27, s[56:59], s66 offen offset:1024 lds
  v_mfma_f32_16x16x32_bf16 v[152:155], a[200:203], a[152:155], v[152:155]
  v_mfma_f32_16x16x32_bf16 v[156:159], a[204:207], a[88:91], v[156:159]
  buffer_load_dwordx4 v26, s[56:59], s66 offen offset:2048 lds
  v_mfma_f32_16x16x32_bf16 v[160:163], a[204:207], a[104:107], v[160:163]
  buffer_load_dwordx4 v27, s[56:59], s66 offen offset:3072 lds
  v_mfma_f32_16x16x32_bf16 v[164:167], a[204:207], a[120:123], v[164:167]
  v_mfma_f32_16x16x32_bf16 v[168:171], a[204:207], a[136:139], v[168:171]
  s_add_u32 s70, s70, 32768
  v_mfma_f32_16x16x32_bf16 v[172:175], a[204:207], a[152:155], v[172:175]
  s_waitcnt vmcnt(16)
  v_mfma_f32_16x16x32_bf16 v[176:179], a[208:211], a[88:91], v[176:179]
  ds_read_b64_tr_b16 a[160:161], v30 offset:24576
  v_mfma_f32_16x16x32_bf16 v[180:183], a[208:211], a[104:107], v[180:183]
  ds_read_b64_tr_b16 a[162:163], v30 offset:25600
  v_mfma_f32_16x16x32_bf16 v[184:187], a[208:211], a[120:123], v[184:187]
  ds_read_b64_tr_b16 a[164:165], v30 offset:24584
  v_mfma_f32_16x16x32_bf16 v[188:191], a[208:211], a[136:139], v[188:191]
  ds_read_b64_tr_b16 a[166:167], v30 offset:25608
  v_mfma_f32_16x16x32_bf16 v[192:195], a[208:211], a[152:155], v[192:195]
  v_mfma_f32_16x16x32_bf16 v[196:199], a[212:215], a[88:91], v[196:199]
  ds_read_b64_tr_b16 a[168:169], v31 offset:24576
  v_mfma_f32_16x16x32_bf16 v[200:203], a[212:215], a[104:107], v[200:203]
  ds_read_b64_tr_b16 a[170:171], v31 offset:25600
  v_mfma_f32_16x16x32_bf16 v[204:207], a[212:215], a[120:123], v[204:207]
  ds_read_b64_tr_b16 a[172:173], v31 offset:24584
  v_mfma_f32_16x16x32_bf16 v[208:211], a[212:215], a[136:139], v[208:211]
  ds_read_b64_tr_b16 a[174:175], v31 offset:25608
  v_mfma_f32_16x16x32_bf16 v[212:215], a[212:215], a[152:155], v[212:215]
  v_mfma_f32_16x16x32_bf16 v[216:219], a[216:219], a[88:91], v[216:219]
  ds_read_b64_tr_b16 a[176:177], v32 offset:24576
  v_mfma_f32_16x16x32_bf16 v[220:223], a[216:219], a[104:107], v[220:223]
  ds_read_b64_tr_b16 a[178:179], v32 offset:25600
  v_mfma_f32_16x16x32_bf16 v[224:227], a[216:219], a[120:123], v[224:227]
  ds_read_b64_tr_b16 a[180:181], v32 offset:24584
  v_mfma_f32_16x16x32_bf16 v[228:231], a[216:219], a[136:139], v[228:231]
  ds_read_b64_tr_b16 a[182:183], v32 offset:25608
  v_mfma_f32_16x16x32_bf16 v[232:235], a[216:219], a[152:155], v[232:235]
  v_mfma_f32_16x16x32_bf16 v[236:239], a[220:223], a[88:91], v[236:239]
  ds_read_b64_tr_b16 a[184:185], v33 offset:24576
  v_mfma_f32_16x16x32_bf16 v[240:243], a[220:223], a[104:107], v[240:243]
  ds_read_b64_tr_b16 a[186:187], v33 offset:25600
  v_mfma_f32_16x16x32_bf16 v[244:247], a[220:223], a[120:123], v[244:247]
  ds_read_b64_tr_b16 a[188:189], v33 offset:24584
  v_mfma_f32_16x16x32_bf16 v[248:251], a[220:223], a[136:139], v[248:251]
  ds_read_b64_tr_b16 a[190:191], v33 offset:25608
  v_mfma_f32_16x16x32_bf16 v[252:255], a[220:223], a[152:155], v[252:255]
  s_waitcnt lgkmcnt(0)
  v_mfma_f32_16x16x32_bf16 v[96:99], a[160:163], a[92:95], v[96:99]
  v_mfma_f32_16x16x32_bf16 v[100:103], a[160:163], a[108:111], v[100:103]
  v_mfma_f32_16x16x32_bf16 v[104:107], a[160:163], a[124:127], v[104:107]
  v_mfma_f32_16x16x32_bf16 v[108:111], a[160:163], a[140:143], v[108:111]
  v_mfma_f32_16x16x32_bf16 v[112:115], a[160:163], a[156:159], v[112:115]
  v_mfma_f32_16x16x32_bf16 v[116:119], a[164:167], a[92:95], v[116:119]
  v_mfma_f32_16x16x32_bf16 v[120:123], a[164:167], a[108:111], v[120:123]
  v_mfma_f32_16x16x32_bf16 v[124:127], a[164:167], a[124:127], v[124:127]
  v_mfma_f32_16x16x32_bf16 v[128:131], a[164:167], a[140:143], v[128:131]
  v_mfma_f32_16x16x32_bf16 v[132:135], a[164:167], a[156:159], v[132:135]
  v_mfma_f32_16x16x32_bf16 v[136:139], a[168:171], a[92:95], v[136:139]
  v_mfma_f32_16x16x32_bf16 v[140:143], a[168:171], a[108:111], v[140:143]
  v_mfma_f32_16x16x32_bf16 v[144:147], a[168:171], a[124:127], v[144:147]
  v_mfma_f32_16x16x32_bf16 v[148:151], a[168:171], a[140:143], v[148:151]
  v_mfma_f32_16x16x32_bf16 v[152:155], a[168:171], a[156:159], v[152:155]
  v_mfma_f32_16x16x32_bf16 v[156:159], a[172:175], a[92:95], v[156:159]
  v_mfma_f32_16x16x32_bf16 v[160:163], a[172:175], a[108:111], v[160:163]
  v_mfma_f32_16x16x32_bf16 v[164:167], a[172:175], a[124:127], v[164:167]
  v_mfma_f32_16x16x32_bf16 v[168:171], a[172:175], a[140:143], v[168:171]
  v_mfma_f32_16x16x32_bf16 v[172:175], a[172:175], a[156:159], v[172:175]
  v_mfma_f32_16x16x32_bf16 v[176:179], a[176:179], a[92:95], v[176:179]
  v_mfma_f32_16x16x32_bf16 v[180:183], a[176:179], a[108:111], v[180:183]
  v_mfma_f32_16x16x32_bf16 v[184:187], a[176:179], a[124:127], v[184:187]
  v_mfma_f32_16x16x32_bf16 v[188:191], a[176:179], a[140:143], v[188:191]
  v_mfma_f32_16x16x32_bf16 v[192:195], a[176:179], a[156:159], v[192:195]
  v_mfma_f32_16x16x32_bf16 v[196:199], a[180:183], a[92:95], v[196:199]
  v_mfma_f32_16x16x32_bf16 v[200:203], a[180:183], a[108:111], v[200:203]
  v_mfma_f32_16x16x32_bf16 v[204:207], a[180:183], a[124:127], v[204:207]
  v_mfma_f32_16x16x32_bf16 v[208:211], a[180:183], a[140:143], v[208:211]
  v_mfma_f32_16x16x32_bf16 v[212:215], a[180:183], a[156:159], v[212:215]
  v_mfma_f32_16x16x32_bf16 v[216:219], a[184:187], a[92:95], v[216:219]
  v_mfma_f32_16x16x32_bf16 v[220:223], a[184:187], a[108:111], v[220:223]
  v_mfma_f32_16x16x32_bf16 v[224:227], a[184:187], a[124:127], v[224:227]
  v_mfma_f32_16x16x32_bf16 v[228:231], a[184:187], a[140:143], v[228:231]
  v_mfma_f32_16x16x32_bf16 v[232:235], a[184:187], a[156:159], v[232:235]
  v_mfma_f32_16x16x32_bf16 v[236:239], a[188:191], a[92:95], v[236:239]
  v_mfma_f32_16x16x32_bf16 v[240:243], a[188:191], a[108:111], v[240:243]
  v_mfma_f32_16x16x32_bf16 v[244:247], a[188:191], a[124:127], v[244:247]
  v_mfma_f32_16x16x32_bf16 v[248:251], a[188:191], a[140:143], v[248:251]
  v_mfma_f32_16x16x32_bf16 v[252:255], a[188:191], a[156:159], v[252:255]
  s_nop 7
  s_call_b64 s[96:97], L_rsq
  s_cmp_eq_u32 s34, 0
  s_cbranch_scc0 L_init_1
  v_mov_b32 v6, 1
  v_mov_b32 v7, 0
  v_cmp_eq_u32 vcc, 0, v0
  s_and_saveexec_b64 s[94:95], vcc
  buffer_atomic_add v6, v7, s[4:7], 0 offen sc1
  s_mov_b64 exec, s[94:95]
L_init_1:
  s_mov_b32 s4, s32
  s_and_b32 s5, s33, 0xffff
  s_mov_b32 s6, 33587200
  s_mov_b32 s7, 0x20000
  s_mov_b32 s65, 0x3e0293ee
  v_mul_f32 v96, s65, v96
  v_mul_f32 v97, s65, v97
  v_mul_f32 v98, s65, v98
  v_mul_f32 v99, s65, v99
  v_mul_f32 v100, s65, v100
  v_mul_f32 v101, s65, v101
  v_mul_f32 v102, s65, v102
  v_mul_f32 v103, s65, v103
  v_mul_f32 v104, s65, v104
  v_mul_f32 v105, s65, v105
  v_mul_f32 v106, s65, v106
  v_mul_f32 v107, s65, v107
  v_mul_f32 v108, s65, v108
  v_mul_f32 v109, s65, v109
  v_mul_f32 v110, s65, v110
  v_mul_f32 v111, s65, v111
  v_mul_f32 v112, s65, v112
  v_mul_f32 v113, s65, v113
  v_mul_f32 v114, s65, v114
  v_mul_f32 v115, s65, v115
  v_mul_f32 v116, s65, v116
  v_mul_f32 v117, s65, v117
  v_mul_f32 v118, s65, v118
  v_mul_f32 v119, s65, v119
  v_mul_f32 v120, s65, v120
  v_mul_f32 v121, s65, v121
  v_mul_f32 v122, s65, v122
  v_mul_f32 v123, s65, v123
  v_mul_f32 v124, s65, v124
  v_mul_f32 v125, s65, v125
  v_mul_f32 v126, s65, v126
  v_mul_f32 v127, s65, v127
  v_mul_f32 v128, s65, v128
  v_mul_f32 v129, s65, v129
  v_mul_f32 v130, s65, v130
  v_mul_f32 v131, s65, v131
  v_mul_f32 v132, s65, v132
  v_mul_f32 v133, s65, v133
  v_mul_f32 v134, s65, v134
  v_mul_f32 v135, s65, v135
  v_cvt_pk_bf16_f32 v64, v96, v97
  v_cvt_pk_bf16_f32 v65, v98, v99
  v_cvt_pk_bf16_f32 v66, v116, v117
  v_cvt_pk_bf16_f32 v67, v118, v119
  v_cvt_pk_bf16_f32 v68, v100, v101
  v_cvt_pk_bf16_f32 v69, v102, v103
  v_cvt_pk_bf16_f32 v70, v120, v121
  v_cvt_pk_bf16_f32 v71, v122, v123
  v_cvt_pk_bf16_f32 v72, v104, v105
  v_cvt_pk_bf16_f32 v73, v106, v107
  v_cvt_pk_bf16_f32 v74, v124, v125
  v_cvt_pk_bf16_f32 v75, v126, v127
  v_cvt_pk_bf16_f32 v76, v108, v109
  v_cvt_pk_bf16_f32 v77, v110, v111
  v_cvt_pk_bf16_f32 v78, v128, v129
  v_cvt_pk_bf16_f32 v79, v130, v131
  v_cvt_pk_bf16_f32 v80, v112, v113
  v_cvt_pk_bf16_f32 v81, v114, v115
  v_cvt_pk_bf16_f32 v82, v132, v133
  v_cvt_pk_bf16_f32 v83, v134, v135
  s_waitcnt vmcnt(16)
  ds_read_b128 a[160:163], v10 offset:0
  ds_read_b128 a[164:167], v11 offset:0
  ds_read_b128 a[168:171], v12 offset:0
  ds_read_b128 a[172:175], v13 offset:0
  ds_read_b128 a[176:179], v10 offset:4096
  ds_read_b128 a[180:183], v11 offset:4096
  ds_read_b128 a[184:187], v12 offset:4096
  ds_read_b128 a[188:191], v13 offset:4096
  s_barrier
  s_add_u32 s65, s64, 32768
  v_add_u32 v6, s65, v35
  ds_write_b128 v6, v[64:67] offset:0
  ds_write_b128 v6, v[68:71] offset:1024
  ds_write_b128 v6, v[72:75] offset:2048
  ds_write_b128 v6, v[76:79] offset:3072
  ds_write_b128 v6, v[80:83] offset:4096
  s_add_u32 m0, s64, 24576
  s_add_u32 s66, s70, 0
  buffer_load_dwordx4 v26, s[56:59], s66 offen offset:0 lds
  buffer_load_dwordx4 v27, s[56:59], s66 offen offset:1024 lds
  buffer_load_dwordx4 v26, s[56:59], s66 offen offset:2048 lds
  buffer_load_dwordx4 v27, s[56:59], s66 offen offset:3072 lds
  s_add_u32 m0, s64, 28672
  s_add_u32 s66, s70, 4096
  buffer_load_dwordx4 v26, s[56:59], s66 offen offset:0 lds
  buffer_load_dwordx4 v27, s[56:59], s66 offen offset:1024 lds
  buffer_load_dwordx4 v26, s[56:59], s66 offen offset:2048 lds
  buffer_load_dwordx4 v27, s[56:59], s66 offen offset:3072 lds
  s_add_u32 s70, s70, 32768
  s_cmp_eq_u32 s39, 0
  s_cselect_b32 s44, s8, s18
  s_cselect_b32 s45, s9, s19
  s_cselect_b32 s48, s14, s24
  s_cselect_b32 s49, s15, s25
  s_mul_i32 s65, s35, 81920
  s_add_u32 s44, s44, s65
  s_addc_u32 s45, s45, 0
  s_and_b32 s45, s45, 0xffff
  s_mov_b32 s46, 81920
  s_mov_b32 s47, 0x20000
  s_lshl_b32 s65, s36, 8
  s_add_u32 s48, s48, s65
  s_addc_u32 s49, s49, 0
  s_and_b32 s49, s49, 0xffff
  s_mov_b32 s50, 4186368
  s_mov_b32 s51, 0x20000
  s_lshl_b32 s65, s40, 3
  s_add_u32 s65, s65, s35
  s_lshl_b32 s65, s65, 5
  s_add_u32 s65, s65, s36
  s_mul_i32 s65, s65, 20480
  s_add_u32 s60, s32, s65
  s_addc_u32 s61, s33, 0
  s_and_b32 s61, s61, 0xffff
  s_mov_b32 s62, 20480
  s_mov_b32 s63, 0x20000
  s_waitcnt lgkmcnt(0)
  s_barrier
  v_add_u32 v6, 32768, v35
  ds_read_b128 a[0:3], v6 offset:0
  ds_read_b128 a[16:19], v6 offset:1024
  ds_read_b128 a[32:35], v6 offset:2048
  ds_read_b128 a[48:51], v6 offset:3072
  ds_read_b128 a[64:67], v6 offset:4096
  v_add_u32 v6, 73728, v35
  ds_read_b128 a[4:7], v6 offset:0
  ds_read_b128 a[20:23], v6 offset:1024
  ds_read_b128 a[36:39], v6 offset:2048
  ds_read_b128 a[52:55], v6 offset:3072
  ds_read_b128 a[68:71], v6 offset:4096
  v_add_u32 v6, 114688, v35
  ds_read_b128 a[8:11], v6 offset:0
  ds_read_b128 a[24:27], v6 offset:1024
  ds_read_b128 a[40:43], v6 offset:2048
  ds_read_b128 a[56:59], v6 offset:3072
  ds_read_b128 a[72:75], v6 offset:4096
  v_add_u32 v6, 155648, v35
  ds_read_b128 a[12:15], v6 offset:0
  ds_read_b128 a[28:31], v6 offset:1024
  ds_read_b128 a[44:47], v6 offset:2048
  ds_read_b128 a[60:63], v6 offset:3072
  ds_read_b128 a[76:79], v6 offset:4096
  s_waitcnt lgkmcnt(0)
  s_lshl_b32 s101, s100, 7
  s_add_u32 s101, s101, 33554492
  v_mov_b32 v38, s101
  s_mov_b32 s71, 0
  v_lshlrev_b32 v1, 7, v0
  s_waitcnt vmcnt(16)
  s_cmp_eq_u32 s40, 0
  s_cbranch_scc0 L_cl_2_b
  s_call_b64 s[96:97], L_attA
  s_branch L_cl_2_e
L_cl_2_b:
  s_call_b64 s[96:97], L_attB
L_cl_2_e:
  s_waitcnt vmcnt(16)
  v_mfma_f32_16x16x32_bf16 v[40:43], a[160:163], a[0:3], 0
  ds_read_b64_tr_b16 a[192:193], v14 offset:8192
  ds_read_b64_tr_b16 a[194:195], v14 offset:12288
  ds_read_b64_tr_b16 a[196:197], v15 offset:8192
  ds_read_b64_tr_b16 a[198:199], v15 offset:12288
  ds_read_b64_tr_b16 a[200:201], v16 offset:8192
  ds_read_b64_tr_b16 a[202:203], v16 offset:12288
  ds_read_b64_tr_b16 a[204:205], v17 offset:8192
  ds_read_b64_tr_b16 a[206:207], v17 offset:12288
  v_mfma_f32_16x16x32_bf16 v[40:43], a[164:167], a[4:7], v[40:43]
  ds_read_b64_tr_b16 a[208:209], v18 offset:8192
  ds_read_b64_tr_b16 a[210:211], v18 offset:12288
  ds_read_b64_tr_b16 a[212:213], v19 offset:8192
  ds_read_b64_tr_b16 a[214:215], v19 offset:12288
  v_lshrrev_b32 v5, 4, v0
  v_mul_u32_u24 v5, 0x300, v5
  s_lshl_b32 s67, s34, 8
  v_mfma_f32_16x16x32_bf16 v[40:43], a[168:171], a[8:11], v[40:43]
  v_add_u32 v5, s67, v5
  v_add_u32 v1, v22, v5
  v_add_u32 v2, v23, v5
  v_add_u32 v3, v24, v5
  v_add_u32 v4, v25, v5
  s_add_u32 m0, s64, 32768
  s_mov_b32 s68, 0
  v_mfma_f32_16x16x32_bf16 v[40:43], a[172:175], a[12:15], v[40:43]
  buffer_load_dwordx4 v1, s[44:47], s68 offen lds
  s_add_u32 m0, s64, 33792
  s_mov_b32 s68, 4096
  buffer_load_dwordx4 v2, s[44:47], s68 offen lds
  s_add_u32 m0, s64, 34816
  s_mov_b32 s68, 8192
  buffer_load_dwordx4 v3, s[44:47], s68 offen lds
  v_mfma_f32_16x16x32_bf16 v[44:47], a[176:179], a[0:3], 0
  s_add_u32 m0, s64, 35840
  s_mov_b32 s68, 12288
  buffer_load_dwordx4 v4, s[44:47], s68 offen lds
  s_add_u32 m0, s64, 36864
  s_mov_b32 s68, 16384
  buffer_load_dwordx4 v1, s[44:47], s68 offen lds
  s_add_u32 m0, s64, 37888
  s_mov_b32 s68, 20480
  v_mfma_f32_16x16x32_bf16 v[44:47], a[180:183], a[4:7], v[44:47]
  buffer_load_dwordx4 v2, s[44:47], s68 offen lds
  s_add_u32 m0, s64, 38912
  s_mov_b32 s68, 24576
  buffer_load_dwordx4 v3, s[44:47], s68 offen lds
  s_add_u32 m0, s64, 39936
  s_mov_b32 s68, 28672
  buffer_load_dwordx4 v4, s[44:47], s68 offen lds
  v_mfma_f32_16x16x32_bf16 v[44:47], a[184:187], a[8:11], v[44:47]
  s_add_u32 m0, s64, 0
  s_mov_b32 s68, 32768
  buffer_load_dwordx4 v1, s[44:47], s68 offen lds
  s_add_u32 m0, s64, 1024
  s_mov_b32 s68, 36864
  buffer_load_dwordx4 v2, s[44:47], s68 offen lds
  s_add_u32 m0, s64, 2048
  v_mfma_f32_16x16x32_bf16 v[44:47], a[188:191], a[12:15], v[44:47]
  s_mov_b32 s68, 40960
  buffer_load_dwordx4 v3, s[44:47], s68 offen lds
  s_add_u32 m0, s64, 3072
  s_mov_b32 s68, 45056
  buffer_load_dwordx4 v4, s[44:47], s68 offen lds
  s_add_u32 m0, s64, 4096
  s_mov_b32 s68, 49152
  v_mfma_f32_16x16x32_bf16 v[48:51], a[160:163], a[16:19], 0
  v_exp_f32 v40, v40
  v_exp_f32 v41, v41
  v_exp_f32 v42, v42
  v_mfma_f32_16x16x32_bf16 v[48:51], a[164:167], a[20:23], v[48:51]
  v_exp_f32 v43, v43
  v_cvt_pk_bf16_f32 v64, v40, v41
  v_mfma_f32_16x16x32_bf16 v[48:51], a[168:171], a[24:27], v[48:51]
  v_cvt_pk_bf16_f32 v65, v42, v43
  v_exp_f32 v44, v44
  v_mfma_f32_16x16x32_bf16 v[48:51], a[172:175], a[28:31], v[48:51]
  v_exp_f32 v45, v45
  v_exp_f32 v46, v46
  v_mfma_f32_16x16x32_bf16 v[52:55], a[176:179], a[16:19], 0
  v_exp_f32 v47, v47
  v_cvt_pk_bf16_f32 v66, v44, v45
  v_cvt_pk_bf16_f32 v67, v46, v47
  v_mfma_f32_16x16x32_bf16 v[52:55], a[180:183], a[20:23], v[52:55]
  ds_read_b64_tr_b16 a[216:217], v20 offset:8192
  ds_read_b64_tr_b16 a[218:219], v20 offset:12288
  v_mfma_f32_16x16x32_bf16 v[52:55], a[184:187], a[24:27], v[52:55]
  ds_read_b64_tr_b16 a[220:221], v21 offset:8192
  ds_read_b64_tr_b16 a[222:223], v21 offset:12288
  v_mfma_f32_16x16x32_bf16 v[52:55], a[188:191], a[28:31], v[52:55]
  buffer_load_dwordx4 v1, s[44:47], s68 offen lds
  s_add_u32 m0, s64, 5120
  v_mfma_f32_16x16x32_bf16 v[56:59], a[160:163], a[32:35], 0
  v_exp_f32 v48, v48
  v_exp_f32 v49, v49
  v_mfma_f32_16x16x32_bf16 v[56:59], a[164:167], a[36:39], v[56:59]
  v_exp_f32 v50, v50
  v_exp_f32 v51, v51
  v_mfma_f32_16x16x32_bf16 v[56:59], a[168:171], a[40:43], v[56:59]
  v_cvt_pk_bf16_f32 v68, v48, v49
  v_cvt_pk_bf16_f32 v69, v50, v51
  v_mfma_f32_16x16x32_bf16 v[56:59], a[172:175], a[44:47], v[56:59]
  v_exp_f32 v52, v52
  v_exp_f32 v53, v53
  v_mfma_f32_16x16x32_bf16 v[60:63], a[176:179], a[32:35], 0
  v_exp_f32 v54, v54
  v_exp_f32 v55, v55
  v_mfma_f32_16x16x32_bf16 v[60:63], a[180:183], a[36:39], v[60:63]
  v_cvt_pk_bf16_f32 v70, v52, v53
  v_cvt_pk_bf16_f32 v71, v54, v55
  v_mfma_f32_16x16x32_bf16 v[60:63], a[184:187], a[40:43], v[60:63]
  s_mov_b32 s68, 53248
  buffer_load_dwordx4 v2, s[44:47], s68 offen lds
  v_mfma_f32_16x16x32_bf16 v[60:63], a[188:191], a[44:47], v[60:63]
  s_add_u32 m0, s64, 6144
  v_mfma_f32_16x16x32_bf16 v[40:43], a[160:163], a[48:51], 0
  v_exp_f32 v56, v56
  v_exp_f32 v57, v57
  v_mfma_f32_16x16x32_bf16 v[40:43], a[164:167], a[52:55], v[40:43]
  v_exp_f32 v58, v58
  v_exp_f32 v59, v59
  v_mfma_f32_16x16x32_bf16 v[40:43], a[168:171], a[56:59], v[40:43]
  v_cvt_pk_bf16_f32 v72, v56, v57
  v_cvt_pk_bf16_f32 v73, v58, v59
  v_mfma_f32_16x16x32_bf16 v[40:43], a[172:175], a[60:63], v[40:43]
  v_exp_f32 v60, v60
  v_mfma_f32_16x16x32_bf16 v[44:47], a[176:179], a[48:51], 0
  v_exp_f32 v61, v61
  v_exp_f32 v62, v62
  v_mfma_f32_16x16x32_bf16 v[44:47], a[180:183], a[52:55], v[44:47]
  v_exp_f32 v63, v63
  v_cvt_pk_bf16_f32 v74, v60, v61
  v_mfma_f32_16x16x32_bf16 v[44:47], a[184:187], a[56:59], v[44:47]
  v_cvt_pk_bf16_f32 v75, v62, v63
  s_mov_b32 s68, 57344
  v_mfma_f32_16x16x32_bf16 v[44:47], a[188:191], a[60:63], v[44:47]
  buffer_load_dwordx4 v3, s[44:47], s68 offen lds
  v_mfma_f32_16x16x32_bf16 v[48:51], a[160:163], a[64:67], 0
  v_exp_f32 v40, v40
  v_exp_f32 v41, v41
  v_mfma_f32_16x16x32_bf16 v[48:51], a[164:167], a[68:71], v[48:51]
  v_exp_f32 v42, v42
  v_exp_f32 v43, v43
  v_mfma_f32_16x16x32_bf16 v[48:51], a[168:171], a[72:75], v[48:51]
  v_cvt_pk_bf16_f32 v76, v40, v41
  v_cvt_pk_bf16_f32 v77, v42, v43
  v_mfma_f32_16x16x32_bf16 v[48:51], a[172:175], a[76:79], v[48:51]
  v_exp_f32 v44, v44
  v_exp_f32 v45, v45
  v_mfma_f32_16x16x32_bf16 v[52:55], a[176:179], a[64:67], 0
  v_exp_f32 v46, v46
  v_exp_f32 v47, v47
  v_mfma_f32_16x16x32_bf16 v[52:55], a[180:183], a[68:71], v[52:55]
  v_cvt_pk_bf16_f32 v78, v44, v45
  v_cvt_pk_bf16_f32 v79, v46, v47
  v_mfma_f32_16x16x32_bf16 v[52:55], a[184:187], a[72:75], v[52:55]
  s_add_u32 m0, s64, 7168
  s_mov_b32 s68, 61440
  v_mfma_f32_16x16x32_bf16 v[52:55], a[188:191], a[76:79], v[52:55]
  buffer_load_dwordx4 v4, s[44:47], s68 offen lds
  s_waitcnt lgkmcnt(0)
  v_mfma_f32_16x16x32_bf16 v[96:99], a[192:195], v[64:67], v[96:99]
  v_exp_f32 v48, v48
  v_exp_f32 v49, v49
  v_mfma_f32_16x16x32_bf16 v[116:119], a[196:199], v[64:67], v[116:119]
  v_exp_f32 v50, v50
  v_mfma_f32_16x16x32_bf16 v[136:139], a[200:203], v[64:67], v[136:139]
  v_exp_f32 v51, v51
  v_mfma_f32_16x16x32_bf16 v[156:159], a[204:207], v[64:67], v[156:159]
  v_cvt_pk_bf16_f32 v80, v48, v49
  v_cvt_pk_bf16_f32 v81, v50, v51
  v_mfma_f32_16x16x32_bf16 v[176:179], a[208:211], v[64:67], v[176:179]
  v_exp_f32 v52, v52
  v_mfma_f32_16x16x32_bf16 v[196:199], a[212:215], v[64:67], v[196:199]
  v_exp_f32 v53, v53
  v_mfma_f32_16x16x32_bf16 v[216:219], a[216:219], v[64:67], v[216:219]
  v_exp_f32 v54, v54
  v_exp_f32 v55, v55
  v_mfma_f32_16x16x32_bf16 v[236:239], a[220:223], v[64:67], v[236:239]
  v_cvt_pk_bf16_f32 v82, v52, v53
  v_mfma_f32_16x16x32_bf16 a[224:227], a[244:247], v[64:67], a[224:227]
  v_cvt_pk_bf16_f32 v83, v54, v55
  s_waitcnt vmcnt(24)
  v_mfma_f32_16x16x32_bf16 v[100:103], a[192:195], v[68:71], v[100:103]
  ds_read_b128 a[160:163], v10 offset:16384
  ds_read_b128 a[164:167], v11 offset:16384
  v_mfma_f32_16x16x32_bf16 v[120:123], a[196:199], v[68:71], v[120:123]
  ds_read_b128 a[168:171], v12 offset:16384
  v_mfma_f32_16x16x32_bf16 v[140:143], a[200:203], v[68:71], v[140:143]
  ds_read_b128 a[172:175], v13 offset:16384
  v_mfma_f32_16x16x32_bf16 v[160:163], a[204:207], v[68:71], v[160:163]
  ds_read_b128 a[176:179], v10 offset:20480
  ds_read_b128 a[180:183], v11 offset:20480
  v_mfma_f32_16x16x32_bf16 v[180:183], a[208:211], v[68:71], v[180:183]
  ds_read_b128 a[184:187], v12 offset:20480
  v_mfma_f32_16x16x32_bf16 v[200:203], a[212:215], v[68:71], v[200:203]
  ds_read_b128 a[188:191], v13 offset:20480
  v_mfma_f32_16x16x32_bf16 v[220:223], a[216:219], v[68:71], v[220:223]
  s_add_u32 m0, s64, 8192
  s_mov_b32 s68, 65536
  v_mfma_f32_16x16x32_bf16 v[240:243], a[220:223], v[68:71], v[240:243]
  buffer_load_dwordx4 v1, s[44:47], s68 offen lds
  v_mfma_f32_16x16x32_bf16 a[228:231], a[244:247], v[68:71], a[228:231]
  s_add_u32 m0, s64, 9216
  v_mfma_f32_16x16x32_bf16 v[104:107], a[192:195], v[72:75], v[104:107]
  s_mov_b32 s68, 69632
  v_mfma_f32_16x16x32_bf16 v[124:127], a[196:199], v[72:75], v[124:127]
  v_mfma_f32_16x16x32_bf16 v[144:147], a[200:203], v[72:75], v[144:147]
  buffer_load_dwordx4 v2, s[44:47], s68 offen lds
  v_mfma_f32_16x16x32_bf16 v[164:167], a[204:207], v[72:75], v[164:167]
  v_mfma_f32_16x16x32_bf16 v[184:187], a[208:211], v[72:75], v[184:187]
  s_add_u32 m0, s64, 10240
  v_mfma_f32_16x16x32_bf16 v[204:207], a[212:215], v[72:75], v[204:207]
  v_mfma_f32_16x16x32_bf16 v[224:227], a[216:219], v[72:75], v[224:227]
  s_mov_b32 s68, 73728
  v_mfma_f32_16x16x32_bf16 v[244:247], a[220:223], v[72:75], v[244:247]
  v_mfma_f32_16x16x32_bf16 a[232:235], a[244:247], v[72:75], a[232:235]
  v_mfma_f32_16x16x32_bf16 v[108:111], a[192:195], v[76:79], v[108:111]
  buffer_load_dwordx4 v3, s[44:47], s68 offen lds
  v_mfma_f32_16x16x32_bf16 v[128:131], a[196:199], v[76:79], v[128:131]
  v_mfma_f32_16x16x32_bf16 v[148:151], a[200:203], v[76:79], v[148:151]
  s_add_u32 m0, s64, 11264
  v_mfma_f32_16x16x32_bf16 v[168:171], a[204:207], v[76:79], v[168:171]
  v_mfma_f32_16x16x32_bf16 v[188:191], a[208:211], v[76:79], v[188:191]
  s_mov_b32 s68, 77824
  v_mfma_f32_16x16x32_bf16 v[208:211], a[212:215], v[76:79], v[208:211]
  v_mfma_f32_16x16x32_bf16 v[228:231], a[216:219], v[76:79], v[228:231]
  buffer_load_dwordx4 v4, s[44:47], s68 offen lds
  v_mfma_f32_16x16x32_bf16 v[248:251], a[220:223], v[76:79], v[248:251]
  v_mfma_f32_16x16x32_bf16 a[236:239], a[244:247], v[76:79], a[236:239]
  v_mfma_f32_16x16x32_bf16 v[112:115], a[192:195], v[80:83], v[112:115]
  v_mfma_f32_16x16x32_bf16 v[132:135], a[196:199], v[80:83], v[132:135]
  v_mfma_f32_16x16x32_bf16 v[152:155], a[200:203], v[80:83], v[152:155]
  v_mfma_f32_16x16x32_bf16 v[172:175], a[204:207], v[80:83], v[172:175]
  v_mfma_f32_16x16x32_bf16 v[192:195], a[208:211], v[80:83], v[192:195]
  v_mfma_f32_16x16x32_bf16 v[212:215], a[212:215], v[80:83], v[212:215]
  v_mfma_f32_16x16x32_bf16 v[232:235], a[216:219], v[80:83], v[232:235]
  v_mfma_f32_16x16x32_bf16 v[252:255], a[220:223], v[80:83], v[252:255]
  v_mfma_f32_16x16x32_bf16 a[240:243], a[244:247], v[80:83], a[240:243]
  s_waitcnt lgkmcnt(0)
  s_waitcnt vmcnt(20)
  v_mfma_f32_16x16x32_bf16 v[40:43], a[160:163], a[0:3], 0
  ds_read_b64_tr_b16 a[192:193], v14 offset:24576
  ds_read_b64_tr_b16 a[194:195], v14 offset:28672
  ds_read_b64_tr_b16 a[196:197], v15 offset:24576
  ds_read_b64_tr_b16 a[198:199], v15 offset:28672
  v_mfma_f32_16x16x32_bf16 v[40:43], a[164:167], a[4:7], v[40:43]
  ds_read_b64_tr_b16 a[200:201], v16 offset:24576
  ds_read_b64_tr_b16 a[202:203], v16 offset:28672
  ds_read_b64_tr_b16 a[204:205], v17 offset:24576
  ds_read_b64_tr_b16 a[206:207], v17 offset:28672
  v_mfma_f32_16x16x32_bf16 v[40:43], a[168:171], a[8:11], v[40:43]
  ds_read_b64_tr_b16 a[208:209], v18 offset:24576
  ds_read_b64_tr_b16 a[210:211], v18 offset:28672
  ds_read_b64_tr_b16 a[212:213], v19 offset:24576
  v_mfma_f32_16x16x32_bf16 v[40:43], a[172:175], a[12:15], v[40:43]
  ds_read_b64_tr_b16 a[214:215], v19 offset:28672
  s_lshl_b32 s98, s34, 20
  s_lshl_b32 s68, s43, 18
  s_add_u32 s98, s98, s68
  v_mfma_f32_16x16x32_bf16 v[44:47], a[176:179], a[0:3], 0
  s_add_u32 m0, s64, 16384
  s_add_u32 s68, s98, 0
  buffer_load_dwordx4 v28, s[48:51], s68 offen lds
  s_add_u32 m0, s64, 17408
  v_mfma_f32_16x16x32_bf16 v[44:47], a[180:183], a[4:7], v[44:47]
  s_add_u32 s68, s98, 32768
  buffer_load_dwordx4 v28, s[48:51], s68 offen lds
  s_add_u32 m0, s64, 18432
  v_mfma_f32_16x16x32_bf16 v[44:47], a[184:187], a[8:11], v[44:47]
  s_add_u32 s68, s98, 65536
  buffer_load_dwordx4 v29, s[48:51], s68 offen lds
  s_add_u32 m0, s64, 19456
  s_add_u32 s68, s98, 98304
  v_mfma_f32_16x16x32_bf16 v[44:47], a[188:191], a[12:15], v[44:47]
  buffer_load_dwordx4 v29, s[48:51], s68 offen lds
  s_add_u32 m0, s64, 20480
  s_add_u32 s68, s98, 131072
  v_mfma_f32_16x16x32_bf16 v[48:51], a[160:163], a[16:19], 0
  v_exp_f32 v40, v40
  v_exp_f32 v41, v41
  v_exp_f32 v42, v42
  v_mfma_f32_16x16x32_bf16 v[48:51], a[164:167], a[20:23], v[48:51]
  v_exp_f32 v43, v43
  v_cvt_pk_bf16_f32 v64, v40, v41
  v_mfma_f32_16x16x32_bf16 v[48:51], a[168:171], a[24:27], v[48:51]
  v_cvt_pk_bf16_f32 v65, v42, v43
  v_exp_f32 v44, v44
  v_mfma_f32_16x16x32_bf16 v[48:51], a[172:175], a[28:31], v[48:51]
  v_exp_f32 v45, v45
  v_exp_f32 v46, v46
  v_mfma_f32_16x16x32_bf16 v[52:55], a[176:179], a[16:19], 0
  v_exp_f32 v47, v47
  v_cvt_pk_bf16_f32 v66, v44, v45
  v_cvt_pk_bf16_f32 v67, v46, v47
  v_mfma_f32_16x16x32_bf16 v[52:55], a[180:183], a[20:23], v[52:55]
  ds_read_b64_tr_b16 a[216:217], v20 offset:24576
  ds_read_b64_tr_b16 a[218:219], v20 offset:28672
  v_mfma_f32_16x16x32_bf16 v[52:55], a[184:187], a[24:27], v[52:55]
  ds_read_b64_tr_b16 a[220:221], v21 offset:24576
  ds_read_b64_tr_b16 a[222:223], v21 offset:28672
  v_mfma_f32_16x16x32_bf16 v[52:55], a[188:191], a[28:31], v[52:55]
  buffer_load_dwordx4 v28, s[48:51], s68 offen lds
  s_add_u32 m0, s64, 21504
  v_mfma_f32_16x16x32_bf16 v[56:59], a[160:163], a[32:35], 0
  v_exp_f32 v48, v48
  v_exp_f32 v49, v49
  v_mfma_f32_16x16x32_bf16 v[56:59], a[164:167], a[36:39], v[56:59]
  v_exp_f32 v50, v50
  v_exp_f32 v51, v51
  v_mfma_f32_16x16x32_bf16 v[56:59], a[168:171], a[40:43], v[56:59]
  v_cvt_pk_bf16_f32 v68, v48, v49
  v_cvt_pk_bf16_f32 v69, v50, v51
  v_mfma_f32_16x16x32_bf16 v[56:59], a[172:175], a[44:47], v[56:59]
  v_exp_f32 v52, v52
  v_exp_f32 v53, v53
  v_mfma_f32_16x16x32_bf16 v[60:63], a[176:179], a[32:35], 0
  v_exp_f32 v54, v54
  v_exp_f32 v55, v55
  v_mfma_f32_16x16x32_bf16 v[60:63], a[180:183], a[36:39], v[60:63]
  v_cvt_pk_bf16_f32 v70, v52, v53
  v_cvt_pk_bf16_f32 v71, v54, v55
  v_mfma_f32_16x16x32_bf16 v[60:63], a[184:187], a[40:43], v[60:63]
  s_add_u32 s68, s98, 163840
  buffer_load_dwordx4 v28, s[48:51], s68 offen lds
  v_mfma_f32_16x16x32_bf16 v[60:63], a[188:191], a[44:47], v[60:63]
  s_add_u32 m0, s64, 22528
  v_mfma_f32_16x16x32_bf16 v[40:43], a[160:163], a[48:51], 0
  v_exp_f32 v56, v56
  v_exp_f32 v57, v57
  v_mfma_f32_16x16x32_bf16 v[40:43], a[164:167], a[52:55], v[40:43]
  v_exp_f32 v58, v58
  v_exp_f32 v59, v59
  v_mfma_f32_16x16x32_bf16 v[40:43], a[168:171], a[56:59], v[40:43]
  v_cvt_pk_bf16_f32 v72, v56, v57
  v_cvt_pk_bf16_f32 v73, v58, v59
  v_mfma_f32_16x16x32_bf16 v[40:43], a[172:175], a[60:63], v[40:43]
  v_exp_f32 v60, v60
  v_mfma_f32_16x16x32_bf16 v[44:47], a[176:179], a[48:51], 0
  v_exp_f32 v61, v61
  v_exp_f32 v62, v62
  v_mfma_f32_16x16x32_bf16 v[44:47], a[180:183], a[52:55], v[44:47]
  v_exp_f32 v63, v63
  v_cvt_pk_bf16_f32 v74, v60, v61
  v_mfma_f32_16x16x32_bf16 v[44:47], a[184:187], a[56:59], v[44:47]
  v_cvt_pk_bf16_f32 v75, v62, v63
  s_add_u32 s68, s98, 196608
  v_mfma_f32_16x16x32_bf16 v[44:47], a[188:191], a[60:63], v[44:47]
  buffer_load_dwordx4 v29, s[48:51], s68 offen lds
  v_mfma_f32_16x16x32_bf16 v[48:51], a[160:163], a[64:67], 0
  v_exp_f32 v40, v40
  v_exp_f32 v41, v41
  v_mfma_f32_16x16x32_bf16 v[48:51], a[164:167], a[68:71], v[48:51]
  v_exp_f32 v42, v42
  v_exp_f32 v43, v43
  v_mfma_f32_16x16x32_bf16 v[48:51], a[168:171], a[72:75], v[48:51]
  v_cvt_pk_bf16_f32 v76, v40, v41
  v_cvt_pk_bf16_f32 v77, v42, v43
  v_mfma_f32_16x16x32_bf16 v[48:51], a[172:175], a[76:79], v[48:51]
  v_exp_f32 v44, v44
  v_exp_f32 v45, v45
  v_mfma_f32_16x16x32_bf16 v[52:55], a[176:179], a[64:67], 0
  v_exp_f32 v46, v46
  v_exp_f32 v47, v47
  v_mfma_f32_16x16x32_bf16 v[52:55], a[180:183], a[68:71], v[52:55]
  v_cvt_pk_bf16_f32 v78, v44, v45
  v_cvt_pk_bf16_f32 v79, v46, v47
  v_mfma_f32_16x16x32_bf16 v[52:55], a[184:187], a[72:75], v[52:55]
  s_add_u32 m0, s64, 23552
  s_add_u32 s68, s98, 229376
  v_mfma_f32_16x16x32_bf16 v[52:55], a[188:191], a[76:79], v[52:55]
  buffer_load_dwordx4 v29, s[48:51], s68 offen lds
  s_waitcnt lgkmcnt(0)
  v_mfma_f32_16x16x32_bf16 v[96:99], a[192:195], v[64:67], v[96:99]
  v_exp_f32 v48, v48
  v_exp_f32 v49, v49
  v_mfma_f32_16x16x32_bf16 v[116:119], a[196:199], v[64:67], v[116:119]
  v_exp_f32 v50, v50
  v_mfma_f32_16x16x32_bf16 v[136:139], a[200:203], v[64:67], v[136:139]
  v_exp_f32 v51, v51
  v_mfma_f32_16x16x32_bf16 v[156:159], a[204:207], v[64:67], v[156:159]
  v_cvt_pk_bf16_f32 v80, v48, v49
  v_cvt_pk_bf16_f32 v81, v50, v51
  v_mfma_f32_16x16x32_bf16 v[176:179], a[208:211], v[64:67], v[176:179]
  v_exp_f32 v52, v52
  v_mfma_f32_16x16x32_bf16 v[196:199], a[212:215], v[64:67], v[196:199]
  v_exp_f32 v53, v53
  v_mfma_f32_16x16x32_bf16 v[216:219], a[216:219], v[64:67], v[216:219]
  v_exp_f32 v54, v54
  v_exp_f32 v55, v55
  v_mfma_f32_16x16x32_bf16 v[236:239], a[220:223], v[64:67], v[236:239]
  v_cvt_pk_bf16_f32 v82, v52, v53
  v_mfma_f32_16x16x32_bf16 a[224:227], a[244:247], v[64:67], a[224:227]
  v_cvt_pk_bf16_f32 v83, v54, v55
  s_waitcnt vmcnt(8)
  v_mfma_f32_16x16x32_bf16 v[100:103], a[192:195], v[68:71], v[100:103]
  s_lshl_b32 s67, s41, 6
  v_mfma_f32_16x16x32_bf16 v[120:123], a[196:199], v[68:71], v[120:123]
  v_xor_b32 v1, s67, v10
  v_mfma_f32_16x16x32_bf16 v[140:143], a[200:203], v[68:71], v[140:143]
  s_lshl_b32 s67, s42, 6
  v_mfma_f32_16x16x32_bf16 v[160:163], a[204:207], v[68:71], v[160:163]
  v_xor_b32 v2, s67, v10
  v_mfma_f32_16x16x32_bf16 v[180:183], a[208:211], v[68:71], v[180:183]
  v_mfma_f32_16x16x32_bf16 v[200:203], a[212:215], v[68:71], v[200:203]
  s_lshl_b32 s67, s43, 6
  v_mfma_f32_16x16x32_bf16 v[220:223], a[216:219], v[68:71], v[220:223]
  v_xor_b32 v3, s67, v10
  v_mfma_f32_16x16x32_bf16 v[240:243], a[220:223], v[68:71], v[240:243]
  s_lshl_b32 s67, s3, 6
  v_mfma_f32_16x16x32_bf16 a[228:231], a[244:247], v[68:71], a[228:231]
  v_mfma_f32_16x16x32_bf16 v[104:107], a[192:195], v[72:75], v[104:107]
  v_xor_b32 v4, s67, v10
  v_mfma_f32_16x16x32_bf16 v[124:127], a[196:199], v[72:75], v[124:127]
  ds_read_b128 a[80:83], v1 offset:32768
  v_mfma_f32_16x16x32_bf16 v[144:147], a[200:203], v[72:75], v[144:147]
  ds_read_b128 a[84:87], v2 offset:32768
  v_mfma_f32_16x16x32_bf16 v[164:167], a[204:207], v[72:75], v[164:167]
  ds_read_b128 a[88:91], v3 offset:32768
  v_mfma_f32_16x16x32_bf16 v[184:187], a[208:211], v[72:75], v[184:187]
  v_mfma_f32_16x16x32_bf16 v[204:207], a[212:215], v[72:75], v[204:207]
  ds_read_b128 a[92:95], v4 offset:32768
  v_mfma_f32_16x16x32_bf16 v[224:227], a[216:219], v[72:75], v[224:227]
  ds_read_b128 a[96:99], v1 offset:36864
  v_mfma_f32_16x16x32_bf16 v[244:247], a[220:223], v[72:75], v[244:247]
  ds_read_b128 a[100:103], v2 offset:36864
  v_mfma_f32_16x16x32_bf16 a[232:235], a[244:247], v[72:75], a[232:235]
  v_mfma_f32_16x16x32_bf16 v[108:111], a[192:195], v[76:79], v[108:111]
  ds_read_b128 a[104:107], v3 offset:36864
  v_mfma_f32_16x16x32_bf16 v[128:131], a[196:199], v[76:79], v[128:131]
  ds_read_b128 a[108:111], v4 offset:36864
  v_mfma_f32_16x16x32_bf16 v[148:151], a[200:203], v[76:79], v[148:151]
  ds_read_b128 a[112:115], v1 offset:0
  v_mfma_f32_16x16x32_bf16 v[168:171], a[204:207], v[76:79], v[168:171]
  ds_read_b128 a[116:119], v2 offset:0
  v_mfma_f32_16x16x32_bf16 v[188:191], a[208:211], v[76:79], v[188:191]
  v_mfma_f32_16x16x32_bf16 v[208:211], a[212:215], v[76:79], v[208:211]
  ds_read_b128 a[120:123], v3 offset:0
  v_mfma_f32_16x16x32_bf16 v[228:231], a[216:219], v[76:79], v[228:231]
  ds_read_b128 a[124:127], v4 offset:0
  v_mfma_f32_16x16x32_bf16 v[248:251], a[220:223], v[76:79], v[248:251]
  ds_read_b128 a[128:131], v1 offset:4096
  v_mfma_f32_16x16x32_bf16 a[236:239], a[244:247], v[76:79], a[236:239]
  v_mfma_f32_16x16x32_bf16 v[112:115], a[192:195], v[80:83], v[112:115]
  ds_read_b128 a[132:135], v2 offset:4096
  ds_read_b128 a[136:139], v3 offset:4096
  ds_read_b128 a[140:143], v4 offset:4096
  ds_read_b128 a[144:147], v1 offset:8192
  v_mfma_f32_16x16x32_bf16 v[132:135], a[196:199], v[80:83], v[132:135]
  ds_read_b128 a[148:151], v2 offset:8192
  ds_read_b128 a[152:155], v3 offset:8192
  ds_read_b128 a[156:159], v4 offset:8192
  s_cmp_eq_u32 s39, 0
  v_mfma_f32_16x16x32_bf16 v[152:155], a[200:203], v[80:83], v[152:155]
  s_cselect_b32 s52, s10, s20
  s_cselect_b32 s53, s11, s21
  s_cselect_b32 s56, s12, s22
  v_mfma_f32_16x16x32_bf16 v[172:175], a[204:207], v[80:83], v[172:175]
  s_cselect_b32 s57, s13, s23
  s_lshl_b32 s65, s35, 3
  s_add_u32 s65, s65, s37
  s_lshl_b32 s66, s35, 5
  v_mfma_f32_16x16x32_bf16 v[192:195], a[208:211], v[80:83], v[192:195]
  s_add_u32 s66, s66, s36
  s_cmp_eq_u32 s39, 0
  s_cselect_b32 s65, s65, s66
  v_mfma_f32_16x16x32_bf16 v[212:215], a[212:215], v[80:83], v[212:215]
  s_lshr_b32 s66, s65, 13
  s_lshl_b32 s65, s65, 19
  s_add_u32 s52, s52, s65
  s_addc_u32 s53, s53, s66
  v_mfma_f32_16x16x32_bf16 v[232:235], a[216:219], v[80:83], v[232:235]
  s_and_b32 s53, s53, 0xffff
  s_mov_b32 s54, 524288
  s_mov_b32 s55, 0x20000
  v_mfma_f32_16x16x32_bf16 v[252:255], a[220:223], v[80:83], v[252:255]
  s_add_u32 s56, s56, s65
  s_addc_u32 s57, s57, s66
  s_and_b32 s57, s57, 0xffff
  s_mov_b32 s58, 524288
  v_mfma_f32_16x16x32_bf16 a[240:243], a[244:247], v[80:83], a[240:243]
  s_mov_b32 s59, 0x20000
  s_mov_b32 s69, s72
  s_mov_b32 s70, s72
  s_waitcnt lgkmcnt(0)
  s_add_u32 s65, s64, 24576
  v_add_u32 v8, s65, v35
  v_and_b32 v95, 15, v0
  v_lshlrev_b32 v95, 2, v95
  s_add_u32 s65, s64, 39936
  v_add_u32 v94, s65, v95
  ds_write_b32 v94, a224 offset:0
  ds_write_b32 v94, a228 offset:64
  ds_write_b32 v94, a232 offset:128
  ds_write_b32 v94, a236 offset:192
  ds_write_b32 v94, a240 offset:256
  v_cvt_pk_bf16_f32 v40, v136, v137
  v_cvt_pk_bf16_f32 v41, v138, v139
  v_cvt_pk_bf16_f32 v42, v156, v157
  v_cvt_pk_bf16_f32 v43, v158, v159
  ds_write_b128 v8, v[40:43] offset:0
  s_lshl_b32 s98, s34, 20
  s_lshl_b32 s68, s41, 18
  s_add_u32 s98, s98, s68
  v_cvt_pk_bf16_f32 v44, v140, v141
  v_cvt_pk_bf16_f32 v45, v142, v143
  v_cvt_pk_bf16_f32 v46, v160, v161
  v_cvt_pk_bf16_f32 v47, v162, v163
  ds_write_b128 v8, v[44:47] offset:1024
  s_add_u32 m0, s64, 0
  s_add_u32 s68, s98, 0
  buffer_load_dwordx4 v28, s[48:51], s68 offen lds
  s_add_u32 m0, s64, 1024
  v_cvt_pk_bf16_f32 v48, v144, v145
  v_cvt_pk_bf16_f32 v49, v146, v147
  v_cvt_pk_bf16_f32 v50, v164, v165
  v_cvt_pk_bf16_f32 v51, v166, v167
  ds_write_b128 v8, v[48:51] offset:2048
  s_add_u32 s68, s98, 32768
  buffer_load_dwordx4 v28, s[48:51], s68 offen lds
  s_add_u32 m0, s64, 2048
  v_cvt_pk_bf16_f32 v52, v148, v149
  v_cvt_pk_bf16_f32 v53, v150, v151
  v_cvt_pk_bf16_f32 v54, v168, v169
  v_cvt_pk_bf16_f32 v55, v170, v171
  ds_write_b128 v8, v[52:55] offset:3072
  s_add_u32 s68, s98, 65536
  buffer_load_dwordx4 v29, s[48:51], s68 offen lds
  s_add_u32 m0, s64, 3072
  s_add_u32 s68, s98, 98304
  v_cvt_pk_bf16_f32 v56, v152, v153
  v_cvt_pk_bf16_f32 v57, v154, v155
  v_cvt_pk_bf16_f32 v58, v172, v173
  v_cvt_pk_bf16_f32 v59, v174, v175
  ds_write_b128 v8, v[56:59] offset:4096
  buffer_load_dwordx4 v29, s[48:51], s68 offen lds
  s_add_u32 m0, s64, 4096
  s_add_u32 s68, s98, 131072
  buffer_load_dwordx4 v28, s[48:51], s68 offen lds
  v_cvt_pk_bf16_f32 v60, v176, v177
  v_cvt_pk_bf16_f32 v61, v178, v179
  v_cvt_pk_bf16_f32 v62, v196, v197
  v_cvt_pk_bf16_f32 v63, v198, v199
  ds_write_b128 v8, v[60:63] offset:5120
  s_add_u32 m0, s64, 5120
  s_add_u32 s68, s98, 163840
  buffer_load_dwordx4 v28, s[48:51], s68 offen lds
  v_cvt_pk_bf16_f32 v64, v180, v181
  v_cvt_pk_bf16_f32 v65, v182, v183
  v_cvt_pk_bf16_f32 v66, v200, v201
  v_cvt_pk_bf16_f32 v67, v202, v203
  ds_write_b128 v8, v[64:67] offset:6144
  s_add_u32 m0, s64, 6144
  s_add_u32 s68, s98, 196608
  buffer_load_dwordx4 v29, s[48:51], s68 offen lds
  s_add_u32 m0, s64, 7168
  v_cvt_pk_bf16_f32 v68, v184, v185
  v_cvt_pk_bf16_f32 v69, v186, v187
  v_cvt_pk_bf16_f32 v70, v204, v205
  v_cvt_pk_bf16_f32 v71, v206, v207
  ds_write_b128 v8, v[68:71] offset:7168
  s_add_u32 s68, s98, 229376
  buffer_load_dwordx4 v29, s[48:51], s68 offen lds
  s_lshl_b32 s98, s34, 20
  v_cvt_pk_bf16_f32 v40, v188, v189
  v_cvt_pk_bf16_f32 v41, v190, v191
  v_cvt_pk_bf16_f32 v42, v208, v209
  v_cvt_pk_bf16_f32 v43, v210, v211
  ds_write_b128 v8, v[40:43] offset:8192
  s_lshl_b32 s68, s42, 18
  s_add_u32 s98, s98, s68
  s_add_u32 m0, s64, 8192
  s_add_u32 s68, s98, 0
  v_cvt_pk_bf16_f32 v44, v192, v193
  v_cvt_pk_bf16_f32 v45, v194, v195
  v_cvt_pk_bf16_f32 v46, v212, v213
  v_cvt_pk_bf16_f32 v47, v214, v215
  ds_write_b128 v8, v[44:47] offset:9216
  buffer_load_dwordx4 v28, s[48:51], s68 offen lds
  s_add_u32 m0, s64, 9216
  s_add_u32 s68, s98, 32768
  buffer_load_dwordx4 v28, s[48:51], s68 offen lds
  v_cvt_pk_bf16_f32 v48, v216, v217
  v_cvt_pk_bf16_f32 v49, v218, v219
  v_cvt_pk_bf16_f32 v50, v236, v237
  v_cvt_pk_bf16_f32 v51, v238, v239
  ds_write_b128 v8, v[48:51] offset:10240
  s_add_u32 m0, s64, 10240
  s_add_u32 s68, s98, 65536
  buffer_load_dwordx4 v29, s[48:51], s68 offen lds
  v_cvt_pk_bf16_f32 v52, v220, v221
  v_cvt_pk_bf16_f32 v53, v222, v223
  v_cvt_pk_bf16_f32 v54, v240, v241
  v_cvt_pk_bf16_f32 v55, v242, v243
  ds_write_b128 v8, v[52:55] offset:11264
  s_add_u32 m0, s64, 11264
  s_add_u32 s68, s98, 98304
  buffer_load_dwordx4 v29, s[48:51], s68 offen lds
  s_add_u32 m0, s64, 12288
  v_cvt_pk_bf16_f32 v56, v224, v225
  v_cvt_pk_bf16_f32 v57, v226, v227
  v_cvt_pk_bf16_f32 v58, v244, v245
  v_cvt_pk_bf16_f32 v59, v246, v247
  ds_write_b128 v8, v[56:59] offset:12288
  s_add_u32 s68, s98, 131072
  buffer_load_dwordx4 v28, s[48:51], s68 offen lds
  s_add_u32 m0, s64, 13312
  v_cvt_pk_bf16_f32 v60, v228, v229
  v_cvt_pk_bf16_f32 v61, v230, v231
  v_cvt_pk_bf16_f32 v62, v248, v249
  v_cvt_pk_bf16_f32 v63, v250, v251
  ds_write_b128 v8, v[60:63] offset:13312
  s_add_u32 s68, s98, 163840
  buffer_load_dwordx4 v28, s[48:51], s68 offen lds
  s_add_u32 m0, s64, 14336
  s_add_u32 s68, s98, 196608
  v_cvt_pk_bf16_f32 v64, v232, v233
  v_cvt_pk_bf16_f32 v65, v234, v235
  v_cvt_pk_bf16_f32 v66, v252, v253
  v_cvt_pk_bf16_f32 v67, v254, v255
  ds_write_b128 v8, v[64:67] offset:14336
  buffer_load_dwordx4 v29, s[48:51], s68 offen lds
  s_add_u32 m0, s64, 15360
  s_add_u32 s68, s98, 229376
  buffer_load_dwordx4 v29, s[48:51], s68 offen lds
  s_sub_u32 s65, s34, 1
  s_and_b32 s65, s65, 3
  s_mul_i32 s65, s65, 40960
  s_add_u32 s65, s65, 24576
  v_add_u32 v1, s65, v35
  s_sub_u32 s65, s34, 2
  s_and_b32 s65, s65, 3
  s_mul_i32 s65, s65, 40960
  s_add_u32 s65, s65, 29696
  v_add_u32 v8, s65, v35
  s_sub_u32 s65, s34, 3
  s_and_b32 s65, s65, 3
  s_mul_i32 s65, s65, 40960
  s_add_u32 s65, s65, 34816
  v_add_u32 v9, s65, v35
  v_mov_b32 v2, 0
  v_mov_b32 v3, 0
  v_accvgpr_read_b32 v4, a248
  v_accvgpr_read_b32 v5, a249
  v_mov_b32 v6, 0
  v_mov_b32 v7, 0
  s_waitcnt lgkmcnt(0)
  s_barrier
  ds_read_b128 a[160:163], v1 offset:0
  ds_read_b128 a[164:167], v1 offset:1024
  ds_read_b128 a[168:171], v1 offset:2048
  ds_read_b128 a[172:175], v1 offset:3072
  ds_read_b128 a[176:179], v1 offset:4096
  ds_read_b128 a[180:183], v8 offset:0
  ds_read_b128 a[184:187], v8 offset:1024
  ds_read_b128 a[188:191], v8 offset:2048
  ds_read_b128 a[192:195], v8 offset:3072
  ds_read_b128 a[196:199], v8 offset:4096
  ds_read_b128 a[200:203], v9 offset:0
  ds_read_b128 a[204:207], v9 offset:1024
  ds_read_b128 a[208:211], v9 offset:2048
  ds_read_b128 a[212:215], v9 offset:3072
  ds_read_b128 a[216:219], v9 offset:4096
  s_waitcnt lgkmcnt(10)
  v_mfma_f32_16x16x32_bf16 v[96:99], v[4:7], a[160:163], v[96:99]
  v_mfma_f32_16x16x32_bf16 v[116:119], v[2:5], a[160:163], v[116:119]
  v_mfma_f32_16x16x32_bf16 v[100:103], v[4:7], a[164:167], v[100:103]
  v_mfma_f32_16x16x32_bf16 v[120:123], v[2:5], a[164:167], v[120:123]
  v_mfma_f32_16x16x32_bf16 v[104:107], v[4:7], a[168:171], v[104:107]
  v_mfma_f32_16x16x32_bf16 v[124:127], v[2:5], a[168:171], v[124:127]
  v_mfma_f32_16x16x32_bf16 v[108:111], v[4:7], a[172:175], v[108:111]
  v_mfma_f32_16x16x32_bf16 v[128:131], v[2:5], a[172:175], v[128:131]
  v_mfma_f32_16x16x32_bf16 v[112:115], v[4:7], a[176:179], v[112:115]
  v_mfma_f32_16x16x32_bf16 v[132:135], v[2:5], a[176:179], v[132:135]
  s_waitcnt lgkmcnt(5)
  v_mfma_f32_16x16x32_bf16 v[96:99], v[4:7], a[180:183], v[96:99]
  v_mfma_f32_16x16x32_bf16 v[116:119], v[2:5], a[180:183], v[116:119]
  v_mfma_f32_16x16x32_bf16 v[100:103], v[4:7], a[184:187], v[100:103]
  v_mfma_f32_16x16x32_bf16 v[120:123], v[2:5], a[184:187], v[120:123]
  v_mfma_f32_16x16x32_bf16 v[104:107], v[4:7], a[188:191], v[104:107]
  v_mfma_f32_16x16x32_bf16 v[124:127], v[2:5], a[188:191], v[124:127]
  v_mfma_f32_16x16x32_bf16 v[108:111], v[4:7], a[192:195], v[108:111]
  v_mfma_f32_16x16x32_bf16 v[128:131], v[2:5], a[192:195], v[128:131]
  v_mfma_f32_16x16x32_bf16 v[112:115], v[4:7], a[196:199], v[112:115]
  v_mfma_f32_16x16x32_bf16 v[132:135], v[2:5], a[196:199], v[132:135]
  s_waitcnt lgkmcnt(0)
  v_add_u32 v95, 39936, v95
  ds_read_b32 v64, v95 offset:0
  ds_read_b32 v65, v95 offset:64
  ds_read_b32 v66, v95 offset:128
  ds_read_b32 v67, v95 offset:192
  ds_read_b32 v68, v95 offset:256
  v_add_u32 v95, 40960, v95
  ds_read_b32 v69, v95 offset:0
  ds_read_b32 v70, v95 offset:64
  ds_read_b32 v71, v95 offset:128
  ds_read_b32 v72, v95 offset:192
  ds_read_b32 v73, v95 offset:256
  v_add_u32 v95, 40960, v95
  ds_read_b32 v74, v95 offset:0
  ds_read_b32 v75, v95 offset:64
  ds_read_b32 v76, v95 offset:128
  ds_read_b32 v77, v95 offset:192
  ds_read_b32 v78, v95 offset:256
  v_add_u32 v95, 40960, v95
  ds_read_b32 v79, v95 offset:0
  ds_read_b32 v80, v95 offset:64
  ds_read_b32 v81, v95 offset:128
  ds_read_b32 v82, v95 offset:192
  ds_read_b32 v83, v95 offset:256
  v_mfma_f32_16x16x32_bf16 v[96:99], v[4:7], a[200:203], v[96:99]
  v_mfma_f32_16x16x32_bf16 v[116:119], v[2:5], a[200:203], v[116:119]
  v_mfma_f32_16x16x32_bf16 v[100:103], v[4:7], a[204:207], v[100:103]
  v_mfma_f32_16x16x32_bf16 v[120:123], v[2:5], a[204:207], v[120:123]
  v_mfma_f32_16x16x32_bf16 v[104:107], v[4:7], a[208:211], v[104:107]
  v_mfma_f32_16x16x32_bf16 v[124:127], v[2:5], a[208:211], v[124:127]
  v_mfma_f32_16x16x32_bf16 v[108:111], v[4:7], a[212:215], v[108:111]
  v_mfma_f32_16x16x32_bf16 v[128:131], v[2:5], a[212:215], v[128:131]
  v_mfma_f32_16x16x32_bf16 v[112:115], v[4:7], a[216:219], v[112:115]
  v_mfma_f32_16x16x32_bf16 v[132:135], v[2:5], a[216:219], v[132:135]
  s_waitcnt lgkmcnt(0)
  v_add_f32 v64, v64, v69
  v_add_f32 v74, v74, v79
  v_add_f32 v65, v65, v70
  v_add_f32 v75, v75, v80
  v_add_f32 v66, v66, v71
  v_add_f32 v76, v76, v81
  v_add_f32 v67, v67, v72
  v_add_f32 v77, v77, v82
  v_add_f32 v68, v68, v73
  v_add_f32 v78, v78, v83
  v_add_f32 v84, v64, v74
  v_add_f32 v85, v65, v75
  v_add_f32 v86, v66, v76
  v_add_f32 v87, v67, v77
  v_add_f32 v88, v68, v78
  v_max3_f32 v1, v84, v85, v86
  v_min3_f32 v2, v84, v85, v86
  v_max3_f32 v1, v1, v87, v88
  v_min3_f32 v2, v2, v87, v88
  s_mov_b32 s65, 0x5d800000
  s_mov_b32 s66, 0x21800000
  v_cmp_nge_f32 vcc, s65, v1
  v_cmp_nle_f32 s[0:1], s66, v2
  v_rcp_f32 v84, v84
  v_rcp_f32 v85, v85
  v_rcp_f32 v86, v86
  v_rcp_f32 v87, v87
  v_rcp_f32 v88, v88
  s_nop 0
  v_mul_f32 v96, v84, v96
  v_mul_f32 v97, v84, v97
  v_mul_f32 v98, v84, v98
  v_mul_f32 v99, v84, v99
  v_mul_f32 v116, v84, v116
  v_mul_f32 v117, v84, v117
  v_mul_f32 v118, v84, v118
  v_mul_f32 v119, v84, v119
  v_mul_f32 v100, v85, v100
  v_mul_f32 v101, v85, v101
  v_mul_f32 v102, v85, v102
  v_mul_f32 v103, v85, v103
  v_mul_f32 v120, v85, v120
  v_mul_f32 v121, v85, v121
  v_mul_f32 v122, v85, v122
  v_mul_f32 v123, v85, v123
  v_mul_f32 v104, v86, v104
  v_mul_f32 v105, v86, v105
  v_mul_f32 v106, v86, v106
  v_mul_f32 v107, v86, v107
  v_mul_f32 v124, v86, v124
  v_mul_f32 v125, v86, v125
  v_mul_f32 v126, v86, v126
  v_mul_f32 v127, v86, v127
  v_mul_f32 v108, v87, v108
  v_mul_f32 v109, v87, v109
  v_mul_f32 v110, v87, v110
  v_mul_f32 v111, v87, v111
  v_mul_f32 v128, v87, v128
  v_mul_f32 v129, v87, v129
  v_mul_f32 v130, v87, v130
  v_mul_f32 v131, v87, v131
  v_mul_f32 v112, v88, v112
  v_mul_f32 v113, v88, v113
  v_mul_f32 v114, v88, v114
  v_mul_f32 v115, v88, v115
  v_mul_f32 v132, v88, v132
  v_mul_f32 v133, v88, v133
  v_mul_f32 v134, v88, v134
  v_mul_f32 v135, v88, v135
  v_cvt_pk_bf16_f32 v64, v96, v97
  v_cvt_pk_bf16_f32 v65, v98, v99
  v_cvt_pk_bf16_f32 v66, v116, v117
  v_cvt_pk_bf16_f32 v67, v118, v119
  v_cvt_pk_bf16_f32 v68, v100, v101
  v_cvt_pk_bf16_f32 v69, v102, v103
  v_cvt_pk_bf16_f32 v70, v120, v121
  v_cvt_pk_bf16_f32 v71, v122, v123
  v_cvt_pk_bf16_f32 v72, v104, v105
  v_cvt_pk_bf16_f32 v73, v106, v107
  v_cvt_pk_bf16_f32 v74, v124, v125
  v_cvt_pk_bf16_f32 v75, v126, v127
  v_cvt_pk_bf16_f32 v76, v108, v109
  v_cvt_pk_bf16_f32 v77, v110, v111
  v_cvt_pk_bf16_f32 v78, v128, v129
  v_cvt_pk_bf16_f32 v79, v130, v131
  v_cvt_pk_bf16_f32 v80, v112, v113
  v_cvt_pk_bf16_f32 v81, v114, v115
  v_cvt_pk_bf16_f32 v82, v132, v133
  v_cvt_pk_bf16_f32 v83, v134, v135
  s_mul_i32 s65, s34, 5120
  buffer_store_dwordx4 v[64:67], v35, s[60:63], s65 offen offset:0 sc1
  buffer_store_dwordx4 v[68:71], v35, s[60:63], s65 offen offset:1024 sc1
  buffer_store_dwordx4 v[72:75], v35, s[60:63], s65 offen offset:2048 sc1
  buffer_store_dwordx4 v[76:79], v35, s[60:63], s65 offen offset:3072 sc1
  s_add_u32 s65, s65, 4096
  buffer_store_dwordx4 v[80:83], v35, s[60:63], s65 offen sc1
  v_mov_b32 v4, 0
  v_mov_b32 v5, 0
  v_mov_b32 v6, 0
  v_mov_b32 v7, 0
  s_or_b64 s[0:1], s[0:1], vcc
  s_nop 0
  v_mfma_f32_16x16x32_bf16 v[40:43], v[4:7], v[64:67], 0
  v_mfma_f32_16x16x32_bf16 v[40:43], v[4:7], v[68:71], v[40:43]
  v_mfma_f32_16x16x32_bf16 v[40:43], v[4:7], v[72:75], v[40:43]
  v_mfma_f32_16x16x32_bf16 v[40:43], v[4:7], v[76:79], v[40:43]
  v_mfma_f32_16x16x32_bf16 v[40:43], v[4:7], v[80:83], v[40:43]
  s_add_u32 s65, s64, 40704
  v_mov_b32 v2, s65
  s_nop 7
  v_cmp_u_f32 vcc, v40, v40
  s_nop 1
  s_or_b64 vcc, vcc, s[0:1]
  s_cmp_lg_u64 vcc, 0
  s_cselect_b32 s65, 1, 0
  v_mov_b32 v3, s65
  ds_write_b32 v2, v3
  s_waitcnt lgkmcnt(0)
  s_barrier
  v_and_b32 v2, 3, v0
  v_mul_u32_u24 v2, 40960, v2
  v_add_u32 v2, 40704, v2
  ds_read_b32 v3, v2
  s_waitcnt lgkmcnt(0)
  v_cmp_ne_u32 vcc, 0, v3
  s_nop 1
  s_cbranch_vccz L_ok_9
  s_mov_b32 s2, s40
  s_call_b64 s[92:93], L_fb
L_ok_9:
  s_add_u32 s60, s30, 0
  s_addc_u32 s61, s31, 0
  s_and_b32 s61, s61, 0xffff
  s_mov_b32 s62, 256
  s_mov_b32 s63, 0x20000
  buffer_load_dword v9, off, s[60:63], 0 sc1
  s_lshl_b32 s98, s34, 20
  s_lshl_b32 s68, s3, 18
  s_add_u32 s98, s98, s68
  s_add_u32 m0, s64, 24576
  s_add_u32 s68, s98, 0
  buffer_load_dwordx4 v28, s[48:51], s68 offen lds
  s_add_u32 m0, s64, 25600
  s_add_u32 s68, s98, 32768
  buffer_load_dwordx4 v28, s[48:51], s68 offen lds
  s_add_u32 m0, s64, 26624
  s_add_u32 s68, s98, 65536
  buffer_load_dwordx4 v29, s[48:51], s68 offen lds
  s_add_u32 m0, s64, 27648
  s_add_u32 s68, s98, 98304
  buffer_load_dwordx4 v29, s[48:51], s68 offen lds
  s_add_u32 m0, s64, 28672
  s_add_u32 s68, s98, 131072
  buffer_load_dwordx4 v28, s[48:51], s68 offen lds
  s_add_u32 m0, s64, 29696
  s_add_u32 s68, s98, 163840
  buffer_load_dwordx4 v28, s[48:51], s68 offen lds
  s_add_u32 m0, s64, 30720
  s_add_u32 s68, s98, 196608
  buffer_load_dwordx4 v29, s[48:51], s68 offen lds
  s_add_u32 m0, s64, 31744
  s_add_u32 s68, s98, 229376
  buffer_load_dwordx4 v29, s[48:51], s68 offen lds
  s_waitcnt vmcnt(22)
  ds_read_b64_tr_b16 a[192:193], v30 offset:0
  ds_read_b64_tr_b16 a[194:195], v30 offset:1024
  ds_read_b64_tr_b16 a[196:197], v30 offset:8
  ds_read_b64_tr_b16 a[198:199], v30 offset:1032
  ds_read_b64_tr_b16 a[200:201], v31 offset:0
  ds_read_b64_tr_b16 a[202:203], v31 offset:1024
  ds_read_b64_tr_b16 a[204:205], v31 offset:8
  ds_read_b64_tr_b16 a[206:207], v31 offset:1032
  ds_read_b64_tr_b16 a[208:209], v32 offset:0
  ds_read_b64_tr_b16 a[210:211], v32 offset:1024
  ds_read_b64_tr_b16 a[212:213], v32 offset:8
  ds_read_b64_tr_b16 a[214:215], v32 offset:1032
  ds_read_b64_tr_b16 a[216:217], v33 offset:0
  ds_read_b64_tr_b16 a[218:219], v33 offset:1024
  ds_read_b64_tr_b16 a[220:221], v33 offset:8
  ds_read_b64_tr_b16 a[222:223], v33 offset:1032
  s_waitcnt lgkmcnt(0)
  v_mfma_f32_16x16x32_bf16 v[96:99], a[192:195], a[80:83], 0
  v_mfma_f32_16x16x32_bf16 v[100:103], a[192:195], a[96:99], 0
  v_mfma_f32_16x16x32_bf16 v[104:107], a[192:195], a[112:115], 0
  v_mfma_f32_16x16x32_bf16 v[108:111], a[192:195], a[128:131], 0
  v_mfma_f32_16x16x32_bf16 v[112:115], a[192:195], a[144:147], 0
  v_mfma_f32_16x16x32_bf16 v[116:119], a[196:199], a[80:83], 0
  v_mfma_f32_16x16x32_bf16 v[120:123], a[196:199], a[96:99], 0
  v_mfma_f32_16x16x32_bf16 v[124:127], a[196:199], a[112:115], 0
  v_mfma_f32_16x16x32_bf16 v[128:131], a[196:199], a[128:131], 0
  v_mfma_f32_16x16x32_bf16 v[132:135], a[196:199], a[144:147], 0
  v_mfma_f32_16x16x32_bf16 v[136:139], a[200:203], a[80:83], 0
  v_mfma_f32_16x16x32_bf16 v[140:143], a[200:203], a[96:99], 0
  v_mfma_f32_16x16x32_bf16 v[144:147], a[200:203], a[112:115], 0
  v_mfma_f32_16x16x32_bf16 v[148:151], a[200:203], a[128:131], 0
  v_mfma_f32_16x16x32_bf16 v[152:155], a[200:203], a[144:147], 0
  v_mfma_f32_16x16x32_bf16 v[156:159], a[204:207], a[80:83], 0
  v_mfma_f32_16x16x32_bf16 v[160:163], a[204:207], a[96:99], 0
  v_mfma_f32_16x16x32_bf16 v[164:167], a[204:207], a[112:115], 0
  v_mfma_f32_16x16x32_bf16 v[168:171], a[204:207], a[128:131], 0
  v_mfma_f32_16x16x32_bf16 v[172:175], a[204:207], a[144:147], 0
  s_waitcnt vmcnt(14)
  v_mfma_f32_16x16x32_bf16 v[176:179], a[208:211], a[80:83], 0
  ds_read_b64_tr_b16 a[160:161], v30 offset:8192
  v_mfma_f32_16x16x32_bf16 v[180:183], a[208:211], a[96:99], 0
  ds_read_b64_tr_b16 a[162:163], v30 offset:9216
  v_mfma_f32_16x16x32_bf16 v[184:187], a[208:211], a[112:115], 0
  ds_read_b64_tr_b16 a[164:165], v30 offset:8200
  v_mfma_f32_16x16x32_bf16 v[188:191], a[208:211], a[128:131], 0
  ds_read_b64_tr_b16 a[166:167], v30 offset:9224
  v_mfma_f32_16x16x32_bf16 v[192:195], a[208:211], a[144:147], 0
  v_mfma_f32_16x16x32_bf16 v[196:199], a[212:215], a[80:83], 0
  ds_read_b64_tr_b16 a[168:169], v31 offset:8192
  v_mfma_f32_16x16x32_bf16 v[200:203], a[212:215], a[96:99], 0
  ds_read_b64_tr_b16 a[170:171], v31 offset:9216
  v_mfma_f32_16x16x32_bf16 v[204:207], a[212:215], a[112:115], 0
  ds_read_b64_tr_b16 a[172:173], v31 offset:8200
  v_mfma_f32_16x16x32_bf16 v[208:211], a[212:215], a[128:131], 0
  ds_read_b64_tr_b16 a[174:175], v31 offset:9224
  v_mfma_f32_16x16x32_bf16 v[212:215], a[212:215], a[144:147], 0
  v_mfma_f32_16x16x32_bf16 v[216:219], a[216:219], a[80:83], 0
  ds_read_b64_tr_b16 a[176:177], v32 offset:8192
  v_mfma_f32_16x16x32_bf16 v[220:223], a[216:219], a[96:99], 0
  ds_read_b64_tr_b16 a[178:179], v32 offset:9216
  v_mfma_f32_16x16x32_bf16 v[224:227], a[216:219], a[112:115], 0
  ds_read_b64_tr_b16 a[180:181], v32 offset:8200
  v_mfma_f32_16x16x32_bf16 v[228:231], a[216:219], a[128:131], 0
  ds_read_b64_tr_b16 a[182:183], v32 offset:9224
  v_mfma_f32_16x16x32_bf16 v[232:235], a[216:219], a[144:147], 0
  v_mfma_f32_16x16x32_bf16 v[236:239], a[220:223], a[80:83], 0
  ds_read_b64_tr_b16 a[184:185], v33 offset:8192
  v_mfma_f32_16x16x32_bf16 v[240:243], a[220:223], a[96:99], 0
  ds_read_b64_tr_b16 a[186:187], v33 offset:9216
  v_mfma_f32_16x16x32_bf16 v[244:247], a[220:223], a[112:115], 0
  ds_read_b64_tr_b16 a[188:189], v33 offset:8200
  v_mfma_f32_16x16x32_bf16 v[248:251], a[220:223], a[128:131], 0
  ds_read_b64_tr_b16 a[190:191], v33 offset:9224
  v_mfma_f32_16x16x32_bf16 v[252:255], a[220:223], a[144:147], 0
  s_waitcnt lgkmcnt(0)
  v_mfma_f32_16x16x32_bf16 v[96:99], a[160:163], a[84:87], v[96:99]
  s_add_u32 m0, s64, 0
  v_mfma_f32_16x16x32_bf16 v[100:103], a[160:163], a[100:103], v[100:103]
  s_add_u32 s65, s69, 0
  v_mfma_f32_16x16x32_bf16 v[104:107], a[160:163], a[116:119], v[104:107]
  v_mfma_f32_16x16x32_bf16 v[108:111], a[160:163], a[132:135], v[108:111]
  buffer_load_dwordx4 v22, s[52:55], s65 offen offset:0 lds
  v_mfma_f32_16x16x32_bf16 v[112:115], a[160:163], a[148:151], v[112:115]
  buffer_load_dwordx4 v23, s[52:55], s65 offen offset:1024 lds
  v_mfma_f32_16x16x32_bf16 v[116:119], a[164:167], a[84:87], v[116:119]
  v_mfma_f32_16x16x32_bf16 v[120:123], a[164:167], a[100:103], v[120:123]
  buffer_load_dwordx4 v24, s[52:55], s65 offen offset:2048 lds
  v_mfma_f32_16x16x32_bf16 v[124:127], a[164:167], a[116:119], v[124:127]
  buffer_load_dwordx4 v25, s[52:55], s65 offen offset:3072 lds
  v_mfma_f32_16x16x32_bf16 v[128:131], a[164:167], a[132:135], v[128:131]
  v_mfma_f32_16x16x32_bf16 v[132:135], a[164:167], a[148:151], v[132:135]
  s_add_u32 m0, s64, 4096
  v_mfma_f32_16x16x32_bf16 v[136:139], a[168:171], a[84:87], v[136:139]
  s_add_u32 s65, s69, 4096
  v_mfma_f32_16x16x32_bf16 v[140:143], a[168:171], a[100:103], v[140:143]
  v_mfma_f32_16x16x32_bf16 v[144:147], a[168:171], a[116:119], v[144:147]
  buffer_load_dwordx4 v22, s[52:55], s65 offen offset:0 lds
  v_mfma_f32_16x16x32_bf16 v[148:151], a[168:171], a[132:135], v[148:151]
  buffer_load_dwordx4 v23, s[52:55], s65 offen offset:1024 lds
  v_mfma_f32_16x16x32_bf16 v[152:155], a[168:171], a[148:151], v[152:155]
  v_mfma_f32_16x16x32_bf16 v[156:159], a[172:175], a[84:87], v[156:159]
  buffer_load_dwordx4 v24, s[52:55], s65 offen offset:2048 lds
  v_mfma_f32_16x16x32_bf16 v[160:163], a[172:175], a[100:103], v[160:163]
  buffer_load_dwordx4 v25, s[52:55], s65 offen offset:3072 lds
  v_mfma_f32_16x16x32_bf16 v[164:167], a[172:175], a[116:119], v[164:167]
  v_mfma_f32_16x16x32_bf16 v[168:171], a[172:175], a[132:135], v[168:171]
  s_add_u32 s69, s69, 32768
  v_mfma_f32_16x16x32_bf16 v[172:175], a[172:175], a[148:151], v[172:175]
  s_waitcnt vmcnt(63)
  v_mfma_f32_16x16x32_bf16 v[176:179], a[176:179], a[84:87], v[176:179]
  ds_read_b64_tr_b16 a[192:193], v30 offset:16384
  v_mfma_f32_16x16x32_bf16 v[180:183], a[176:179], a[100:103], v[180:183]
  ds_read_b64_tr_b16 a[194:195], v30 offset:17408
  v_mfma_f32_16x16x32_bf16 v[184:187], a[176:179], a[116:119], v[184:187]
  ds_read_b64_tr_b16 a[196:197], v30 offset:16392
  v_mfma_f32_16x16x32_bf16 v[188:191], a[176:179], a[132:135], v[188:191]
  ds_read_b64_tr_b16 a[198:199], v30 offset:17416
  v_mfma_f32_16x16x32_bf16 v[192:195], a[176:179], a[148:151], v[192:195]
  v_mfma_f32_16x16x32_bf16 v[196:199], a[180:183], a[84:87], v[196:199]
  ds_read_b64_tr_b16 a[200:201], v31 offset:16384
  v_mfma_f32_16x16x32_bf16 v[200:203], a[180:183], a[100:103], v[200:203]
  ds_read_b64_tr_b16 a[202:203], v31 offset:17408
  v_mfma_f32_16x16x32_bf16 v[204:207], a[180:183], a[116:119], v[204:207]
  ds_read_b64_tr_b16 a[204:205], v31 offset:16392
  v_mfma_f32_16x16x32_bf16 v[208:211], a[180:183], a[132:135], v[208:211]
  ds_read_b64_tr_b16 a[206:207], v31 offset:17416
  v_mfma_f32_16x16x32_bf16 v[212:215], a[180:183], a[148:151], v[212:215]
  v_mfma_f32_16x16x32_bf16 v[216:219], a[184:187], a[84:87], v[216:219]
  ds_read_b64_tr_b16 a[208:209], v32 offset:16384
  v_mfma_f32_16x16x32_bf16 v[220:223], a[184:187], a[100:103], v[220:223]
  ds_read_b64_tr_b16 a[210:211], v32 offset:17408
  v_mfma_f32_16x16x32_bf16 v[224:227], a[184:187], a[116:119], v[224:227]
  ds_read_b64_tr_b16 a[212:213], v32 offset:16392
  v_mfma_f32_16x16x32_bf16 v[228:231], a[184:187], a[132:135], v[228:231]
  ds_read_b64_tr_b16 a[214:215], v32 offset:17416
  v_mfma_f32_16x16x32_bf16 v[232:235], a[184:187], a[148:151], v[232:235]
  v_mfma_f32_16x16x32_bf16 v[236:239], a[188:191], a[84:87], v[236:239]
  ds_read_b64_tr_b16 a[216:217], v33 offset:16384
  v_mfma_f32_16x16x32_bf16 v[240:243], a[188:191], a[100:103], v[240:243]
  ds_read_b64_tr_b16 a[218:219], v33 offset:17408
  v_mfma_f32_16x16x32_bf16 v[244:247], a[188:191], a[116:119], v[244:247]
  ds_read_b64_tr_b16 a[220:221], v33 offset:16392
  v_mfma_f32_16x16x32_bf16 v[248:251], a[188:191], a[132:135], v[248:251]
  ds_read_b64_tr_b16 a[222:223], v33 offset:17416
  v_mfma_f32_16x16x32_bf16 v[252:255], a[188:191], a[148:151], v[252:255]
  s_waitcnt lgkmcnt(0)
  v_mfma_f32_16x16x32_bf16 v[96:99], a[192:195], a[88:91], v[96:99]
  s_add_u32 m0, s64, 8192
  v_mfma_f32_16x16x32_bf16 v[100:103], a[192:195], a[104:107], v[100:103]
  s_add_u32 s66, s70, 0
  v_mfma_f32_16x16x32_bf16 v[104:107], a[192:195], a[120:123], v[104:107]
  v_mfma_f32_16x16x32_bf16 v[108:111], a[192:195], a[136:139], v[108:111]
  buffer_load_dwordx4 v26, s[56:59], s66 offen offset:0 lds
  v_mfma_f32_16x16x32_bf16 v[112:115], a[192:195], a[152:155], v[112:115]
  buffer_load_dwordx4 v27, s[56:59], s66 offen offset:1024 lds
  v_mfma_f32_16x16x32_bf16 v[116:119], a[196:199], a[88:91], v[116:119]
  v_mfma_f32_16x16x32_bf16 v[120:123], a[196:199], a[104:107], v[120:123]
  buffer_load_dwordx4 v26, s[56:59], s66 offen offset:2048 lds
  v_mfma_f32_16x16x32_bf16 v[124:127], a[196:199], a[120:123], v[124:127]
  buffer_load_dwordx4 v27, s[56:59], s66 offen offset:3072 lds
  v_mfma_f32_16x16x32_bf16 v[128:131], a[196:199], a[136:139], v[128:131]
  v_mfma_f32_16x16x32_bf16 v[132:135], a[196:199], a[152:155], v[132:135]
  s_add_u32 m0, s64, 12288
  v_mfma_f32_16x16x32_bf16 v[136:139], a[200:203], a[88:91], v[136:139]
  s_add_u32 s66, s70, 4096
  v_mfma_f32_16x16x32_bf16 v[140:143], a[200:203], a[104:107], v[140:143]
  v_mfma_f32_16x16x32_bf16 v[144:147], a[200:203], a[120:123], v[144:147]
  buffer_load_dwordx4 v26, s[56:59], s66 offen offset:0 lds
  v_mfma_f32_16x16x32_bf16 v[148:151], a[200:203], a[136:139], v[148:151]
  buffer_load_dwordx4 v27, s[56:59], s66 offen offset:1024 lds
  v_mfma_f32_16x16x32_bf16 v[152:155], a[200:203], a[152:155], v[152:155]
  v_mfma_f32_16x16x32_bf16 v[156:159], a[204:207], a[88:91], v[156:159]
  buffer_load_dwordx4 v26, s[56:59], s66 offen offset:2048 lds
  v_mfma_f32_16x16x32_bf16 v[160:163], a[204:207], a[104:107], v[160:163]
  buffer_load_dwordx4 v27, s[56:59], s66 offen offset:3072 lds
  v_mfma_f32_16x16x32_bf16 v[164:167], a[204:207], a[120:123], v[164:167]
  v_mfma_f32_16x16x32_bf16 v[168:171], a[204:207], a[136:139], v[168:171]
  s_add_u32 s70, s70, 32768
  v_mfma_f32_16x16x32_bf16 v[172:175], a[204:207], a[152:155], v[172:175]
  s_waitcnt vmcnt(16)
  v_mfma_f32_16x16x32_bf16 v[176:179], a[208:211], a[88:91], v[176:179]
  ds_read_b64_tr_b16 a[160:161], v30 offset:24576
  v_mfma_f32_16x16x32_bf16 v[180:183], a[208:211], a[104:107], v[180:183]
  ds_read_b64_tr_b16 a[162:163], v30 offset:25600
  v_mfma_f32_16x16x32_bf16 v[184:187], a[208:211], a[120:123], v[184:187]
  ds_read_b64_tr_b16 a[164:165], v30 offset:24584
  v_mfma_f32_16x16x32_bf16 v[188:191], a[208:211], a[136:139], v[188:191]
  ds_read_b64_tr_b16 a[166:167], v30 offset:25608
  v_mfma_f32_16x16x32_bf16 v[192:195], a[208:211], a[152:155], v[192:195]
  v_mfma_f32_16x16x32_bf16 v[196:199], a[212:215], a[88:91], v[196:199]
  ds_read_b64_tr_b16 a[168:169], v31 offset:24576
  v_mfma_f32_16x16x32_bf16 v[200:203], a[212:215], a[104:107], v[200:203]
  ds_read_b64_tr_b16 a[170:171], v31 offset:25600
  v_mfma_f32_16x16x32_bf16 v[204:207], a[212:215], a[120:123], v[204:207]
  ds_read_b64_tr_b16 a[172:173], v31 offset:24584
  v_mfma_f32_16x16x32_bf16 v[208:211], a[212:215], a[136:139], v[208:211]
  ds_read_b64_tr_b16 a[174:175], v31 offset:25608
  v_mfma_f32_16x16x32_bf16 v[212:215], a[212:215], a[152:155], v[212:215]
  v_mfma_f32_16x16x32_bf16 v[216:219], a[216:219], a[88:91], v[216:219]
  ds_read_b64_tr_b16 a[176:177], v32 offset:24576
  v_mfma_f32_16x16x32_bf16 v[220:223], a[216:219], a[104:107], v[220:223]
  ds_read_b64_tr_b16 a[178:179], v32 offset:25600
  v_mfma_f32_16x16x32_bf16 v[224:227], a[216:219], a[120:123], v[224:227]
  ds_read_b64_tr_b16 a[180:181], v32 offset:24584
  v_mfma_f32_16x16x32_bf16 v[228:231], a[216:219], a[136:139], v[228:231]
  ds_read_b64_tr_b16 a[182:183], v32 offset:25608
  v_mfma_f32_16x16x32_bf16 v[232:235], a[216:219], a[152:155], v[232:235]
  v_mfma_f32_16x16x32_bf16 v[236:239], a[220:223], a[88:91], v[236:239]
  ds_read_b64_tr_b16 a[184:185], v33 offset:24576
  v_mfma_f32_16x16x32_bf16 v[240:243], a[220:223], a[104:107], v[240:243]
  ds_read_b64_tr_b16 a[186:187], v33 offset:25600
  v_mfma_f32_16x16x32_bf16 v[244:247], a[220:223], a[120:123], v[244:247]
  ds_read_b64_tr_b16 a[188:189], v33 offset:24584
  v_mfma_f32_16x16x32_bf16 v[248:251], a[220:223], a[136:139], v[248:251]
  ds_read_b64_tr_b16 a[190:191], v33 offset:25608
  v_mfma_f32_16x16x32_bf16 v[252:255], a[220:223], a[152:155], v[252:255]
  s_waitcnt lgkmcnt(0)
  v_mfma_f32_16x16x32_bf16 v[96:99], a[160:163], a[92:95], v[96:99]
  v_mfma_f32_16x16x32_bf16 v[100:103], a[160:163], a[108:111], v[100:103]
  v_mfma_f32_16x16x32_bf16 v[104:107], a[160:163], a[124:127], v[104:107]
  v_mfma_f32_16x16x32_bf16 v[108:111], a[160:163], a[140:143], v[108:111]
  v_mfma_f32_16x16x32_bf16 v[112:115], a[160:163], a[156:159], v[112:115]
  v_mfma_f32_16x16x32_bf16 v[116:119], a[164:167], a[92:95], v[116:119]
  v_mfma_f32_16x16x32_bf16 v[120:123], a[164:167], a[108:111], v[120:123]
  v_mfma_f32_16x16x32_bf16 v[124:127], a[164:167], a[124:127], v[124:127]
  v_mfma_f32_16x16x32_bf16 v[128:131], a[164:167], a[140:143], v[128:131]
  v_mfma_f32_16x16x32_bf16 v[132:135], a[164:167], a[156:159], v[132:135]
  v_mfma_f32_16x16x32_bf16 v[136:139], a[168:171], a[92:95], v[136:139]
  v_mfma_f32_16x16x32_bf16 v[140:143], a[168:171], a[108:111], v[140:143]
  v_mfma_f32_16x16x32_bf16 v[144:147], a[168:171], a[124:127], v[144:147]
  v_mfma_f32_16x16x32_bf16 v[148:151], a[168:171], a[140:143], v[148:151]
  v_mfma_f32_16x16x32_bf16 v[152:155], a[168:171], a[156:159], v[152:155]
  v_mfma_f32_16x16x32_bf16 v[156:159], a[172:175], a[92:95], v[156:159]
  v_mfma_f32_16x16x32_bf16 v[160:163], a[172:175], a[108:111], v[160:163]
  v_mfma_f32_16x16x32_bf16 v[164:167], a[172:175], a[124:127], v[164:167]
  v_mfma_f32_16x16x32_bf16 v[168:171], a[172:175], a[140:143], v[168:171]
  v_mfma_f32_16x16x32_bf16 v[172:175], a[172:175], a[156:159], v[172:175]
  v_mfma_f32_16x16x32_bf16 v[176:179], a[176:179], a[92:95], v[176:179]
  v_mfma_f32_16x16x32_bf16 v[180:183], a[176:179], a[108:111], v[180:183]
  v_mfma_f32_16x16x32_bf16 v[184:187], a[176:179], a[124:127], v[184:187]
  v_mfma_f32_16x16x32_bf16 v[188:191], a[176:179], a[140:143], v[188:191]
  v_mfma_f32_16x16x32_bf16 v[192:195], a[176:179], a[156:159], v[192:195]
  v_mfma_f32_16x16x32_bf16 v[196:199], a[180:183], a[92:95], v[196:199]
  v_mfma_f32_16x16x32_bf16 v[200:203], a[180:183], a[108:111], v[200:203]
  v_mfma_f32_16x16x32_bf16 v[204:207], a[180:183], a[124:127], v[204:207]
  v_mfma_f32_16x16x32_bf16 v[208:211], a[180:183], a[140:143], v[208:211]
  v_mfma_f32_16x16x32_bf16 v[212:215], a[180:183], a[156:159], v[212:215]
  v_mfma_f32_16x16x32_bf16 v[216:219], a[184:187], a[92:95], v[216:219]
  v_mfma_f32_16x16x32_bf16 v[220:223], a[184:187], a[108:111], v[220:223]
  v_mfma_f32_16x16x32_bf16 v[224:227], a[184:187], a[124:127], v[224:227]
  v_mfma_f32_16x16x32_bf16 v[228:231], a[184:187], a[140:143], v[228:231]
  v_mfma_f32_16x16x32_bf16 v[232:235], a[184:187], a[156:159], v[232:235]
  v_mfma_f32_16x16x32_bf16 v[236:239], a[188:191], a[92:95], v[236:239]
  v_mfma_f32_16x16x32_bf16 v[240:243], a[188:191], a[108:111], v[240:243]
  v_mfma_f32_16x16x32_bf16 v[244:247], a[188:191], a[124:127], v[244:247]
  v_mfma_f32_16x16x32_bf16 v[248:251], a[188:191], a[140:143], v[248:251]
  v_mfma_f32_16x16x32_bf16 v[252:255], a[188:191], a[156:159], v[252:255]
  s_nop 7
  v_accvgpr_write_b32 a250, v9
  s_call_b64 s[96:97], L_rsq
  s_lshl_b32 s65, s100, 7
  s_add_u32 s65, s65, 33554432
  s_lshl_b32 s66, s34, 2
  s_add_u32 s65, s65, s66
  v_mov_b32 v6, 1
  v_mov_b32 v7, s65
  v_cmp_eq_u32 vcc, 0, v0
  s_and_saveexec_b64 s[94:95], vcc
  buffer_store_dword v6, v7, s[4:7], 0 offen sc1
  s_mov_b64 exec, s[94:95]
  s_mov_b32 s65, 0x3e0293ee
  v_mul_f32 v96, s65, v96
  v_mul_f32 v97, s65, v97
  v_mul_f32 v98, s65, v98
  v_mul_f32 v99, s65, v99
  v_mul_f32 v100, s65, v100
  v_mul_f32 v101, s65, v101
  v_mul_f32 v102, s65, v102
  v_mul_f32 v103, s65, v103
  v_mul_f32 v104, s65, v104
  v_mul_f32 v105, s65, v105
  v_mul_f32 v106, s65, v106
  v_mul_f32 v107, s65, v107
  v_mul_f32 v108, s65, v108
  v_mul_f32 v109, s65, v109
  v_mul_f32 v110, s65, v110
  v_mul_f32 v111, s65, v111
  v_mul_f32 v112, s65, v112
  v_mul_f32 v113, s65, v113
  v_mul_f32 v114, s65, v114
  v_mul_f32 v115, s65, v115
  v_mul_f32 v116, s65, v116
  v_mul_f32 v117, s65, v117
  v_mul_f32 v118, s65, v118
  v_mul_f32 v119, s65, v119
  v_mul_f32 v120, s65, v120
  v_mul_f32 v121, s65, v121
  v_mul_f32 v122, s65, v122
  v_mul_f32 v123, s65, v123
  v_mul_f32 v124, s65, v124
  v_mul_f32 v125, s65, v125
  v_mul_f32 v126, s65, v126
  v_mul_f32 v127, s65, v127
  v_mul_f32 v128, s65, v128
  v_mul_f32 v129, s65, v129
  v_mul_f32 v130, s65, v130
  v_mul_f32 v131, s65, v131
  v_mul_f32 v132, s65, v132
  v_mul_f32 v133, s65, v133
  v_mul_f32 v134, s65, v134
  v_mul_f32 v135, s65, v135
  v_cvt_pk_bf16_f32 v64, v96, v97
  v_cvt_pk_bf16_f32 v65, v98, v99
  v_cvt_pk_bf16_f32 v66, v116, v117
  v_cvt_pk_bf16_f32 v67, v118, v119
  v_cvt_pk_bf16_f32 v68, v100, v101
  v_cvt_pk_bf16_f32 v69, v102, v103
  v_cvt_pk_bf16_f32 v70, v120, v121
  v_cvt_pk_bf16_f32 v71, v122, v123
  v_cvt_pk_bf16_f32 v72, v104, v105
  v_cvt_pk_bf16_f32 v73, v106, v107
  v_cvt_pk_bf16_f32 v74, v124, v125
  v_cvt_pk_bf16_f32 v75, v126, v127
  v_cvt_pk_bf16_f32 v76, v108, v109
  v_cvt_pk_bf16_f32 v77, v110, v111
  v_cvt_pk_bf16_f32 v78, v128, v129
  v_cvt_pk_bf16_f32 v79, v130, v131
  v_cvt_pk_bf16_f32 v80, v112, v113
  v_cvt_pk_bf16_f32 v81, v114, v115
  v_cvt_pk_bf16_f32 v82, v132, v133
  v_cvt_pk_bf16_f32 v83, v134, v135
  s_waitcnt vmcnt(16)
  ds_read_b128 a[160:163], v10 offset:0
  ds_read_b128 a[164:167], v11 offset:0
  ds_read_b128 a[168:171], v12 offset:0
  ds_read_b128 a[172:175], v13 offset:0
  ds_read_b128 a[176:179], v10 offset:4096
  ds_read_b128 a[180:183], v11 offset:4096
  ds_read_b128 a[184:187], v12 offset:4096
  ds_read_b128 a[188:191], v13 offset:4096
  s_barrier
  s_add_u32 s65, s64, 32768
  v_add_u32 v6, s65, v35
  ds_write_b128 v6, v[64:67] offset:0
  ds_write_b128 v6, v[68:71] offset:1024
  ds_write_b128 v6, v[72:75] offset:2048
  ds_write_b128 v6, v[76:79] offset:3072
  ds_write_b128 v6, v[80:83] offset:4096
  s_add_u32 m0, s64, 24576
  s_add_u32 s66, s70, 0
  buffer_load_dwordx4 v26, s[56:59], s66 offen offset:0 lds
  buffer_load_dwordx4 v27, s[56:59], s66 offen offset:1024 lds
  buffer_load_dwordx4 v26, s[56:59], s66 offen offset:2048 lds
  buffer_load_dwordx4 v27, s[56:59], s66 offen offset:3072 lds
  s_add_u32 m0, s64, 28672
  s_add_u32 s66, s70, 4096
  buffer_load_dwordx4 v26, s[56:59], s66 offen offset:0 lds
  buffer_load_dwordx4 v27, s[56:59], s66 offen offset:1024 lds
  buffer_load_dwordx4 v26, s[56:59], s66 offen offset:2048 lds
  buffer_load_dwordx4 v27, s[56:59], s66 offen offset:3072 lds
  s_add_u32 s70, s70, 32768
  s_lshl_b32 s66, s37, 2
  s_add_u32 s66, s66, s34
  s_lshl_b32 s65, s40, 3
  s_add_u32 s65, s65, s35
  s_lshl_b32 s65, s65, 5
  s_add_u32 s65, s65, s66
  s_mul_i32 s65, s65, 20480
  s_add_u32 s44, s32, s65
  s_addc_u32 s45, s33, 0
  s_and_b32 s45, s45, 0xffff
  s_mov_b32 s46, 20480
  s_mov_b32 s47, 0x20000
  s_cmp_eq_u32 s40, 0
  s_cselect_b32 s48, s16, s26
  s_cselect_b32 s49, s17, s27
  s_lshl_b32 s65, s66, 17
  s_lshl_b32 s66, s38, 8
  s_add_u32 s65, s65, s66
  s_add_u32 s48, s48, s65
  s_addc_u32 s49, s49, 0
  s_and_b32 s49, s49, 0xffff
  s_mov_b32 s50, 130304
  s_mov_b32 s51, 0x20000
  s_lshl_b32 s65, s39, 3
  s_add_u32 s65, s65, s35
  s_lshl_b32 s65, s65, 5
  s_add_u32 s65, s65, s36
  s_mul_i32 s65, s65, 20480
  s_add_u32 s60, s32, s65
  s_addc_u32 s61, s33, 0
  s_and_b32 s61, s61, 0xffff
  s_mov_b32 s62, 20480
  s_mov_b32 s63, 0x20000
  s_waitcnt lgkmcnt(0)
  s_barrier
  v_add_u32 v6, 32768, v35
  ds_read_b128 a[0:3], v6 offset:0
  ds_read_b128 a[16:19], v6 offset:1024
  ds_read_b128 a[32:35], v6 offset:2048
  ds_read_b128 a[48:51], v6 offset:3072
  ds_read_b128 a[64:67], v6 offset:4096
  v_add_u32 v6, 73728, v35
  ds_read_b128 a[4:7], v6 offset:0
  ds_read_b128 a[20:23], v6 offset:1024
  ds_read_b128 a[36:39], v6 offset:2048
  ds_read_b128 a[52:55], v6 offset:3072
  ds_read_b128 a[68:71], v6 offset:4096
  v_add_u32 v6, 114688, v35
  ds_read_b128 a[8:11], v6 offset:0
  ds_read_b128 a[24:27], v6 offset:1024
  ds_read_b128 a[40:43], v6 offset:2048
  ds_read_b128 a[56:59], v6 offset:3072
  ds_read_b128 a[72:75], v6 offset:4096
  v_add_u32 v6, 155648, v35
  ds_read_b128 a[12:15], v6 offset:0
  ds_read_b128 a[28:31], v6 offset:1024
  ds_read_b128 a[44:47], v6 offset:2048
  ds_read_b128 a[60:63], v6 offset:3072
  ds_read_b128 a[76:79], v6 offset:4096
  s_waitcnt lgkmcnt(0)
  s_lshl_b32 s101, s100, 7
  s_add_u32 s101, s101, 33554492
  s_lshl_b32 s65, s35, 2
  s_add_u32 s65, s65, s34
  s_lshl_b32 s65, s65, 3
  s_or_b32 s65, s65, s37
  s_lshl_b32 s65, s65, 7
  s_add_u32 s65, s65, 33554432
  v_and_b32 v38, 3, v0
  v_lshlrev_b32 v38, 2, v38
  v_add_u32 v38, s65, v38
  s_mov_b32 s73, 1
  s_mov_b32 s71, 0
  v_lshlrev_b32 v1, 7, v0
  s_waitcnt vmcnt(16)
  s_cmp_eq_u32 s39, 0
  s_cbranch_scc0 L_cl_10_b
  s_call_b64 s[96:97], L_attA
  s_branch L_cl_10_e
L_cl_10_b:
  s_call_b64 s[96:97], L_attB
L_cl_10_e:
  v_accvgpr_read_b32 v2, a250
  s_movk_i32 s98, 256
  s_nop 0
  v_cmp_gt_u32 vcc, s98, v2
  s_nop 1
  s_cbranch_vccz L_ic_17
  s_add_u32 s4, s30, 0
  s_addc_u32 s5, s31, 0
  s_and_b32 s5, s5, 0xffff
  s_mov_b32 s6, 256
  s_mov_b32 s7, 0x20000
  s_mov_b32 s99, 0
L_icw_18:
  buffer_load_dword v2, off, s[4:7], 0 sc1
  s_waitcnt vmcnt(0)
  v_cmp_gt_u32 vcc, s98, v2
  s_nop 1
  s_cbranch_vccz L_icw_18_ok
  s_sleep 1
  s_add_u32 s99, s99, 1
  s_cmp_lt_u32 s99, 32768
  s_cbranch_scc1 L_icw_18
L_icw_18_ok:
  s_mov_b32 s4, s32
  s_and_b32 s5, s33, 0xffff
  s_mov_b32 s6, 33587200
  s_mov_b32 s7, 0x20000
  v_mov_b32 v39, 0
L_ic_17:
  s_mov_b32 s99, 0
  v_cmp_ne_u32 vcc, s73, v39
  s_nop 1
  s_cbranch_vccz L_pl_19_ok
L_pl_19_sp:
  buffer_load_dword v39, v38, s[4:7], 0 offen sc1
  s_waitcnt vmcnt(0)
  v_cmp_ne_u32 vcc, s73, v39
  s_nop 1
  s_cbranch_vccz L_pl_19_ok
  s_sleep 1
  s_add_u32 s99, s99, 1
  s_cmp_lt_u32 s99, 32768
  s_cbranch_scc1 L_pl_19_sp
L_pl_19_ok:
  s_waitcnt vmcnt(16)
  v_mfma_f32_16x16x32_bf16 v[40:43], a[160:163], a[0:3], 0
  ds_read_b64_tr_b16 a[192:193], v14 offset:8192
  ds_read_b64_tr_b16 a[194:195], v14 offset:12288
  v_mfma_f32_16x16x32_bf16 v[40:43], a[164:167], a[4:7], v[40:43]
  ds_read_b64_tr_b16 a[196:197], v15 offset:8192
  ds_read_b64_tr_b16 a[198:199], v15 offset:12288
  v_mfma_f32_16x16x32_bf16 v[40:43], a[168:171], a[8:11], v[40:43]
  ds_read_b64_tr_b16 a[200:201], v16 offset:8192
  ds_read_b64_tr_b16 a[202:203], v16 offset:12288
  v_mfma_f32_16x16x32_bf16 v[40:43], a[172:175], a[12:15], v[40:43]
  ds_read_b64_tr_b16 a[204:205], v17 offset:8192
  ds_read_b64_tr_b16 a[206:207], v17 offset:12288
  v_mfma_f32_16x16x32_bf16 v[44:47], a[176:179], a[0:3], 0
  ds_read_b64_tr_b16 a[208:209], v18 offset:8192
  ds_read_b64_tr_b16 a[210:211], v18 offset:12288
  v_mfma_f32_16x16x32_bf16 v[44:47], a[180:183], a[4:7], v[44:47]
  ds_read_b64_tr_b16 a[212:213], v19 offset:8192
  ds_read_b64_tr_b16 a[214:215], v19 offset:12288
  v_mfma_f32_16x16x32_bf16 v[44:47], a[184:187], a[8:11], v[44:47]
  s_mul_i32 s67, s41, 5120
  buffer_load_dwordx4 a[80:83], v35, s[44:47], s67 offen offset:0 sc1
  v_mfma_f32_16x16x32_bf16 v[44:47], a[188:191], a[12:15], v[44:47]
  buffer_load_dwordx4 a[96:99], v35, s[44:47], s67 offen offset:1024 sc1
  buffer_load_dwordx4 a[112:115], v35, s[44:47], s67 offen offset:2048 sc1
  v_mfma_f32_16x16x32_bf16 v[48:51], a[160:163], a[16:19], 0
  v_exp_f32 v40, v40
  v_exp_f32 v41, v41
  v_exp_f32 v42, v42
  v_mfma_f32_16x16x32_bf16 v[48:51], a[164:167], a[20:23], v[48:51]
  v_exp_f32 v43, v43
  v_cvt_pk_bf16_f32 v64, v40, v41
  v_mfma_f32_16x16x32_bf16 v[48:51], a[168:171], a[24:27], v[48:51]
  v_cvt_pk_bf16_f32 v65, v42, v43
  v_exp_f32 v44, v44
  v_mfma_f32_16x16x32_bf16 v[48:51], a[172:175], a[28:31], v[48:51]
  v_exp_f32 v45, v45
  v_exp_f32 v46, v46
  v_mfma_f32_16x16x32_bf16 v[52:55], a[176:179], a[16:19], 0
  v_exp_f32 v47, v47
  v_cvt_pk_bf16_f32 v66, v44, v45
  v_cvt_pk_bf16_f32 v67, v46, v47
  v_mfma_f32_16x16x32_bf16 v[52:55], a[180:183], a[20:23], v[52:55]
  ds_read_b64_tr_b16 a[216:217], v20 offset:8192
  ds_read_b64_tr_b16 a[218:219], v20 offset:12288
  v_mfma_f32_16x16x32_bf16 v[52:55], a[184:187], a[24:27], v[52:55]
  ds_read_b64_tr_b16 a[220:221], v21 offset:8192
  ds_read_b64_tr_b16 a[222:223], v21 offset:12288
  v_mfma_f32_16x16x32_bf16 v[52:55], a[188:191], a[28:31], v[52:55]
  buffer_load_dwordx4 a[128:131], v35, s[44:47], s67 offen offset:3072 sc1
  s_add_u32 s67, s67, 4096
  v_mfma_f32_16x16x32_bf16 v[56:59], a[160:163], a[32:35], 0
  v_exp_f32 v48, v48
  v_exp_f32 v49, v49
  v_mfma_f32_16x16x32_bf16 v[56:59], a[164:167], a[36:39], v[56:59]
  v_exp_f32 v50, v50
  v_exp_f32 v51, v51
  v_mfma_f32_16x16x32_bf16 v[56:59], a[168:171], a[40:43], v[56:59]
  v_cvt_pk_bf16_f32 v68, v48, v49
  v_cvt_pk_bf16_f32 v69, v50, v51
  v_mfma_f32_16x16x32_bf16 v[56:59], a[172:175], a[44:47], v[56:59]
  v_exp_f32 v52, v52
  v_exp_f32 v53, v53
  v_mfma_f32_16x16x32_bf16 v[60:63], a[176:179], a[32:35], 0
  v_exp_f32 v54, v54
  v_exp_f32 v55, v55
  v_mfma_f32_16x16x32_bf16 v[60:63], a[180:183], a[36:39], v[60:63]
  v_cvt_pk_bf16_f32 v70, v52, v53
  v_cvt_pk_bf16_f32 v71, v54, v55
  v_mfma_f32_16x16x32_bf16 v[60:63], a[184:187], a[40:43], v[60:63]
  buffer_load_dwordx4 a[144:147], v35, s[44:47], s67 offen sc1
  s_mul_i32 s67, s42, 5120
  v_mfma_f32_16x16x32_bf16 v[60:63], a[188:191], a[44:47], v[60:63]
  buffer_load_dwordx4 a[84:87], v35, s[44:47], s67 offen offset:0 sc1
  v_mfma_f32_16x16x32_bf16 v[40:43], a[160:163], a[48:51], 0
  v_exp_f32 v56, v56
  v_exp_f32 v57, v57
  v_mfma_f32_16x16x32_bf16 v[40:43], a[164:167], a[52:55], v[40:43]
  v_exp_f32 v58, v58
  v_exp_f32 v59, v59
  v_mfma_f32_16x16x32_bf16 v[40:43], a[168:171], a[56:59], v[40:43]
  v_cvt_pk_bf16_f32 v72, v56, v57
  v_cvt_pk_bf16_f32 v73, v58, v59
  v_mfma_f32_16x16x32_bf16 v[40:43], a[172:175], a[60:63], v[40:43]
  v_exp_f32 v60, v60
  v_mfma_f32_16x16x32_bf16 v[44:47], a[176:179], a[48:51], 0
  v_exp_f32 v61, v61
  v_exp_f32 v62, v62
  v_mfma_f32_16x16x32_bf16 v[44:47], a[180:183], a[52:55], v[44:47]
  v_exp_f32 v63, v63
  v_cvt_pk_bf16_f32 v74, v60, v61
  v_mfma_f32_16x16x32_bf16 v[44:47], a[184:187], a[56:59], v[44:47]
  v_cvt_pk_bf16_f32 v75, v62, v63
  buffer_load_dwordx4 a[100:103], v35, s[44:47], s67 offen offset:1024 sc1
  v_mfma_f32_16x16x32_bf16 v[44:47], a[188:191], a[60:63], v[44:47]
  buffer_load_dwordx4 a[116:119], v35, s[44:47], s67 offen offset:2048 sc1
  v_mfma_f32_16x16x32_bf16 v[48:51], a[160:163], a[64:67], 0
  v_exp_f32 v40, v40
  v_exp_f32 v41, v41
  v_mfma_f32_16x16x32_bf16 v[48:51], a[164:167], a[68:71], v[48:51]
  v_exp_f32 v42, v42
  v_exp_f32 v43, v43
  v_mfma_f32_16x16x32_bf16 v[48:51], a[168:171], a[72:75], v[48:51]
  v_cvt_pk_bf16_f32 v76, v40, v41
  v_cvt_pk_bf16_f32 v77, v42, v43
  v_mfma_f32_16x16x32_bf16 v[48:51], a[172:175], a[76:79], v[48:51]
  v_exp_f32 v44, v44
  v_exp_f32 v45, v45
  v_mfma_f32_16x16x32_bf16 v[52:55], a[176:179], a[64:67], 0
  v_exp_f32 v46, v46
  v_exp_f32 v47, v47
  v_mfma_f32_16x16x32_bf16 v[52:55], a[180:183], a[68:71], v[52:55]
  v_cvt_pk_bf16_f32 v78, v44, v45
  v_cvt_pk_bf16_f32 v79, v46, v47
  v_mfma_f32_16x16x32_bf16 v[52:55], a[184:187], a[72:75], v[52:55]
  buffer_load_dwordx4 a[132:135], v35, s[44:47], s67 offen offset:3072 sc1
  s_add_u32 s67, s67, 4096
  v_mfma_f32_16x16x32_bf16 v[52:55], a[188:191], a[76:79], v[52:55]
  buffer_load_dwordx4 a[148:151], v35, s[44:47], s67 offen sc1
  s_waitcnt lgkmcnt(0)
  v_mfma_f32_16x16x32_bf16 v[96:99], a[192:195], v[64:67], v[96:99]
  v_exp_f32 v48, v48
  v_exp_f32 v49, v49
  v_mfma_f32_16x16x32_bf16 v[116:119], a[196:199], v[64:67], v[116:119]
  v_exp_f32 v50, v50
  v_mfma_f32_16x16x32_bf16 v[136:139], a[200:203], v[64:67], v[136:139]
  v_exp_f32 v51, v51
  v_mfma_f32_16x16x32_bf16 v[156:159], a[204:207], v[64:67], v[156:159]
  v_cvt_pk_bf16_f32 v80, v48, v49
  v_cvt_pk_bf16_f32 v81, v50, v51
  v_mfma_f32_16x16x32_bf16 v[176:179], a[208:211], v[64:67], v[176:179]
  v_exp_f32 v52, v52
  v_mfma_f32_16x16x32_bf16 v[196:199], a[212:215], v[64:67], v[196:199]
  v_exp_f32 v53, v53
  v_mfma_f32_16x16x32_bf16 v[216:219], a[216:219], v[64:67], v[216:219]
  v_exp_f32 v54, v54
  v_exp_f32 v55, v55
  v_mfma_f32_16x16x32_bf16 v[236:239], a[220:223], v[64:67], v[236:239]
  v_cvt_pk_bf16_f32 v82, v52, v53
  v_mfma_f32_16x16x32_bf16 a[224:227], a[244:247], v[64:67], a[224:227]
  v_cvt_pk_bf16_f32 v83, v54, v55
  s_waitcnt vmcnt(18)
  v_mfma_f32_16x16x32_bf16 v[100:103], a[192:195], v[68:71], v[100:103]
  ds_read_b128 a[160:163], v10 offset:16384
  ds_read_b128 a[164:167], v11 offset:16384
  v_mfma_f32_16x16x32_bf16 v[120:123], a[196:199], v[68:71], v[120:123]
  ds_read_b128 a[168:171], v12 offset:16384
  v_mfma_f32_16x16x32_bf16 v[140:143], a[200:203], v[68:71], v[140:143]
  ds_read_b128 a[172:175], v13 offset:16384
  v_mfma_f32_16x16x32_bf16 v[160:163], a[204:207], v[68:71], v[160:163]
  ds_read_b128 a[176:179], v10 offset:20480
  ds_read_b128 a[180:183], v11 offset:20480
  v_mfma_f32_16x16x32_bf16 v[180:183], a[208:211], v[68:71], v[180:183]
  ds_read_b128 a[184:187], v12 offset:20480
  v_mfma_f32_16x16x32_bf16 v[200:203], a[212:215], v[68:71], v[200:203]
  ds_read_b128 a[188:191], v13 offset:20480
  v_mfma_f32_16x16x32_bf16 v[220:223], a[216:219], v[68:71], v[220:223]
  s_mul_i32 s67, s43, 5120
  buffer_load_dwordx4 a[88:91], v35, s[44:47], s67 offen offset:0 sc1
  v_mfma_f32_16x16x32_bf16 v[240:243], a[220:223], v[68:71], v[240:243]
  buffer_load_dwordx4 a[104:107], v35, s[44:47], s67 offen offset:1024 sc1
  v_mfma_f32_16x16x32_bf16 a[228:231], a[244:247], v[68:71], a[228:231]
  buffer_load_dwordx4 a[120:123], v35, s[44:47], s67 offen offset:2048 sc1
  v_mfma_f32_16x16x32_bf16 v[104:107], a[192:195], v[72:75], v[104:107]
  buffer_load_dwordx4 a[136:139], v35, s[44:47], s67 offen offset:3072 sc1
  v_mfma_f32_16x16x32_bf16 v[124:127], a[196:199], v[72:75], v[124:127]
  s_add_u32 s67, s67, 4096
  v_mfma_f32_16x16x32_bf16 v[144:147], a[200:203], v[72:75], v[144:147]
  v_mfma_f32_16x16x32_bf16 v[164:167], a[204:207], v[72:75], v[164:167]
  buffer_load_dwordx4 a[152:155], v35, s[44:47], s67 offen sc1
  v_mfma_f32_16x16x32_bf16 v[184:187], a[208:211], v[72:75], v[184:187]
  v_mfma_f32_16x16x32_bf16 v[204:207], a[212:215], v[72:75], v[204:207]
  s_mul_i32 s67, s3, 5120
  v_mfma_f32_16x16x32_bf16 v[224:227], a[216:219], v[72:75], v[224:227]
  v_mfma_f32_16x16x32_bf16 v[244:247], a[220:223], v[72:75], v[244:247]
  buffer_load_dwordx4 a[92:95], v35, s[44:47], s67 offen offset:0 sc1
  v_mfma_f32_16x16x32_bf16 a[232:235], a[244:247], v[72:75], a[232:235]
  v_mfma_f32_16x16x32_bf16 v[108:111], a[192:195], v[76:79], v[108:111]
  buffer_load_dwordx4 a[108:111], v35, s[44:47], s67 offen offset:1024 sc1
  v_mfma_f32_16x16x32_bf16 v[128:131], a[196:199], v[76:79], v[128:131]
  buffer_load_dwordx4 a[124:127], v35, s[44:47], s67 offen offset:2048 sc1
  v_mfma_f32_16x16x32_bf16 v[148:151], a[200:203], v[76:79], v[148:151]
  v_mfma_f32_16x16x32_bf16 v[168:171], a[204:207], v[76:79], v[168:171]
  buffer_load_dwordx4 a[140:143], v35, s[44:47], s67 offen offset:3072 sc1
  v_mfma_f32_16x16x32_bf16 v[188:191], a[208:211], v[76:79], v[188:191]
  v_mfma_f32_16x16x32_bf16 v[208:211], a[212:215], v[76:79], v[208:211]
  s_add_u32 s67, s67, 4096
  v_mfma_f32_16x16x32_bf16 v[228:231], a[216:219], v[76:79], v[228:231]
  v_mfma_f32_16x16x32_bf16 v[248:251], a[220:223], v[76:79], v[248:251]
  buffer_load_dwordx4 a[156:159], v35, s[44:47], s67 offen sc1
  v_mfma_f32_16x16x32_bf16 a[236:239], a[244:247], v[76:79], a[236:239]
  v_mfma_f32_16x16x32_bf16 v[112:115], a[192:195], v[80:83], v[112:115]
  v_mfma_f32_16x16x32_bf16 v[132:135], a[196:199], v[80:83], v[132:135]
  v_mfma_f32_16x16x32_bf16 v[152:155], a[200:203], v[80:83], v[152:155]
  v_mfma_f32_16x16x32_bf16 v[172:175], a[204:207], v[80:83], v[172:175]
  v_mfma_f32_16x16x32_bf16 v[192:195], a[208:211], v[80:83], v[192:195]
  v_mfma_f32_16x16x32_bf16 v[212:215], a[212:215], v[80:83], v[212:215]
  v_mfma_f32_16x16x32_bf16 v[232:235], a[216:219], v[80:83], v[232:235]
  v_mfma_f32_16x16x32_bf16 v[252:255], a[220:223], v[80:83], v[252:255]
  v_mfma_f32_16x16x32_bf16 a[240:243], a[244:247], v[80:83], a[240:243]
  s_waitcnt lgkmcnt(0)
  s_waitcnt vmcnt(20)
  v_mfma_f32_16x16x32_bf16 v[40:43], a[160:163], a[0:3], 0
  ds_read_b64_tr_b16 a[192:193], v14 offset:24576
  ds_read_b64_tr_b16 a[194:195], v14 offset:28672
  ds_read_b64_tr_b16 a[196:197], v15 offset:24576
  ds_read_b64_tr_b16 a[198:199], v15 offset:28672
  v_mfma_f32_16x16x32_bf16 v[40:43], a[164:167], a[4:7], v[40:43]
  ds_read_b64_tr_b16 a[200:201], v16 offset:24576
  ds_read_b64_tr_b16 a[202:203], v16 offset:28672
  ds_read_b64_tr_b16 a[204:205], v17 offset:24576
  v_mfma_f32_16x16x32_bf16 v[40:43], a[168:171], a[8:11], v[40:43]
  ds_read_b64_tr_b16 a[206:207], v17 offset:28672
  ds_read_b64_tr_b16 a[208:209], v18 offset:24576
  ds_read_b64_tr_b16 a[210:211], v18 offset:28672
  ds_read_b64_tr_b16 a[212:213], v19 offset:24576
  v_mfma_f32_16x16x32_bf16 v[40:43], a[172:175], a[12:15], v[40:43]
  ds_read_b64_tr_b16 a[214:215], v19 offset:28672
  s_lshl_b32 s98, s41, 15
  s_add_u32 m0, s64, 0
  v_mfma_f32_16x16x32_bf16 v[44:47], a[176:179], a[0:3], 0
  s_add_u32 s68, s98, 0
  buffer_load_dwordx4 v36, s[48:51], s68 offen lds
  s_add_u32 m0, s64, 1024
  v_mfma_f32_16x16x32_bf16 v[44:47], a[180:183], a[4:7], v[44:47]
  s_add_u32 s68, s98, 4096
  buffer_load_dwordx4 v37, s[48:51], s68 offen lds
  s_add_u32 m0, s64, 2048
  s_add_u32 s68, s98, 8192
  v_mfma_f32_16x16x32_bf16 v[44:47], a[184:187], a[8:11], v[44:47]
  buffer_load_dwordx4 v36, s[48:51], s68 offen lds
  s_add_u32 m0, s64, 3072
  s_add_u32 s68, s98, 12288
  v_mfma_f32_16x16x32_bf16 v[44:47], a[188:191], a[12:15], v[44:47]
  buffer_load_dwordx4 v37, s[48:51], s68 offen lds
  s_add_u32 m0, s64, 4096
  s_add_u32 s68, s98, 16384
  v_mfma_f32_16x16x32_bf16 v[48:51], a[160:163], a[16:19], 0
  v_exp_f32 v40, v40
  v_exp_f32 v41, v41
  v_exp_f32 v42, v42
  v_mfma_f32_16x16x32_bf16 v[48:51], a[164:167], a[20:23], v[48:51]
  v_exp_f32 v43, v43
  v_cvt_pk_bf16_f32 v64, v40, v41
  v_mfma_f32_16x16x32_bf16 v[48:51], a[168:171], a[24:27], v[48:51]
  v_cvt_pk_bf16_f32 v65, v42, v43
  v_exp_f32 v44, v44
  v_mfma_f32_16x16x32_bf16 v[48:51], a[172:175], a[28:31], v[48:51]
  v_exp_f32 v45, v45
  v_exp_f32 v46, v46
  v_mfma_f32_16x16x32_bf16 v[52:55], a[176:179], a[16:19], 0
  v_exp_f32 v47, v47
  v_cvt_pk_bf16_f32 v66, v44, v45
  v_cvt_pk_bf16_f32 v67, v46, v47
  v_mfma_f32_16x16x32_bf16 v[52:55], a[180:183], a[20:23], v[52:55]
  ds_read_b64_tr_b16 a[216:217], v20 offset:24576
  ds_read_b64_tr_b16 a[218:219], v20 offset:28672
  v_mfma_f32_16x16x32_bf16 v[52:55], a[184:187], a[24:27], v[52:55]
  ds_read_b64_tr_b16 a[220:221], v21 offset:24576
  ds_read_b64_tr_b16 a[222:223], v21 offset:28672
  v_mfma_f32_16x16x32_bf16 v[52:55], a[188:191], a[28:31], v[52:55]
  buffer_load_dwordx4 v36, s[48:51], s68 offen lds
  s_add_u32 m0, s64, 5120
  v_mfma_f32_16x16x32_bf16 v[56:59], a[160:163], a[32:35], 0
  v_exp_f32 v48, v48
  v_exp_f32 v49, v49
  v_mfma_f32_16x16x32_bf16 v[56:59], a[164:167], a[36:39], v[56:59]
  v_exp_f32 v50, v50
  v_exp_f32 v51, v51
  v_mfma_f32_16x16x32_bf16 v[56:59], a[168:171], a[40:43], v[56:59]
  v_cvt_pk_bf16_f32 v68, v48, v49
  v_cvt_pk_bf16_f32 v69, v50, v51
  v_mfma_f32_16x16x32_bf16 v[56:59], a[172:175], a[44:47], v[56:59]
  v_exp_f32 v52, v52
  v_exp_f32 v53, v53
  v_mfma_f32_16x16x32_bf16 v[60:63], a[176:179], a[32:35], 0
  v_exp_f32 v54, v54
  v_exp_f32 v55, v55
  v_mfma_f32_16x16x32_bf16 v[60:63], a[180:183], a[36:39], v[60:63]
  v_cvt_pk_bf16_f32 v70, v52, v53
  v_cvt_pk_bf16_f32 v71, v54, v55
  v_mfma_f32_16x16x32_bf16 v[60:63], a[184:187], a[40:43], v[60:63]
  s_add_u32 s68, s98, 20480
  buffer_load_dwordx4 v37, s[48:51], s68 offen lds
  v_mfma_f32_16x16x32_bf16 v[60:63], a[188:191], a[44:47], v[60:63]
  s_add_u32 m0, s64, 6144
  v_mfma_f32_16x16x32_bf16 v[40:43], a[160:163], a[48:51], 0
  v_exp_f32 v56, v56
  v_exp_f32 v57, v57
  v_mfma_f32_16x16x32_bf16 v[40:43], a[164:167], a[52:55], v[40:43]
  v_exp_f32 v58, v58
  v_exp_f32 v59, v59
  v_mfma_f32_16x16x32_bf16 v[40:43], a[168:171], a[56:59], v[40:43]
  v_cvt_pk_bf16_f32 v72, v56, v57
  v_cvt_pk_bf16_f32 v73, v58, v59
  v_mfma_f32_16x16x32_bf16 v[40:43], a[172:175], a[60:63], v[40:43]
  v_exp_f32 v60, v60
  v_mfma_f32_16x16x32_bf16 v[44:47], a[176:179], a[48:51], 0
  v_exp_f32 v61, v61
  v_exp_f32 v62, v62
  v_mfma_f32_16x16x32_bf16 v[44:47], a[180:183], a[52:55], v[44:47]
  v_exp_f32 v63, v63
  v_cvt_pk_bf16_f32 v74, v60, v61
  v_mfma_f32_16x16x32_bf16 v[44:47], a[184:187], a[56:59], v[44:47]
  v_cvt_pk_bf16_f32 v75, v62, v63
  s_add_u32 s68, s98, 24576
  v_mfma_f32_16x16x32_bf16 v[44:47], a[188:191], a[60:63], v[44:47]
  buffer_load_dwordx4 v36, s[48:51], s68 offen lds
  v_mfma_f32_16x16x32_bf16 v[48:51], a[160:163], a[64:67], 0
  v_exp_f32 v40, v40
  v_exp_f32 v41, v41
  v_mfma_f32_16x16x32_bf16 v[48:51], a[164:167], a[68:71], v[48:51]
  v_exp_f32 v42, v42
  v_exp_f32 v43, v43
  v_mfma_f32_16x16x32_bf16 v[48:51], a[168:171], a[72:75], v[48:51]
  v_cvt_pk_bf16_f32 v76, v40, v41
  v_cvt_pk_bf16_f32 v77, v42, v43
  v_mfma_f32_16x16x32_bf16 v[48:51], a[172:175], a[76:79], v[48:51]
  v_exp_f32 v44, v44
  v_exp_f32 v45, v45
  v_mfma_f32_16x16x32_bf16 v[52:55], a[176:179], a[64:67], 0
  v_exp_f32 v46, v46
  v_exp_f32 v47, v47
  v_mfma_f32_16x16x32_bf16 v[52:55], a[180:183], a[68:71], v[52:55]
  v_cvt_pk_bf16_f32 v78, v44, v45
  v_cvt_pk_bf16_f32 v79, v46, v47
  v_mfma_f32_16x16x32_bf16 v[52:55], a[184:187], a[72:75], v[52:55]
  s_add_u32 m0, s64, 7168
  s_add_u32 s68, s98, 28672
  v_mfma_f32_16x16x32_bf16 v[52:55], a[188:191], a[76:79], v[52:55]
  buffer_load_dwordx4 v37, s[48:51], s68 offen lds
  s_waitcnt lgkmcnt(0)
  v_mfma_f32_16x16x32_bf16 v[96:99], a[192:195], v[64:67], v[96:99]
  v_exp_f32 v48, v48
  v_exp_f32 v49, v49
  v_mfma_f32_16x16x32_bf16 v[116:119], a[196:199], v[64:67], v[116:119]
  v_exp_f32 v50, v50
  v_mfma_f32_16x16x32_bf16 v[136:139], a[200:203], v[64:67], v[136:139]
  v_exp_f32 v51, v51
  v_mfma_f32_16x16x32_bf16 v[156:159], a[204:207], v[64:67], v[156:159]
  v_cvt_pk_bf16_f32 v80, v48, v49
  v_cvt_pk_bf16_f32 v81, v50, v51
  v_mfma_f32_16x16x32_bf16 v[176:179], a[208:211], v[64:67], v[176:179]
  v_exp_f32 v52, v52
  v_mfma_f32_16x16x32_bf16 v[196:199], a[212:215], v[64:67], v[196:199]
  v_exp_f32 v53, v53
  v_mfma_f32_16x16x32_bf16 v[216:219], a[216:219], v[64:67], v[216:219]
  v_exp_f32 v54, v54
  v_exp_f32 v55, v55
  v_mfma_f32_16x16x32_bf16 v[236:239], a[220:223], v[64:67], v[236:239]
  v_cvt_pk_bf16_f32 v82, v52, v53
  v_mfma_f32_16x16x32_bf16 a[224:227], a[244:247], v[64:67], a[224:227]
  v_cvt_pk_bf16_f32 v83, v54, v55
  v_mfma_f32_16x16x32_bf16 v[100:103], a[192:195], v[68:71], v[100:103]
  s_lshl_b32 s98, s42, 15
  v_mfma_f32_16x16x32_bf16 v[120:123], a[196:199], v[68:71], v[120:123]
  s_add_u32 m0, s64, 8192
  v_mfma_f32_16x16x32_bf16 v[140:143], a[200:203], v[68:71], v[140:143]
  s_add_u32 s68, s98, 0
  v_mfma_f32_16x16x32_bf16 v[160:163], a[204:207], v[68:71], v[160:163]
  buffer_load_dwordx4 v36, s[48:51], s68 offen lds
  v_mfma_f32_16x16x32_bf16 v[180:183], a[208:211], v[68:71], v[180:183]
  s_add_u32 m0, s64, 9216
  v_mfma_f32_16x16x32_bf16 v[200:203], a[212:215], v[68:71], v[200:203]
  s_add_u32 s68, s98, 4096
  v_mfma_f32_16x16x32_bf16 v[220:223], a[216:219], v[68:71], v[220:223]
  buffer_load_dwordx4 v37, s[48:51], s68 offen lds
  v_mfma_f32_16x16x32_bf16 v[240:243], a[220:223], v[68:71], v[240:243]
  s_add_u32 m0, s64, 10240
  v_mfma_f32_16x16x32_bf16 a[228:231], a[244:247], v[68:71], a[228:231]
  v_mfma_f32_16x16x32_bf16 v[104:107], a[192:195], v[72:75], v[104:107]
  s_add_u32 s68, s98, 8192
  v_mfma_f32_16x16x32_bf16 v[124:127], a[196:199], v[72:75], v[124:127]
  buffer_load_dwordx4 v36, s[48:51], s68 offen lds
  v_mfma_f32_16x16x32_bf16 v[144:147], a[200:203], v[72:75], v[144:147]
  s_add_u32 m0, s64, 11264
  v_mfma_f32_16x16x32_bf16 v[164:167], a[204:207], v[72:75], v[164:167]
  s_add_u32 s68, s98, 12288
  v_mfma_f32_16x16x32_bf16 v[184:187], a[208:211], v[72:75], v[184:187]
  buffer_load_dwordx4 v37, s[48:51], s68 offen lds
  v_mfma_f32_16x16x32_bf16 v[204:207], a[212:215], v[72:75], v[204:207]
  s_add_u32 m0, s64, 12288
  v_mfma_f32_16x16x32_bf16 v[224:227], a[216:219], v[72:75], v[224:227]
  s_add_u32 s68, s98, 16384
  v_mfma_f32_16x16x32_bf16 v[244:247], a[220:223], v[72:75], v[244:247]
  buffer_load_dwordx4 v36, s[48:51], s68 offen lds
  v_mfma_f32_16x16x32_bf16 a[232:235], a[244:247], v[72:75], a[232:235]
  v_mfma_f32_16x16x32_bf16 v[108:111], a[192:195], v[76:79], v[108:111]
  s_add_u32 m0, s64, 13312
  v_mfma_f32_16x16x32_bf16 v[128:131], a[196:199], v[76:79], v[128:131]
  s_add_u32 s68, s98, 20480
  v_mfma_f32_16x16x32_bf16 v[148:151], a[200:203], v[76:79], v[148:151]
  buffer_load_dwordx4 v37, s[48:51], s68 offen lds
  v_mfma_f32_16x16x32_bf16 v[168:171], a[204:207], v[76:79], v[168:171]
  s_add_u32 m0, s64, 14336
  v_mfma_f32_16x16x32_bf16 v[188:191], a[208:211], v[76:79], v[188:191]
  s_add_u32 s68, s98, 24576
  v_mfma_f32_16x16x32_bf16 v[208:211], a[212:215], v[76:79], v[208:211]
  buffer_load_dwordx4 v36, s[48:51], s68 offen lds
  v_mfma_f32_16x16x32_bf16 v[228:231], a[216:219], v[76:79], v[228:231]
  s_add_u32 m0, s64, 15360
  v_mfma_f32_16x16x32_bf16 v[248:251], a[220:223], v[76:79], v[248:251]
  s_add_u32 s68, s98, 28672
  v_mfma_f32_16x16x32_bf16 a[236:239], a[244:247], v[76:79], a[236:239]
  buffer_load_dwordx4 v37, s[48:51], s68 offen lds
  v_mfma_f32_16x16x32_bf16 v[112:115], a[192:195], v[80:83], v[112:115]
  s_lshl_b32 s65, s40, 3
  s_add_u32 s65, s65, s35
  s_lshl_b32 s65, s65, 2
  v_mfma_f32_16x16x32_bf16 v[132:135], a[196:199], v[80:83], v[132:135]
  s_add_u32 s65, s65, s38
  s_lshl_b32 s65, s65, 3
  s_add_u32 s65, s65, s37
  v_mfma_f32_16x16x32_bf16 v[152:155], a[200:203], v[80:83], v[152:155]
  s_mul_i32 s65, s65, 20480
  s_add_u32 s65, s65, 16777216
  s_add_u32 s52, s32, s65
  v_mfma_f32_16x16x32_bf16 v[172:175], a[204:207], v[80:83], v[172:175]
  s_addc_u32 s53, s33, 0
  s_and_b32 s53, s53, 0xffff
  s_mov_b32 s54, 20480
  v_mfma_f32_16x16x32_bf16 v[192:195], a[208:211], v[80:83], v[192:195]
  s_mov_b32 s55, 0x20000
  s_lshl_b32 s65, s39, 3
  s_add_u32 s65, s65, s35
  v_mfma_f32_16x16x32_bf16 v[212:215], a[212:215], v[80:83], v[212:215]
  s_lshl_b32 s65, s65, 2
  s_add_u32 s65, s65, s38
  s_lshl_b32 s65, s65, 3
  v_mfma_f32_16x16x32_bf16 v[232:235], a[216:219], v[80:83], v[232:235]
  s_add_u32 s65, s65, s37
  s_mul_i32 s65, s65, 20480
  s_add_u32 s65, s65, 16777216
  v_mfma_f32_16x16x32_bf16 v[252:255], a[220:223], v[80:83], v[252:255]
  s_add_u32 s56, s32, s65
  s_addc_u32 s57, s33, 0
  s_and_b32 s57, s57, 0xffff
  v_mfma_f32_16x16x32_bf16 a[240:243], a[244:247], v[80:83], a[240:243]
  s_mov_b32 s58, 20480
  s_mov_b32 s59, 0x20000
  s_waitcnt lgkmcnt(0)
  s_add_u32 s65, s64, 24576
  v_add_u32 v8, s65, v35
  v_and_b32 v95, 15, v0
  v_lshlrev_b32 v95, 2, v95
  s_add_u32 s65, s64, 39936
  v_add_u32 v94, s65, v95
  ds_write_b32 v94, a224 offset:0
  ds_write_b32 v94, a228 offset:64
  ds_write_b32 v94, a232 offset:128
  ds_write_b32 v94, a236 offset:192
  ds_write_b32 v94, a240 offset:256
  v_cvt_pk_bf16_f32 v40, v136, v137
  v_cvt_pk_bf16_f32 v41, v138, v139
  v_cvt_pk_bf16_f32 v42, v156, v157
  v_cvt_pk_bf16_f32 v43, v158, v159
  ds_write_b128 v8, v[40:43] offset:0
  s_lshl_b32 s98, s43, 15
  v_cvt_pk_bf16_f32 v44, v140, v141
  v_cvt_pk_bf16_f32 v45, v142, v143
  v_cvt_pk_bf16_f32 v46, v160, v161
  v_cvt_pk_bf16_f32 v47, v162, v163
  ds_write_b128 v8, v[44:47] offset:1024
  s_add_u32 m0, s64, 16384
  s_add_u32 s68, s98, 0
  v_cvt_pk_bf16_f32 v48, v144, v145
  v_cvt_pk_bf16_f32 v49, v146, v147
  v_cvt_pk_bf16_f32 v50, v164, v165
  v_cvt_pk_bf16_f32 v51, v166, v167
  ds_write_b128 v8, v[48:51] offset:2048
  buffer_load_dwordx4 v36, s[48:51], s68 offen lds
  s_add_u32 m0, s64, 17408
  v_cvt_pk_bf16_f32 v52, v148, v149
  v_cvt_pk_bf16_f32 v53, v150, v151
  v_cvt_pk_bf16_f32 v54, v168, v169
  v_cvt_pk_bf16_f32 v55, v170, v171
  ds_write_b128 v8, v[52:55] offset:3072
  s_add_u32 s68, s98, 4096
  v_cvt_pk_bf16_f32 v56, v152, v153
  v_cvt_pk_bf16_f32 v57, v154, v155
  v_cvt_pk_bf16_f32 v58, v172, v173
  v_cvt_pk_bf16_f32 v59, v174, v175
  ds_write_b128 v8, v[56:59] offset:4096
  buffer_load_dwordx4 v37, s[48:51], s68 offen lds
  s_add_u32 m0, s64, 18432
  v_cvt_pk_bf16_f32 v60, v176, v177
  v_cvt_pk_bf16_f32 v61, v178, v179
  v_cvt_pk_bf16_f32 v62, v196, v197
  v_cvt_pk_bf16_f32 v63, v198, v199
  ds_write_b128 v8, v[60:63] offset:5120
  s_add_u32 s68, s98, 8192
  buffer_load_dwordx4 v36, s[48:51], s68 offen lds
  v_cvt_pk_bf16_f32 v64, v180, v181
  v_cvt_pk_bf16_f32 v65, v182, v183
  v_cvt_pk_bf16_f32 v66, v200, v201
  v_cvt_pk_bf16_f32 v67, v202, v203
  ds_write_b128 v8, v[64:67] offset:6144
  s_add_u32 m0, s64, 19456
  v_cvt_pk_bf16_f32 v68, v184, v185
  v_cvt_pk_bf16_f32 v69, v186, v187
  v_cvt_pk_bf16_f32 v70, v204, v205
  v_cvt_pk_bf16_f32 v71, v206, v207
  ds_write_b128 v8, v[68:71] offset:7168
  s_add_u32 s68, s98, 12288
  buffer_load_dwordx4 v37, s[48:51], s68 offen lds
  v_cvt_pk_bf16_f32 v40, v188, v189
  v_cvt_pk_bf16_f32 v41, v190, v191
  v_cvt_pk_bf16_f32 v42, v208, v209
  v_cvt_pk_bf16_f32 v43, v210, v211
  ds_write_b128 v8, v[40:43] offset:8192
  s_add_u32 m0, s64, 20480
  s_add_u32 s68, s98, 16384
  v_cvt_pk_bf16_f32 v44, v192, v193
  v_cvt_pk_bf16_f32 v45, v194, v195
  v_cvt_pk_bf16_f32 v46, v212, v213
  v_cvt_pk_bf16_f32 v47, v214, v215
  ds_write_b128 v8, v[44:47] offset:9216
  buffer_load_dwordx4 v36, s[48:51], s68 offen lds
  v_cvt_pk_bf16_f32 v48, v216, v217
  v_cvt_pk_bf16_f32 v49, v218, v219
  v_cvt_pk_bf16_f32 v50, v236, v237
  v_cvt_pk_bf16_f32 v51, v238, v239
  ds_write_b128 v8, v[48:51] offset:10240
  s_add_u32 m0, s64, 21504
  s_add_u32 s68, s98, 20480
  v_cvt_pk_bf16_f32 v52, v220, v221
  v_cvt_pk_bf16_f32 v53, v222, v223
  v_cvt_pk_bf16_f32 v54, v240, v241
  v_cvt_pk_bf16_f32 v55, v242, v243
  ds_write_b128 v8, v[52:55] offset:11264
  buffer_load_dwordx4 v37, s[48:51], s68 offen lds
  s_add_u32 m0, s64, 22528
  v_cvt_pk_bf16_f32 v56, v224, v225
  v_cvt_pk_bf16_f32 v57, v226, v227
  v_cvt_pk_bf16_f32 v58, v244, v245
  v_cvt_pk_bf16_f32 v59, v246, v247
  ds_write_b128 v8, v[56:59] offset:12288
  s_add_u32 s68, s98, 24576
  v_cvt_pk_bf16_f32 v60, v228, v229
  v_cvt_pk_bf16_f32 v61, v230, v231
  v_cvt_pk_bf16_f32 v62, v248, v249
  v_cvt_pk_bf16_f32 v63, v250, v251
  ds_write_b128 v8, v[60:63] offset:13312
  buffer_load_dwordx4 v36, s[48:51], s68 offen lds
  s_add_u32 m0, s64, 23552
  v_cvt_pk_bf16_f32 v64, v232, v233
  v_cvt_pk_bf16_f32 v65, v234, v235
  v_cvt_pk_bf16_f32 v66, v252, v253
  v_cvt_pk_bf16_f32 v67, v254, v255
  ds_write_b128 v8, v[64:67] offset:14336
  s_add_u32 s68, s98, 28672
  buffer_load_dwordx4 v37, s[48:51], s68 offen lds
  s_sub_u32 s65, s34, 1
  s_and_b32 s65, s65, 3
  s_mul_i32 s65, s65, 40960
  s_add_u32 s65, s65, 24576
  v_add_u32 v1, s65, v35
  s_sub_u32 s65, s34, 2
  s_and_b32 s65, s65, 3
  s_mul_i32 s65, s65, 40960
  s_add_u32 s65, s65, 29696
  v_add_u32 v8, s65, v35
  s_sub_u32 s65, s34, 3
  s_and_b32 s65, s65, 3
  s_mul_i32 s65, s65, 40960
  s_add_u32 s65, s65, 34816
  v_add_u32 v9, s65, v35
  v_mov_b32 v2, 0
  v_mov_b32 v3, 0
  v_accvgpr_read_b32 v4, a248
  v_accvgpr_read_b32 v5, a249
  v_mov_b32 v6, 0
  v_mov_b32 v7, 0
  s_waitcnt lgkmcnt(0)
  s_barrier
  ds_read_b128 a[160:163], v1 offset:0
  ds_read_b128 a[164:167], v1 offset:1024
  ds_read_b128 a[168:171], v1 offset:2048
  ds_read_b128 a[172:175], v1 offset:3072
  ds_read_b128 a[176:179], v1 offset:4096
  ds_read_b128 a[180:183], v8 offset:0
  ds_read_b128 a[184:187], v8 offset:1024
  ds_read_b128 a[188:191], v8 offset:2048
  ds_read_b128 a[192:195], v8 offset:3072
  ds_read_b128 a[196:199], v8 offset:4096
  ds_read_b128 a[200:203], v9 offset:0
  ds_read_b128 a[204:207], v9 offset:1024
  ds_read_b128 a[208:211], v9 offset:2048
  ds_read_b128 a[212:215], v9 offset:3072
  ds_read_b128 a[216:219], v9 offset:4096
  s_waitcnt lgkmcnt(10)
  v_mfma_f32_16x16x32_bf16 v[96:99], v[4:7], a[160:163], v[96:99]
  v_mfma_f32_16x16x32_bf16 v[116:119], v[2:5], a[160:163], v[116:119]
  v_mfma_f32_16x16x32_bf16 v[100:103], v[4:7], a[164:167], v[100:103]
  v_mfma_f32_16x16x32_bf16 v[120:123], v[2:5], a[164:167], v[120:123]
  v_mfma_f32_16x16x32_bf16 v[104:107], v[4:7], a[168:171], v[104:107]
  v_mfma_f32_16x16x32_bf16 v[124:127], v[2:5], a[168:171], v[124:127]
  v_mfma_f32_16x16x32_bf16 v[108:111], v[4:7], a[172:175], v[108:111]
  v_mfma_f32_16x16x32_bf16 v[128:131], v[2:5], a[172:175], v[128:131]
  v_mfma_f32_16x16x32_bf16 v[112:115], v[4:7], a[176:179], v[112:115]
  v_mfma_f32_16x16x32_bf16 v[132:135], v[2:5], a[176:179], v[132:135]
  s_waitcnt lgkmcnt(5)
  v_mfma_f32_16x16x32_bf16 v[96:99], v[4:7], a[180:183], v[96:99]
  v_mfma_f32_16x16x32_bf16 v[116:119], v[2:5], a[180:183], v[116:119]
  v_mfma_f32_16x16x32_bf16 v[100:103], v[4:7], a[184:187], v[100:103]
  v_mfma_f32_16x16x32_bf16 v[120:123], v[2:5], a[184:187], v[120:123]
  v_mfma_f32_16x16x32_bf16 v[104:107], v[4:7], a[188:191], v[104:107]
  v_mfma_f32_16x16x32_bf16 v[124:127], v[2:5], a[188:191], v[124:127]
  v_mfma_f32_16x16x32_bf16 v[108:111], v[4:7], a[192:195], v[108:111]
  v_mfma_f32_16x16x32_bf16 v[128:131], v[2:5], a[192:195], v[128:131]
  v_mfma_f32_16x16x32_bf16 v[112:115], v[4:7], a[196:199], v[112:115]
  v_mfma_f32_16x16x32_bf16 v[132:135], v[2:5], a[196:199], v[132:135]
  s_waitcnt lgkmcnt(0)
  v_add_u32 v95, 39936, v95
  ds_read_b32 v64, v95 offset:0
  ds_read_b32 v65, v95 offset:64
  ds_read_b32 v66, v95 offset:128
  ds_read_b32 v67, v95 offset:192
  ds_read_b32 v68, v95 offset:256
  v_add_u32 v95, 40960, v95
  ds_read_b32 v69, v95 offset:0
  ds_read_b32 v70, v95 offset:64
  ds_read_b32 v71, v95 offset:128
  ds_read_b32 v72, v95 offset:192
  ds_read_b32 v73, v95 offset:256
  v_add_u32 v95, 40960, v95
  ds_read_b32 v74, v95 offset:0
  ds_read_b32 v75, v95 offset:64
  ds_read_b32 v76, v95 offset:128
  ds_read_b32 v77, v95 offset:192
  ds_read_b32 v78, v95 offset:256
  v_add_u32 v95, 40960, v95
  ds_read_b32 v79, v95 offset:0
  ds_read_b32 v80, v95 offset:64
  ds_read_b32 v81, v95 offset:128
  ds_read_b32 v82, v95 offset:192
  ds_read_b32 v83, v95 offset:256
  v_mfma_f32_16x16x32_bf16 v[96:99], v[4:7], a[200:203], v[96:99]
  v_mfma_f32_16x16x32_bf16 v[116:119], v[2:5], a[200:203], v[116:119]
  v_mfma_f32_16x16x32_bf16 v[100:103], v[4:7], a[204:207], v[100:103]
  v_mfma_f32_16x16x32_bf16 v[120:123], v[2:5], a[204:207], v[120:123]
  v_mfma_f32_16x16x32_bf16 v[104:107], v[4:7], a[208:211], v[104:107]
  v_mfma_f32_16x16x32_bf16 v[124:127], v[2:5], a[208:211], v[124:127]
  v_mfma_f32_16x16x32_bf16 v[108:111], v[4:7], a[212:215], v[108:111]
  v_mfma_f32_16x16x32_bf16 v[128:131], v[2:5], a[212:215], v[128:131]
  v_mfma_f32_16x16x32_bf16 v[112:115], v[4:7], a[216:219], v[112:115]
  v_mfma_f32_16x16x32_bf16 v[132:135], v[2:5], a[216:219], v[132:135]
  s_waitcnt lgkmcnt(0)
  v_add_f32 v64, v64, v69
  v_add_f32 v74, v74, v79
  v_add_f32 v65, v65, v70
  v_add_f32 v75, v75, v80
  v_add_f32 v66, v66, v71
  v_add_f32 v76, v76, v81
  v_add_f32 v67, v67, v72
  v_add_f32 v77, v77, v82
  v_add_f32 v68, v68, v73
  v_add_f32 v78, v78, v83
  v_add_f32 v84, v64, v74
  v_add_f32 v85, v65, v75
  v_add_f32 v86, v66, v76
  v_add_f32 v87, v67, v77
  v_add_f32 v88, v68, v78
  v_max3_f32 v1, v84, v85, v86
  v_min3_f32 v2, v84, v85, v86
  v_max3_f32 v1, v1, v87, v88
  v_min3_f32 v2, v2, v87, v88
  s_mov_b32 s65, 0x5d800000
  s_mov_b32 s66, 0x21800000
  v_cmp_nge_f32 vcc, s65, v1
  v_cmp_nle_f32 s[0:1], s66, v2
  v_rcp_f32 v84, v84
  v_rcp_f32 v85, v85
  v_rcp_f32 v86, v86
  v_rcp_f32 v87, v87
  v_rcp_f32 v88, v88
  s_nop 0
  v_mul_f32 v96, v84, v96
  v_mul_f32 v97, v84, v97
  v_mul_f32 v98, v84, v98
  v_mul_f32 v99, v84, v99
  v_mul_f32 v116, v84, v116
  v_mul_f32 v117, v84, v117
  v_mul_f32 v118, v84, v118
  v_mul_f32 v119, v84, v119
  v_mul_f32 v100, v85, v100
  v_mul_f32 v101, v85, v101
  v_mul_f32 v102, v85, v102
  v_mul_f32 v103, v85, v103
  v_mul_f32 v120, v85, v120
  v_mul_f32 v121, v85, v121
  v_mul_f32 v122, v85, v122
  v_mul_f32 v123, v85, v123
  v_mul_f32 v104, v86, v104
  v_mul_f32 v105, v86, v105
  v_mul_f32 v106, v86, v106
  v_mul_f32 v107, v86, v107
  v_mul_f32 v124, v86, v124
  v_mul_f32 v125, v86, v125
  v_mul_f32 v126, v86, v126
  v_mul_f32 v127, v86, v127
  v_mul_f32 v108, v87, v108
  v_mul_f32 v109, v87, v109
  v_mul_f32 v110, v87, v110
  v_mul_f32 v111, v87, v111
  v_mul_f32 v128, v87, v128
  v_mul_f32 v129, v87, v129
  v_mul_f32 v130, v87, v130
  v_mul_f32 v131, v87, v131
  v_mul_f32 v112, v88, v112
  v_mul_f32 v113, v88, v113
  v_mul_f32 v114, v88, v114
  v_mul_f32 v115, v88, v115
  v_mul_f32 v132, v88, v132
  v_mul_f32 v133, v88, v133
  v_mul_f32 v134, v88, v134
  v_mul_f32 v135, v88, v135
  v_cvt_pk_bf16_f32 v64, v96, v97
  v_cvt_pk_bf16_f32 v65, v98, v99
  v_cvt_pk_bf16_f32 v66, v116, v117
  v_cvt_pk_bf16_f32 v67, v118, v119
  v_cvt_pk_bf16_f32 v68, v100, v101
  v_cvt_pk_bf16_f32 v69, v102, v103
  v_cvt_pk_bf16_f32 v70, v120, v121
  v_cvt_pk_bf16_f32 v71, v122, v123
  v_cvt_pk_bf16_f32 v72, v104, v105
  v_cvt_pk_bf16_f32 v73, v106, v107
  v_cvt_pk_bf16_f32 v74, v124, v125
  v_cvt_pk_bf16_f32 v75, v126, v127
  v_cvt_pk_bf16_f32 v76, v108, v109
  v_cvt_pk_bf16_f32 v77, v110, v111
  v_cvt_pk_bf16_f32 v78, v128, v129
  v_cvt_pk_bf16_f32 v79, v130, v131
  v_cvt_pk_bf16_f32 v80, v112, v113
  v_cvt_pk_bf16_f32 v81, v114, v115
  v_cvt_pk_bf16_f32 v82, v132, v133
  v_cvt_pk_bf16_f32 v83, v134, v135
  s_mul_i32 s65, s34, 5120
  buffer_store_dwordx4 v[64:67], v35, s[60:63], s65 offen offset:0 sc1
  buffer_store_dwordx4 v[68:71], v35, s[60:63], s65 offen offset:1024 sc1
  buffer_store_dwordx4 v[72:75], v35, s[60:63], s65 offen offset:2048 sc1
  buffer_store_dwordx4 v[76:79], v35, s[60:63], s65 offen offset:3072 sc1
  s_add_u32 s65, s65, 4096
  buffer_store_dwordx4 v[80:83], v35, s[60:63], s65 offen sc1
  v_mov_b32 v4, 0
  v_mov_b32 v5, 0
  v_mov_b32 v6, 0
  v_mov_b32 v7, 0
  s_or_b64 s[0:1], s[0:1], vcc
  s_nop 0
  v_mfma_f32_16x16x32_bf16 v[40:43], v[4:7], v[64:67], 0
  v_mfma_f32_16x16x32_bf16 v[40:43], v[4:7], v[68:71], v[40:43]
  v_mfma_f32_16x16x32_bf16 v[40:43], v[4:7], v[72:75], v[40:43]
  v_mfma_f32_16x16x32_bf16 v[40:43], v[4:7], v[76:79], v[40:43]
  v_mfma_f32_16x16x32_bf16 v[40:43], v[4:7], v[80:83], v[40:43]
  s_add_u32 s65, s64, 40704
  v_mov_b32 v2, s65
  s_nop 7
  v_cmp_u_f32 vcc, v40, v40
  s_nop 1
  s_or_b64 vcc, vcc, s[0:1]
  s_cmp_lg_u64 vcc, 0
  s_cselect_b32 s65, 1, 0
  v_mov_b32 v3, s65
  ds_write_b32 v2, v3
  s_waitcnt lgkmcnt(0)
  s_barrier
  v_and_b32 v2, 3, v0
  v_mul_u32_u24 v2, 40960, v2
  v_add_u32 v2, 40704, v2
  ds_read_b32 v3, v2
  s_waitcnt lgkmcnt(0)
  v_cmp_ne_u32 vcc, 0, v3
  s_nop 1
  s_cbranch_vccz L_ok_20
  s_mov_b32 s2, s39
  s_call_b64 s[92:93], L_fb
L_ok_20:
  s_lshl_b32 s98, s3, 15
  s_add_u32 m0, s64, 24576
  s_add_u32 s68, s98, 0
  buffer_load_dwordx4 v36, s[48:51], s68 offen lds
  s_add_u32 m0, s64, 25600
  s_add_u32 s68, s98, 4096
  buffer_load_dwordx4 v37, s[48:51], s68 offen lds
  s_add_u32 m0, s64, 26624
  s_add_u32 s68, s98, 8192
  buffer_load_dwordx4 v36, s[48:51], s68 offen lds
  s_add_u32 m0, s64, 27648
  s_add_u32 s68, s98, 12288
  buffer_load_dwordx4 v37, s[48:51], s68 offen lds
  s_add_u32 m0, s64, 28672
  s_add_u32 s68, s98, 16384
  buffer_load_dwordx4 v36, s[48:51], s68 offen lds
  s_add_u32 m0, s64, 29696
  s_add_u32 s68, s98, 20480
  buffer_load_dwordx4 v37, s[48:51], s68 offen lds
  s_add_u32 m0, s64, 30720
  s_add_u32 s68, s98, 24576
  buffer_load_dwordx4 v36, s[48:51], s68 offen lds
  s_add_u32 m0, s64, 31744
  s_add_u32 s68, s98, 28672
  buffer_load_dwordx4 v37, s[48:51], s68 offen lds
  s_lshl_b32 s66, s37, 2
  s_add_u32 s66, s66, s34
  s_lshl_b32 s65, s39, 3
  s_add_u32 s65, s65, s35
  s_lshl_b32 s65, s65, 5
  s_add_u32 s65, s65, s66
  s_mul_i32 s65, s65, 20480
  s_add_u32 s44, s32, s65
  s_addc_u32 s45, s33, 0
  s_and_b32 s45, s45, 0xffff
  s_mov_b32 s46, 20480
  s_mov_b32 s47, 0x20000
  s_cmp_eq_u32 s39, 0
  s_cselect_b32 s48, s16, s26
  s_cselect_b32 s49, s17, s27
  s_lshl_b32 s65, s66, 17
  s_lshl_b32 s66, s38, 8
  s_add_u32 s65, s65, s66
  s_add_u32 s48, s48, s65
  s_addc_u32 s49, s49, 0
  s_and_b32 s49, s49, 0xffff
  s_mov_b32 s50, 130304
  s_mov_b32 s51, 0x20000
  s_lshl_b32 s65, s35, 2
  s_add_u32 s65, s65, s34
  s_lshl_b32 s65, s65, 3
  s_or_b32 s65, s65, s37
  s_lshl_b32 s65, s65, 7
  s_add_u32 s65, s65, 33554448
  v_and_b32 v38, 3, v0
  v_lshlrev_b32 v38, 2, v38
  v_add_u32 v38, s65, v38
  s_mov_b32 s73, 1
  s_waitcnt vmcnt(29)
  ds_read_b64_tr_b16 a[192:193], v14 offset:0
  ds_read_b64_tr_b16 a[194:195], v14 offset:4096
  ds_read_b64_tr_b16 a[196:197], v15 offset:0
  ds_read_b64_tr_b16 a[198:199], v15 offset:4096
  ds_read_b64_tr_b16 a[200:201], v16 offset:0
  ds_read_b64_tr_b16 a[202:203], v16 offset:4096
  ds_read_b64_tr_b16 a[204:205], v17 offset:0
  ds_read_b64_tr_b16 a[206:207], v17 offset:4096
  ds_read_b64_tr_b16 a[208:209], v18 offset:0
  ds_read_b64_tr_b16 a[210:211], v18 offset:4096
  ds_read_b64_tr_b16 a[212:213], v19 offset:0
  ds_read_b64_tr_b16 a[214:215], v19 offset:4096
  ds_read_b64_tr_b16 a[216:217], v20 offset:0
  ds_read_b64_tr_b16 a[218:219], v20 offset:4096
  ds_read_b64_tr_b16 a[220:221], v21 offset:0
  ds_read_b64_tr_b16 a[222:223], v21 offset:4096
  s_waitcnt lgkmcnt(0)
  v_mfma_f32_16x16x32_bf16 v[96:99], a[192:195], a[80:83], 0
  s_lshl_b32 s98, s41, 15
  s_add_u32 m0, s64, 0
  v_mfma_f32_16x16x32_bf16 v[100:103], a[192:195], a[96:99], 0
  s_add_u32 s68, s98, 0
  v_mfma_f32_16x16x32_bf16 v[104:107], a[192:195], a[112:115], 0
  buffer_load_dwordx4 v36, s[48:51], s68 offen lds
  v_mfma_f32_16x16x32_bf16 v[108:111], a[192:195], a[128:131], 0
  s_add_u32 m0, s64, 1024
  v_mfma_f32_16x16x32_bf16 v[112:115], a[192:195], a[144:147], 0
  s_add_u32 s68, s98, 4096
  buffer_load_dwordx4 v37, s[48:51], s68 offen lds
  v_mfma_f32_16x16x32_bf16 v[116:119], a[196:199], a[80:83], 0
  s_add_u32 m0, s64, 2048
  v_mfma_f32_16x16x32_bf16 v[120:123], a[196:199], a[96:99], 0
  s_add_u32 s68, s98, 8192
  v_mfma_f32_16x16x32_bf16 v[124:127], a[196:199], a[112:115], 0
  buffer_load_dwordx4 v36, s[48:51], s68 offen lds
  v_mfma_f32_16x16x32_bf16 v[128:131], a[196:199], a[128:131], 0
  s_add_u32 m0, s64, 3072
  s_add_u32 s68, s98, 12288
  v_mfma_f32_16x16x32_bf16 v[132:135], a[196:199], a[144:147], 0
  buffer_load_dwordx4 v37, s[48:51], s68 offen lds
  v_mfma_f32_16x16x32_bf16 v[136:139], a[200:203], a[80:83], 0
  s_add_u32 m0, s64, 4096
  v_mfma_f32_16x16x32_bf16 v[140:143], a[200:203], a[96:99], 0
  s_add_u32 s68, s98, 16384
  v_mfma_f32_16x16x32_bf16 v[144:147], a[200:203], a[112:115], 0
  buffer_load_dwordx4 v36, s[48:51], s68 offen lds
  s_add_u32 m0, s64, 5120
  v_mfma_f32_16x16x32_bf16 v[148:151], a[200:203], a[128:131], 0
  s_add_u32 s68, s98, 20480
  v_mfma_f32_16x16x32_bf16 v[152:155], a[200:203], a[144:147], 0
  buffer_load_dwordx4 v37, s[48:51], s68 offen lds
  v_mfma_f32_16x16x32_bf16 v[156:159], a[204:207], a[80:83], 0
  s_add_u32 m0, s64, 6144
  v_mfma_f32_16x16x32_bf16 v[160:163], a[204:207], a[96:99], 0
  s_add_u32 s68, s98, 24576
  buffer_load_dwordx4 v36, s[48:51], s68 offen lds
  v_mfma_f32_16x16x32_bf16 v[164:167], a[204:207], a[112:115], 0
  s_add_u32 m0, s64, 7168
  v_mfma_f32_16x16x32_bf16 v[168:171], a[204:207], a[128:131], 0
  s_add_u32 s68, s98, 28672
  v_mfma_f32_16x16x32_bf16 v[172:175], a[204:207], a[144:147], 0
  buffer_load_dwordx4 v37, s[48:51], s68 offen lds
  s_waitcnt vmcnt(29)
  v_mfma_f32_16x16x32_bf16 v[176:179], a[208:211], a[80:83], 0
  ds_read_b64_tr_b16 a[160:161], v14 offset:8192
  v_mfma_f32_16x16x32_bf16 v[180:183], a[208:211], a[96:99], 0
  ds_read_b64_tr_b16 a[162:163], v14 offset:12288
  v_mfma_f32_16x16x32_bf16 v[184:187], a[208:211], a[112:115], 0
  ds_read_b64_tr_b16 a[164:165], v15 offset:8192
  v_mfma_f32_16x16x32_bf16 v[188:191], a[208:211], a[128:131], 0
  ds_read_b64_tr_b16 a[166:167], v15 offset:12288
  v_mfma_f32_16x16x32_bf16 v[192:195], a[208:211], a[144:147], 0
  v_mfma_f32_16x16x32_bf16 v[196:199], a[212:215], a[80:83], 0
  ds_read_b64_tr_b16 a[168:169], v16 offset:8192
  v_mfma_f32_16x16x32_bf16 v[200:203], a[212:215], a[96:99], 0
  ds_read_b64_tr_b16 a[170:171], v16 offset:12288
  v_mfma_f32_16x16x32_bf16 v[204:207], a[212:215], a[112:115], 0
  ds_read_b64_tr_b16 a[172:173], v17 offset:8192
  v_mfma_f32_16x16x32_bf16 v[208:211], a[212:215], a[128:131], 0
  ds_read_b64_tr_b16 a[174:175], v17 offset:12288
  v_mfma_f32_16x16x32_bf16 v[212:215], a[212:215], a[144:147], 0
  v_mfma_f32_16x16x32_bf16 v[216:219], a[216:219], a[80:83], 0
  ds_read_b64_tr_b16 a[176:177], v18 offset:8192
  v_mfma_f32_16x16x32_bf16 v[220:223], a[216:219], a[96:99], 0
  ds_read_b64_tr_b16 a[178:179], v18 offset:12288
  v_mfma_f32_16x16x32_bf16 v[224:227], a[216:219], a[112:115], 0
  ds_read_b64_tr_b16 a[180:181], v19 offset:8192
  v_mfma_f32_16x16x32_bf16 v[228:231], a[216:219], a[128:131], 0
  ds_read_b64_tr_b16 a[182:183], v19 offset:12288
  v_mfma_f32_16x16x32_bf16 v[232:235], a[216:219], a[144:147], 0
  v_mfma_f32_16x16x32_bf16 v[236:239], a[220:223], a[80:83], 0
  ds_read_b64_tr_b16 a[184:185], v20 offset:8192
  v_mfma_f32_16x16x32_bf16 v[240:243], a[220:223], a[96:99], 0
  ds_read_b64_tr_b16 a[186:187], v20 offset:12288
  v_mfma_f32_16x16x32_bf16 v[244:247], a[220:223], a[112:115], 0
  ds_read_b64_tr_b16 a[188:189], v21 offset:8192
  v_mfma_f32_16x16x32_bf16 v[248:251], a[220:223], a[128:131], 0
  ds_read_b64_tr_b16 a[190:191], v21 offset:12288
  v_mfma_f32_16x16x32_bf16 v[252:255], a[220:223], a[144:147], 0
  s_waitcnt lgkmcnt(0)
  s_waitcnt vmcnt(16)
  s_lshl_b32 s65, s100, 7
  s_add_u32 s65, s65, 33554448
  s_lshl_b32 s66, s34, 2
  s_add_u32 s65, s65, s66
  v_mov_b32 v6, 1
  v_mov_b32 v7, s65
  v_cmp_eq_u32 vcc, 0, v0
  s_and_saveexec_b64 s[94:95], vcc
  buffer_store_dword v6, v7, s[4:7], 0 offen sc1
  s_mov_b64 exec, s[94:95]
  v_mfma_f32_16x16x32_bf16 v[96:99], a[160:163], a[84:87], v[96:99]
  s_lshl_b32 s98, s42, 15
  s_add_u32 m0, s64, 8192
  v_mfma_f32_16x16x32_bf16 v[100:103], a[160:163], a[100:103], v[100:103]
  s_add_u32 s68, s98, 0
  v_mfma_f32_16x16x32_bf16 v[104:107], a[160:163], a[116:119], v[104:107]
  buffer_load_dwordx4 v36, s[48:51], s68 offen lds
  v_mfma_f32_16x16x32_bf16 v[108:111], a[160:163], a[132:135], v[108:111]
  s_add_u32 m0, s64, 9216
  v_mfma_f32_16x16x32_bf16 v[112:115], a[160:163], a[148:151], v[112:115]
  s_add_u32 s68, s98, 4096
  buffer_load_dwordx4 v37, s[48:51], s68 offen lds
  v_mfma_f32_16x16x32_bf16 v[116:119], a[164:167], a[84:87], v[116:119]
  s_add_u32 m0, s64, 10240
  v_mfma_f32_16x16x32_bf16 v[120:123], a[164:167], a[100:103], v[120:123]
  s_add_u32 s68, s98, 8192
  v_mfma_f32_16x16x32_bf16 v[124:127], a[164:167], a[116:119], v[124:127]
  buffer_load_dwordx4 v36, s[48:51], s68 offen lds
  v_mfma_f32_16x16x32_bf16 v[128:131], a[164:167], a[132:135], v[128:131]
  s_add_u32 m0, s64, 11264
  s_add_u32 s68, s98, 12288
  v_mfma_f32_16x16x32_bf16 v[132:135], a[164:167], a[148:151], v[132:135]
  buffer_load_dwordx4 v37, s[48:51], s68 offen lds
  v_mfma_f32_16x16x32_bf16 v[136:139], a[168:171], a[84:87], v[136:139]
  s_add_u32 m0, s64, 12288
  v_mfma_f32_16x16x32_bf16 v[140:143], a[168:171], a[100:103], v[140:143]
  s_add_u32 s68, s98, 16384
  v_mfma_f32_16x16x32_bf16 v[144:147], a[168:171], a[116:119], v[144:147]
  buffer_load_dwordx4 v36, s[48:51], s68 offen lds
  s_add_u32 m0, s64, 13312
  v_mfma_f32_16x16x32_bf16 v[148:151], a[168:171], a[132:135], v[148:151]
  s_add_u32 s68, s98, 20480
  v_mfma_f32_16x16x32_bf16 v[152:155], a[168:171], a[148:151], v[152:155]
  buffer_load_dwordx4 v37, s[48:51], s68 offen lds
  v_mfma_f32_16x16x32_bf16 v[156:159], a[172:175], a[84:87], v[156:159]
  s_add_u32 m0, s64, 14336
  v_mfma_f32_16x16x32_bf16 v[160:163], a[172:175], a[100:103], v[160:163]
  s_add_u32 s68, s98, 24576
  buffer_load_dwordx4 v36, s[48:51], s68 offen lds
  v_mfma_f32_16x16x32_bf16 v[164:167], a[172:175], a[116:119], v[164:167]
  s_add_u32 m0, s64, 15360
  v_mfma_f32_16x16x32_bf16 v[168:171], a[172:175], a[132:135], v[168:171]
  s_add_u32 s68, s98, 28672
  v_mfma_f32_16x16x32_bf16 v[172:175], a[172:175], a[148:151], v[172:175]
  buffer_load_dwordx4 v37, s[48:51], s68 offen lds
  s_waitcnt vmcnt(63)
  v_mfma_f32_16x16x32_bf16 v[176:179], a[176:179], a[84:87], v[176:179]
  ds_read_b64_tr_b16 a[192:193], v14 offset:16384
  v_mfma_f32_16x16x32_bf16 v[180:183], a[176:179], a[100:103], v[180:183]
  ds_read_b64_tr_b16 a[194:195], v14 offset:20480
  v_mfma_f32_16x16x32_bf16 v[184:187], a[176:179], a[116:119], v[184:187]
  ds_read_b64_tr_b16 a[196:197], v15 offset:16384
  v_mfma_f32_16x16x32_bf16 v[188:191], a[176:179], a[132:135], v[188:191]
  ds_read_b64_tr_b16 a[198:199], v15 offset:20480
  v_mfma_f32_16x16x32_bf16 v[192:195], a[176:179], a[148:151], v[192:195]
  v_mfma_f32_16x16x32_bf16 v[196:199], a[180:183], a[84:87], v[196:199]
  ds_read_b64_tr_b16 a[200:201], v16 offset:16384
  v_mfma_f32_16x16x32_bf16 v[200:203], a[180:183], a[100:103], v[200:203]
  ds_read_b64_tr_b16 a[202:203], v16 offset:20480
  v_mfma_f32_16x16x32_bf16 v[204:207], a[180:183], a[116:119], v[204:207]
  ds_read_b64_tr_b16 a[204:205], v17 offset:16384
  v_mfma_f32_16x16x32_bf16 v[208:211], a[180:183], a[132:135], v[208:211]
  ds_read_b64_tr_b16 a[206:207], v17 offset:20480
  v_mfma_f32_16x16x32_bf16 v[212:215], a[180:183], a[148:151], v[212:215]
  v_mfma_f32_16x16x32_bf16 v[216:219], a[184:187], a[84:87], v[216:219]
  ds_read_b64_tr_b16 a[208:209], v18 offset:16384
  v_mfma_f32_16x16x32_bf16 v[220:223], a[184:187], a[100:103], v[220:223]
  ds_read_b64_tr_b16 a[210:211], v18 offset:20480
  v_mfma_f32_16x16x32_bf16 v[224:227], a[184:187], a[116:119], v[224:227]
  ds_read_b64_tr_b16 a[212:213], v19 offset:16384
  v_mfma_f32_16x16x32_bf16 v[228:231], a[184:187], a[132:135], v[228:231]
  ds_read_b64_tr_b16 a[214:215], v19 offset:20480
  v_mfma_f32_16x16x32_bf16 v[232:235], a[184:187], a[148:151], v[232:235]
  v_mfma_f32_16x16x32_bf16 v[236:239], a[188:191], a[84:87], v[236:239]
  ds_read_b64_tr_b16 a[216:217], v20 offset:16384
  v_mfma_f32_16x16x32_bf16 v[240:243], a[188:191], a[100:103], v[240:243]
  ds_read_b64_tr_b16 a[218:219], v20 offset:20480
  v_mfma_f32_16x16x32_bf16 v[244:247], a[188:191], a[116:119], v[244:247]
  ds_read_b64_tr_b16 a[220:221], v21 offset:16384
  v_mfma_f32_16x16x32_bf16 v[248:251], a[188:191], a[132:135], v[248:251]
  ds_read_b64_tr_b16 a[222:223], v21 offset:20480
  v_mfma_f32_16x16x32_bf16 v[252:255], a[188:191], a[148:151], v[252:255]
  s_waitcnt lgkmcnt(0)
  v_mfma_f32_16x16x32_bf16 v[96:99], a[192:195], a[88:91], v[96:99]
  s_lshl_b32 s98, s43, 15
  s_add_u32 m0, s64, 16384
  v_mfma_f32_16x16x32_bf16 v[100:103], a[192:195], a[104:107], v[100:103]
  s_add_u32 s68, s98, 0
  v_mfma_f32_16x16x32_bf16 v[104:107], a[192:195], a[120:123], v[104:107]
  buffer_load_dwordx4 v36, s[48:51], s68 offen lds
  v_mfma_f32_16x16x32_bf16 v[108:111], a[192:195], a[136:139], v[108:111]
  s_add_u32 m0, s64, 17408
  v_mfma_f32_16x16x32_bf16 v[112:115], a[192:195], a[152:155], v[112:115]
  s_add_u32 s68, s98, 4096
  buffer_load_dwordx4 v37, s[48:51], s68 offen lds
  v_mfma_f32_16x16x32_bf16 v[116:119], a[196:199], a[88:91], v[116:119]
  s_add_u32 m0, s64, 18432
  v_mfma_f32_16x16x32_bf16 v[120:123], a[196:199], a[104:107], v[120:123]
  s_add_u32 s68, s98, 8192
  v_mfma_f32_16x16x32_bf16 v[124:127], a[196:199], a[120:123], v[124:127]
  buffer_load_dwordx4 v36, s[48:51], s68 offen lds
  v_mfma_f32_16x16x32_bf16 v[128:131], a[196:199], a[136:139], v[128:131]
  s_add_u32 m0, s64, 19456
  s_add_u32 s68, s98, 12288
  v_mfma_f32_16x16x32_bf16 v[132:135], a[196:199], a[152:155], v[132:135]
  buffer_load_dwordx4 v37, s[48:51], s68 offen lds
  v_mfma_f32_16x16x32_bf16 v[136:139], a[200:203], a[88:91], v[136:139]
  s_add_u32 m0, s64, 20480
  v_mfma_f32_16x16x32_bf16 v[140:143], a[200:203], a[104:107], v[140:143]
  s_add_u32 s68, s98, 16384
  v_mfma_f32_16x16x32_bf16 v[144:147], a[200:203], a[120:123], v[144:147]
  buffer_load_dwordx4 v36, s[48:51], s68 offen lds
  s_add_u32 m0, s64, 21504
  v_mfma_f32_16x16x32_bf16 v[148:151], a[200:203], a[136:139], v[148:151]
  s_add_u32 s68, s98, 20480
  v_mfma_f32_16x16x32_bf16 v[152:155], a[200:203], a[152:155], v[152:155]
  buffer_load_dwordx4 v37, s[48:51], s68 offen lds
  v_mfma_f32_16x16x32_bf16 v[156:159], a[204:207], a[88:91], v[156:159]
  s_add_u32 m0, s64, 22528
  v_mfma_f32_16x16x32_bf16 v[160:163], a[204:207], a[104:107], v[160:163]
  s_add_u32 s68, s98, 24576
  buffer_load_dwordx4 v36, s[48:51], s68 offen lds
  v_mfma_f32_16x16x32_bf16 v[164:167], a[204:207], a[120:123], v[164:167]
  s_add_u32 m0, s64, 23552
  v_mfma_f32_16x16x32_bf16 v[168:171], a[204:207], a[136:139], v[168:171]
  s_add_u32 s68, s98, 28672
  v_mfma_f32_16x16x32_bf16 v[172:175], a[204:207], a[152:155], v[172:175]
  buffer_load_dwordx4 v37, s[48:51], s68 offen lds
  s_waitcnt vmcnt(24)
  v_mfma_f32_16x16x32_bf16 v[176:179], a[208:211], a[88:91], v[176:179]
  ds_read_b64_tr_b16 a[160:161], v14 offset:24576
  v_mfma_f32_16x16x32_bf16 v[180:183], a[208:211], a[104:107], v[180:183]
  ds_read_b64_tr_b16 a[162:163], v14 offset:28672
  v_mfma_f32_16x16x32_bf16 v[184:187], a[208:211], a[120:123], v[184:187]
  ds_read_b64_tr_b16 a[164:165], v15 offset:24576
  v_mfma_f32_16x16x32_bf16 v[188:191], a[208:211], a[136:139], v[188:191]
  ds_read_b64_tr_b16 a[166:167], v15 offset:28672
  v_mfma_f32_16x16x32_bf16 v[192:195], a[208:211], a[152:155], v[192:195]
  v_mfma_f32_16x16x32_bf16 v[196:199], a[212:215], a[88:91], v[196:199]
  ds_read_b64_tr_b16 a[168:169], v16 offset:24576
  v_mfma_f32_16x16x32_bf16 v[200:203], a[212:215], a[104:107], v[200:203]
  ds_read_b64_tr_b16 a[170:171], v16 offset:28672
  v_mfma_f32_16x16x32_bf16 v[204:207], a[212:215], a[120:123], v[204:207]
  ds_read_b64_tr_b16 a[172:173], v17 offset:24576
  v_mfma_f32_16x16x32_bf16 v[208:211], a[212:215], a[136:139], v[208:211]
  ds_read_b64_tr_b16 a[174:175], v17 offset:28672
  v_mfma_f32_16x16x32_bf16 v[212:215], a[212:215], a[152:155], v[212:215]
  v_mfma_f32_16x16x32_bf16 v[216:219], a[216:219], a[88:91], v[216:219]
  ds_read_b64_tr_b16 a[176:177], v18 offset:24576
  v_mfma_f32_16x16x32_bf16 v[220:223], a[216:219], a[104:107], v[220:223]
  ds_read_b64_tr_b16 a[178:179], v18 offset:28672
  v_mfma_f32_16x16x32_bf16 v[224:227], a[216:219], a[120:123], v[224:227]
  ds_read_b64_tr_b16 a[180:181], v19 offset:24576
  v_mfma_f32_16x16x32_bf16 v[228:231], a[216:219], a[136:139], v[228:231]
  ds_read_b64_tr_b16 a[182:183], v19 offset:28672
  v_mfma_f32_16x16x32_bf16 v[232:235], a[216:219], a[152:155], v[232:235]
  v_mfma_f32_16x16x32_bf16 v[236:239], a[220:223], a[88:91], v[236:239]
  ds_read_b64_tr_b16 a[184:185], v20 offset:24576
  v_mfma_f32_16x16x32_bf16 v[240:243], a[220:223], a[104:107], v[240:243]
  ds_read_b64_tr_b16 a[186:187], v20 offset:28672
  v_mfma_f32_16x16x32_bf16 v[244:247], a[220:223], a[120:123], v[244:247]
  ds_read_b64_tr_b16 a[188:189], v21 offset:24576
  v_mfma_f32_16x16x32_bf16 v[248:251], a[220:223], a[136:139], v[248:251]
  ds_read_b64_tr_b16 a[190:191], v21 offset:28672
  v_mfma_f32_16x16x32_bf16 v[252:255], a[220:223], a[152:155], v[252:255]
  s_waitcnt lgkmcnt(0)
  v_mfma_f32_16x16x32_bf16 v[96:99], a[160:163], a[92:95], v[96:99]
  buffer_load_dword v39, v38, s[4:7], 0 offen sc1
  v_mfma_f32_16x16x32_bf16 v[100:103], a[160:163], a[108:111], v[100:103]
  v_mfma_f32_16x16x32_bf16 v[104:107], a[160:163], a[124:127], v[104:107]
  v_mfma_f32_16x16x32_bf16 v[108:111], a[160:163], a[140:143], v[108:111]
  v_mfma_f32_16x16x32_bf16 v[112:115], a[160:163], a[156:159], v[112:115]
  v_mfma_f32_16x16x32_bf16 v[116:119], a[164:167], a[92:95], v[116:119]
  v_mfma_f32_16x16x32_bf16 v[120:123], a[164:167], a[108:111], v[120:123]
  v_mfma_f32_16x16x32_bf16 v[124:127], a[164:167], a[124:127], v[124:127]
  v_mfma_f32_16x16x32_bf16 v[128:131], a[164:167], a[140:143], v[128:131]
  v_mfma_f32_16x16x32_bf16 v[132:135], a[164:167], a[156:159], v[132:135]
  v_mfma_f32_16x16x32_bf16 v[136:139], a[168:171], a[92:95], v[136:139]
  v_mfma_f32_16x16x32_bf16 v[140:143], a[168:171], a[108:111], v[140:143]
  v_mfma_f32_16x16x32_bf16 v[144:147], a[168:171], a[124:127], v[144:147]
  v_mfma_f32_16x16x32_bf16 v[148:151], a[168:171], a[140:143], v[148:151]
  v_mfma_f32_16x16x32_bf16 v[152:155], a[168:171], a[156:159], v[152:155]
  v_mfma_f32_16x16x32_bf16 v[156:159], a[172:175], a[92:95], v[156:159]
  v_mfma_f32_16x16x32_bf16 v[160:163], a[172:175], a[108:111], v[160:163]
  v_mfma_f32_16x16x32_bf16 v[164:167], a[172:175], a[124:127], v[164:167]
  v_mfma_f32_16x16x32_bf16 v[168:171], a[172:175], a[140:143], v[168:171]
  v_mfma_f32_16x16x32_bf16 v[172:175], a[172:175], a[156:159], v[172:175]
  v_mfma_f32_16x16x32_bf16 v[176:179], a[176:179], a[92:95], v[176:179]
  v_mfma_f32_16x16x32_bf16 v[180:183], a[176:179], a[108:111], v[180:183]
  v_mfma_f32_16x16x32_bf16 v[184:187], a[176:179], a[124:127], v[184:187]
  v_mfma_f32_16x16x32_bf16 v[188:191], a[176:179], a[140:143], v[188:191]
  v_mfma_f32_16x16x32_bf16 v[192:195], a[176:179], a[156:159], v[192:195]
  v_mfma_f32_16x16x32_bf16 v[196:199], a[180:183], a[92:95], v[196:199]
  v_mfma_f32_16x16x32_bf16 v[200:203], a[180:183], a[108:111], v[200:203]
  v_mfma_f32_16x16x32_bf16 v[204:207], a[180:183], a[124:127], v[204:207]
  v_mfma_f32_16x16x32_bf16 v[208:211], a[180:183], a[140:143], v[208:211]
  v_mfma_f32_16x16x32_bf16 v[212:215], a[180:183], a[156:159], v[212:215]
  v_mfma_f32_16x16x32_bf16 v[216:219], a[184:187], a[92:95], v[216:219]
  v_mfma_f32_16x16x32_bf16 v[220:223], a[184:187], a[108:111], v[220:223]
  v_mfma_f32_16x16x32_bf16 v[224:227], a[184:187], a[124:127], v[224:227]
  v_mfma_f32_16x16x32_bf16 v[228:231], a[184:187], a[140:143], v[228:231]
  v_mfma_f32_16x16x32_bf16 v[232:235], a[184:187], a[156:159], v[232:235]
  v_mfma_f32_16x16x32_bf16 v[236:239], a[188:191], a[92:95], v[236:239]
  v_mfma_f32_16x16x32_bf16 v[240:243], a[188:191], a[108:111], v[240:243]
  v_mfma_f32_16x16x32_bf16 v[244:247], a[188:191], a[124:127], v[244:247]
  v_mfma_f32_16x16x32_bf16 v[248:251], a[188:191], a[140:143], v[248:251]
  v_mfma_f32_16x16x32_bf16 v[252:255], a[188:191], a[156:159], v[252:255]
  s_nop 7
  s_waitcnt vmcnt(0)
  s_mov_b32 s99, 0
  v_cmp_ne_u32 vcc, s73, v39
  s_nop 1
  s_cbranch_vccz L_pl_21_ok
L_pl_21_sp:
  buffer_load_dword v39, v38, s[4:7], 0 offen sc1
  s_waitcnt vmcnt(0)
  v_cmp_ne_u32 vcc, s73, v39
  s_nop 1
  s_cbranch_vccz L_pl_21_ok
  s_sleep 1
  s_add_u32 s99, s99, 1
  s_cmp_lt_u32 s99, 32768
  s_cbranch_scc1 L_pl_21_sp
L_pl_21_ok:
  s_add_u32 s65, s64, 24576
  v_add_u32 v8, s65, v35
  v_cvt_pk_bf16_f32 v40, v136, v137
  v_cvt_pk_bf16_f32 v41, v138, v139
  v_cvt_pk_bf16_f32 v42, v156, v157
  v_cvt_pk_bf16_f32 v43, v158, v159
  ds_write_b128 v8, v[40:43] offset:0
  s_mul_i32 s67, s41, 5120
  v_cvt_pk_bf16_f32 v44, v140, v141
  v_cvt_pk_bf16_f32 v45, v142, v143
  v_cvt_pk_bf16_f32 v46, v160, v161
  v_cvt_pk_bf16_f32 v47, v162, v163
  ds_write_b128 v8, v[44:47] offset:1024
  buffer_load_dwordx4 a[80:83], v35, s[44:47], s67 offen offset:0 sc1
  buffer_load_dwordx4 a[96:99], v35, s[44:47], s67 offen offset:1024 sc1
  v_cvt_pk_bf16_f32 v48, v144, v145
  v_cvt_pk_bf16_f32 v49, v146, v147
  v_cvt_pk_bf16_f32 v50, v164, v165
  v_cvt_pk_bf16_f32 v51, v166, v167
  ds_write_b128 v8, v[48:51] offset:2048
  buffer_load_dwordx4 a[112:115], v35, s[44:47], s67 offen offset:2048 sc1
  buffer_load_dwordx4 a[128:131], v35, s[44:47], s67 offen offset:3072 sc1
  v_cvt_pk_bf16_f32 v52, v148, v149
  v_cvt_pk_bf16_f32 v53, v150, v151
  v_cvt_pk_bf16_f32 v54, v168, v169
  v_cvt_pk_bf16_f32 v55, v170, v171
  ds_write_b128 v8, v[52:55] offset:3072
  s_add_u32 s67, s67, 4096
  buffer_load_dwordx4 a[144:147], v35, s[44:47], s67 offen sc1
  v_cvt_pk_bf16_f32 v56, v152, v153
  v_cvt_pk_bf16_f32 v57, v154, v155
  v_cvt_pk_bf16_f32 v58, v172, v173
  v_cvt_pk_bf16_f32 v59, v174, v175
  ds_write_b128 v8, v[56:59] offset:4096
  s_mul_i32 s67, s42, 5120
  buffer_load_dwordx4 a[84:87], v35, s[44:47], s67 offen offset:0 sc1
  v_cvt_pk_bf16_f32 v60, v176, v177
  v_cvt_pk_bf16_f32 v61, v178, v179
  v_cvt_pk_bf16_f32 v62, v196, v197
  v_cvt_pk_bf16_f32 v63, v198, v199
  ds_write_b128 v8, v[60:63] offset:5120
  buffer_load_dwordx4 a[100:103], v35, s[44:47], s67 offen offset:1024 sc1
  buffer_load_dwordx4 a[116:119], v35, s[44:47], s67 offen offset:2048 sc1
  v_cvt_pk_bf16_f32 v64, v180, v181
  v_cvt_pk_bf16_f32 v65, v182, v183
  v_cvt_pk_bf16_f32 v66, v200, v201
  v_cvt_pk_bf16_f32 v67, v202, v203
  ds_write_b128 v8, v[64:67] offset:6144
  buffer_load_dwordx4 a[132:135], v35, s[44:47], s67 offen offset:3072 sc1
  s_add_u32 s67, s67, 4096
  v_cvt_pk_bf16_f32 v68, v184, v185
  v_cvt_pk_bf16_f32 v69, v186, v187
  v_cvt_pk_bf16_f32 v70, v204, v205
  v_cvt_pk_bf16_f32 v71, v206, v207
  ds_write_b128 v8, v[68:71] offset:7168
  buffer_load_dwordx4 a[148:151], v35, s[44:47], s67 offen sc1
  v_cvt_pk_bf16_f32 v40, v188, v189
  v_cvt_pk_bf16_f32 v41, v190, v191
  v_cvt_pk_bf16_f32 v42, v208, v209
  v_cvt_pk_bf16_f32 v43, v210, v211
  ds_write_b128 v8, v[40:43] offset:8192
  s_mul_i32 s67, s43, 5120
  buffer_load_dwordx4 a[88:91], v35, s[44:47], s67 offen offset:0 sc1
  v_cvt_pk_bf16_f32 v44, v192, v193
  v_cvt_pk_bf16_f32 v45, v194, v195
  v_cvt_pk_bf16_f32 v46, v212, v213
  v_cvt_pk_bf16_f32 v47, v214, v215
  ds_write_b128 v8, v[44:47] offset:9216
  buffer_load_dwordx4 a[104:107], v35, s[44:47], s67 offen offset:1024 sc1
  buffer_load_dwordx4 a[120:123], v35, s[44:47], s67 offen offset:2048 sc1
  v_cvt_pk_bf16_f32 v48, v216, v217
  v_cvt_pk_bf16_f32 v49, v218, v219
  v_cvt_pk_bf16_f32 v50, v236, v237
  v_cvt_pk_bf16_f32 v51, v238, v239
  ds_write_b128 v8, v[48:51] offset:10240
  buffer_load_dwordx4 a[136:139], v35, s[44:47], s67 offen offset:3072 sc1
  s_add_u32 s67, s67, 4096
  v_cvt_pk_bf16_f32 v52, v220, v221
  v_cvt_pk_bf16_f32 v53, v222, v223
  v_cvt_pk_bf16_f32 v54, v240, v241
  v_cvt_pk_bf16_f32 v55, v242, v243
  ds_write_b128 v8, v[52:55] offset:11264
  buffer_load_dwordx4 a[152:155], v35, s[44:47], s67 offen sc1
  s_mul_i32 s67, s3, 5120
  v_cvt_pk_bf16_f32 v56, v224, v225
  v_cvt_pk_bf16_f32 v57, v226, v227
  v_cvt_pk_bf16_f32 v58, v244, v245
  v_cvt_pk_bf16_f32 v59, v246, v247
  ds_write_b128 v8, v[56:59] offset:12288
  buffer_load_dwordx4 a[92:95], v35, s[44:47], s67 offen offset:0 sc1
  buffer_load_dwordx4 a[108:111], v35, s[44:47], s67 offen offset:1024 sc1
  v_cvt_pk_bf16_f32 v60, v228, v229
  v_cvt_pk_bf16_f32 v61, v230, v231
  v_cvt_pk_bf16_f32 v62, v248, v249
  v_cvt_pk_bf16_f32 v63, v250, v251
  ds_write_b128 v8, v[60:63] offset:13312
  buffer_load_dwordx4 a[124:127], v35, s[44:47], s67 offen offset:2048 sc1
  buffer_load_dwordx4 a[140:143], v35, s[44:47], s67 offen offset:3072 sc1
  v_cvt_pk_bf16_f32 v64, v232, v233
  v_cvt_pk_bf16_f32 v65, v234, v235
  v_cvt_pk_bf16_f32 v66, v252, v253
  v_cvt_pk_bf16_f32 v67, v254, v255
  ds_write_b128 v8, v[64:67] offset:14336
  s_add_u32 s67, s67, 4096
  buffer_load_dwordx4 a[156:159], v35, s[44:47], s67 offen sc1
  s_sub_u32 s65, s34, 1
  s_and_b32 s65, s65, 3
  s_mul_i32 s65, s65, 40960
  s_add_u32 s65, s65, 24576
  v_add_u32 v1, s65, v35
  s_sub_u32 s65, s34, 2
  s_and_b32 s65, s65, 3
  s_mul_i32 s65, s65, 40960
  s_add_u32 s65, s65, 29696
  v_add_u32 v8, s65, v35
  s_sub_u32 s65, s34, 3
  s_and_b32 s65, s65, 3
  s_mul_i32 s65, s65, 40960
  s_add_u32 s65, s65, 34816
  v_add_u32 v9, s65, v35
  v_mov_b32 v2, 0
  v_mov_b32 v3, 0
  v_accvgpr_read_b32 v4, a248
  v_accvgpr_read_b32 v5, a249
  v_mov_b32 v6, 0
  v_mov_b32 v7, 0
  s_waitcnt lgkmcnt(0)
  s_barrier
  ds_read_b128 a[160:163], v1 offset:0
  ds_read_b128 a[164:167], v1 offset:1024
  ds_read_b128 a[168:171], v1 offset:2048
  ds_read_b128 a[172:175], v1 offset:3072
  ds_read_b128 a[176:179], v1 offset:4096
  ds_read_b128 a[180:183], v8 offset:0
  ds_read_b128 a[184:187], v8 offset:1024
  ds_read_b128 a[188:191], v8 offset:2048
  ds_read_b128 a[192:195], v8 offset:3072
  ds_read_b128 a[196:199], v8 offset:4096
  ds_read_b128 a[200:203], v9 offset:0
  ds_read_b128 a[204:207], v9 offset:1024
  ds_read_b128 a[208:211], v9 offset:2048
  ds_read_b128 a[212:215], v9 offset:3072
  ds_read_b128 a[216:219], v9 offset:4096
  s_waitcnt lgkmcnt(10)
  v_mfma_f32_16x16x32_bf16 v[96:99], v[4:7], a[160:163], v[96:99]
  v_mfma_f32_16x16x32_bf16 v[116:119], v[2:5], a[160:163], v[116:119]
  v_mfma_f32_16x16x32_bf16 v[100:103], v[4:7], a[164:167], v[100:103]
  v_mfma_f32_16x16x32_bf16 v[120:123], v[2:5], a[164:167], v[120:123]
  v_mfma_f32_16x16x32_bf16 v[104:107], v[4:7], a[168:171], v[104:107]
  v_mfma_f32_16x16x32_bf16 v[124:127], v[2:5], a[168:171], v[124:127]
  v_mfma_f32_16x16x32_bf16 v[108:111], v[4:7], a[172:175], v[108:111]
  v_mfma_f32_16x16x32_bf16 v[128:131], v[2:5], a[172:175], v[128:131]
  v_mfma_f32_16x16x32_bf16 v[112:115], v[4:7], a[176:179], v[112:115]
  v_mfma_f32_16x16x32_bf16 v[132:135], v[2:5], a[176:179], v[132:135]
  s_waitcnt lgkmcnt(5)
  v_mfma_f32_16x16x32_bf16 v[96:99], v[4:7], a[180:183], v[96:99]
  v_mfma_f32_16x16x32_bf16 v[116:119], v[2:5], a[180:183], v[116:119]
  v_mfma_f32_16x16x32_bf16 v[100:103], v[4:7], a[184:187], v[100:103]
  v_mfma_f32_16x16x32_bf16 v[120:123], v[2:5], a[184:187], v[120:123]
  v_mfma_f32_16x16x32_bf16 v[104:107], v[4:7], a[188:191], v[104:107]
  v_mfma_f32_16x16x32_bf16 v[124:127], v[2:5], a[188:191], v[124:127]
  v_mfma_f32_16x16x32_bf16 v[108:111], v[4:7], a[192:195], v[108:111]
  v_mfma_f32_16x16x32_bf16 v[128:131], v[2:5], a[192:195], v[128:131]
  v_mfma_f32_16x16x32_bf16 v[112:115], v[4:7], a[196:199], v[112:115]
  v_mfma_f32_16x16x32_bf16 v[132:135], v[2:5], a[196:199], v[132:135]
  s_waitcnt lgkmcnt(0)
  v_mfma_f32_16x16x32_bf16 v[96:99], v[4:7], a[200:203], v[96:99]
  v_mfma_f32_16x16x32_bf16 v[116:119], v[2:5], a[200:203], v[116:119]
  v_mfma_f32_16x16x32_bf16 v[100:103], v[4:7], a[204:207], v[100:103]
  v_mfma_f32_16x16x32_bf16 v[120:123], v[2:5], a[204:207], v[120:123]
  v_mfma_f32_16x16x32_bf16 v[104:107], v[4:7], a[208:211], v[104:107]
  v_mfma_f32_16x16x32_bf16 v[124:127], v[2:5], a[208:211], v[124:127]
  v_mfma_f32_16x16x32_bf16 v[108:111], v[4:7], a[212:215], v[108:111]
  v_mfma_f32_16x16x32_bf16 v[128:131], v[2:5], a[212:215], v[128:131]
  v_mfma_f32_16x16x32_bf16 v[112:115], v[4:7], a[216:219], v[112:115]
  v_mfma_f32_16x16x32_bf16 v[132:135], v[2:5], a[216:219], v[132:135]
  s_nop 7
  v_cvt_pk_bf16_f32 v64, v96, v97
  v_cvt_pk_bf16_f32 v65, v98, v99
  v_cvt_pk_bf16_f32 v66, v116, v117
  v_cvt_pk_bf16_f32 v67, v118, v119
  v_cvt_pk_bf16_f32 v68, v100, v101
  v_cvt_pk_bf16_f32 v69, v102, v103
  v_cvt_pk_bf16_f32 v70, v120, v121
  v_cvt_pk_bf16_f32 v71, v122, v123
  v_cvt_pk_bf16_f32 v72, v104, v105
  v_cvt_pk_bf16_f32 v73, v106, v107
  v_cvt_pk_bf16_f32 v74, v124, v125
  v_cvt_pk_bf16_f32 v75, v126, v127
  v_cvt_pk_bf16_f32 v76, v108, v109
  v_cvt_pk_bf16_f32 v77, v110, v111
  v_cvt_pk_bf16_f32 v78, v128, v129
  v_cvt_pk_bf16_f32 v79, v130, v131
  v_cvt_pk_bf16_f32 v80, v112, v113
  v_cvt_pk_bf16_f32 v81, v114, v115
  v_cvt_pk_bf16_f32 v82, v132, v133
  v_cvt_pk_bf16_f32 v83, v134, v135
  s_mul_i32 s65, s34, 5120
  buffer_store_dwordx4 v[64:67], v35, s[52:55], s65 offen offset:0 sc1
  buffer_store_dwordx4 v[68:71], v35, s[52:55], s65 offen offset:1024 sc1
  buffer_store_dwordx4 v[72:75], v35, s[52:55], s65 offen offset:2048 sc1
  buffer_store_dwordx4 v[76:79], v35, s[52:55], s65 offen offset:3072 sc1
  s_add_u32 s65, s65, 4096
  buffer_store_dwordx4 v[80:83], v35, s[52:55], s65 offen sc1
  s_barrier
  s_lshl_b32 s98, s3, 15
  s_add_u32 m0, s64, 24576
  s_add_u32 s68, s98, 0
  buffer_load_dwordx4 v36, s[48:51], s68 offen lds
  s_add_u32 m0, s64, 25600
  s_add_u32 s68, s98, 4096
  buffer_load_dwordx4 v37, s[48:51], s68 offen lds
  s_add_u32 m0, s64, 26624
  s_add_u32 s68, s98, 8192
  buffer_load_dwordx4 v36, s[48:51], s68 offen lds
  s_add_u32 m0, s64, 27648
  s_add_u32 s68, s98, 12288
  buffer_load_dwordx4 v37, s[48:51], s68 offen lds
  s_add_u32 m0, s64, 28672
  s_add_u32 s68, s98, 16384
  buffer_load_dwordx4 v36, s[48:51], s68 offen lds
  s_add_u32 m0, s64, 29696
  s_add_u32 s68, s98, 20480
  buffer_load_dwordx4 v37, s[48:51], s68 offen lds
  s_add_u32 m0, s64, 30720
  s_add_u32 s68, s98, 24576
  buffer_load_dwordx4 v36, s[48:51], s68 offen lds
  s_add_u32 m0, s64, 31744
  s_add_u32 s68, s98, 28672
  buffer_load_dwordx4 v37, s[48:51], s68 offen lds
  s_waitcnt vmcnt(13)
  ds_read_b64_tr_b16 a[192:193], v14 offset:0
  ds_read_b64_tr_b16 a[194:195], v14 offset:4096
  ds_read_b64_tr_b16 a[196:197], v15 offset:0
  ds_read_b64_tr_b16 a[198:199], v15 offset:4096
  ds_read_b64_tr_b16 a[200:201], v16 offset:0
  ds_read_b64_tr_b16 a[202:203], v16 offset:4096
  ds_read_b64_tr_b16 a[204:205], v17 offset:0
  ds_read_b64_tr_b16 a[206:207], v17 offset:4096
  ds_read_b64_tr_b16 a[208:209], v18 offset:0
  ds_read_b64_tr_b16 a[210:211], v18 offset:4096
  ds_read_b64_tr_b16 a[212:213], v19 offset:0
  ds_read_b64_tr_b16 a[214:215], v19 offset:4096
  ds_read_b64_tr_b16 a[216:217], v20 offset:0
  ds_read_b64_tr_b16 a[218:219], v20 offset:4096
  ds_read_b64_tr_b16 a[220:221], v21 offset:0
  ds_read_b64_tr_b16 a[222:223], v21 offset:4096
  s_waitcnt lgkmcnt(0)
  v_mfma_f32_16x16x32_bf16 v[96:99], a[192:195], a[80:83], 0
  v_mfma_f32_16x16x32_bf16 v[100:103], a[192:195], a[96:99], 0
  v_mfma_f32_16x16x32_bf16 v[104:107], a[192:195], a[112:115], 0
  v_mfma_f32_16x16x32_bf16 v[108:111], a[192:195], a[128:131], 0
  v_mfma_f32_16x16x32_bf16 v[112:115], a[192:195], a[144:147], 0
  v_mfma_f32_16x16x32_bf16 v[116:119], a[196:199], a[80:83], 0
  v_mfma_f32_16x16x32_bf16 v[120:123], a[196:199], a[96:99], 0
  v_mfma_f32_16x16x32_bf16 v[124:127], a[196:199], a[112:115], 0
  v_mfma_f32_16x16x32_bf16 v[128:131], a[196:199], a[128:131], 0
  v_mfma_f32_16x16x32_bf16 v[132:135], a[196:199], a[144:147], 0
  v_mfma_f32_16x16x32_bf16 v[136:139], a[200:203], a[80:83], 0
  v_mfma_f32_16x16x32_bf16 v[140:143], a[200:203], a[96:99], 0
  v_mfma_f32_16x16x32_bf16 v[144:147], a[200:203], a[112:115], 0
  v_mfma_f32_16x16x32_bf16 v[148:151], a[200:203], a[128:131], 0
  v_mfma_f32_16x16x32_bf16 v[152:155], a[200:203], a[144:147], 0
  v_mfma_f32_16x16x32_bf16 v[156:159], a[204:207], a[80:83], 0
  v_mfma_f32_16x16x32_bf16 v[160:163], a[204:207], a[96:99], 0
  v_mfma_f32_16x16x32_bf16 v[164:167], a[204:207], a[112:115], 0
  v_mfma_f32_16x16x32_bf16 v[168:171], a[204:207], a[128:131], 0
  v_mfma_f32_16x16x32_bf16 v[172:175], a[204:207], a[144:147], 0
  s_waitcnt vmcnt(63)
  v_mfma_f32_16x16x32_bf16 v[176:179], a[208:211], a[80:83], 0
  ds_read_b64_tr_b16 a[160:161], v14 offset:8192
  v_mfma_f32_16x16x32_bf16 v[180:183], a[208:211], a[96:99], 0
  ds_read_b64_tr_b16 a[162:163], v14 offset:12288
  v_mfma_f32_16x16x32_bf16 v[184:187], a[208:211], a[112:115], 0
  ds_read_b64_tr_b16 a[164:165], v15 offset:8192
  v_mfma_f32_16x16x32_bf16 v[188:191], a[208:211], a[128:131], 0
  ds_read_b64_tr_b16 a[166:167], v15 offset:12288
  v_mfma_f32_16x16x32_bf16 v[192:195], a[208:211], a[144:147], 0
  v_mfma_f32_16x16x32_bf16 v[196:199], a[212:215], a[80:83], 0
  ds_read_b64_tr_b16 a[168:169], v16 offset:8192
  v_mfma_f32_16x16x32_bf16 v[200:203], a[212:215], a[96:99], 0
  ds_read_b64_tr_b16 a[170:171], v16 offset:12288
  v_mfma_f32_16x16x32_bf16 v[204:207], a[212:215], a[112:115], 0
  ds_read_b64_tr_b16 a[172:173], v17 offset:8192
  v_mfma_f32_16x16x32_bf16 v[208:211], a[212:215], a[128:131], 0
  ds_read_b64_tr_b16 a[174:175], v17 offset:12288
  v_mfma_f32_16x16x32_bf16 v[212:215], a[212:215], a[144:147], 0
  v_mfma_f32_16x16x32_bf16 v[216:219], a[216:219], a[80:83], 0
  ds_read_b64_tr_b16 a[176:177], v18 offset:8192
  v_mfma_f32_16x16x32_bf16 v[220:223], a[216:219], a[96:99], 0
  ds_read_b64_tr_b16 a[178:179], v18 offset:12288
  v_mfma_f32_16x16x32_bf16 v[224:227], a[216:219], a[112:115], 0
  ds_read_b64_tr_b16 a[180:181], v19 offset:8192
  v_mfma_f32_16x16x32_bf16 v[228:231], a[216:219], a[128:131], 0
  ds_read_b64_tr_b16 a[182:183], v19 offset:12288
  v_mfma_f32_16x16x32_bf16 v[232:235], a[216:219], a[144:147], 0
  v_mfma_f32_16x16x32_bf16 v[236:239], a[220:223], a[80:83], 0
  ds_read_b64_tr_b16 a[184:185], v20 offset:8192
  v_mfma_f32_16x16x32_bf16 v[240:243], a[220:223], a[96:99], 0
  ds_read_b64_tr_b16 a[186:187], v20 offset:12288
  v_mfma_f32_16x16x32_bf16 v[244:247], a[220:223], a[112:115], 0
  ds_read_b64_tr_b16 a[188:189], v21 offset:8192
  v_mfma_f32_16x16x32_bf16 v[248:251], a[220:223], a[128:131], 0
  ds_read_b64_tr_b16 a[190:191], v21 offset:12288
  v_mfma_f32_16x16x32_bf16 v[252:255], a[220:223], a[144:147], 0
  s_waitcnt lgkmcnt(0)
  v_mfma_f32_16x16x32_bf16 v[96:99], a[160:163], a[84:87], v[96:99]
  v_mfma_f32_16x16x32_bf16 v[100:103], a[160:163], a[100:103], v[100:103]
  v_mfma_f32_16x16x32_bf16 v[104:107], a[160:163], a[116:119], v[104:107]
  v_mfma_f32_16x16x32_bf16 v[108:111], a[160:163], a[132:135], v[108:111]
  v_mfma_f32_16x16x32_bf16 v[112:115], a[160:163], a[148:151], v[112:115]
  v_mfma_f32_16x16x32_bf16 v[116:119], a[164:167], a[84:87], v[116:119]
  v_mfma_f32_16x16x32_bf16 v[120:123], a[164:167], a[100:103], v[120:123]
  v_mfma_f32_16x16x32_bf16 v[124:127], a[164:167], a[116:119], v[124:127]
  v_mfma_f32_16x16x32_bf16 v[128:131], a[164:167], a[132:135], v[128:131]
  v_mfma_f32_16x16x32_bf16 v[132:135], a[164:167], a[148:151], v[132:135]
  v_mfma_f32_16x16x32_bf16 v[136:139], a[168:171], a[84:87], v[136:139]
  v_mfma_f32_16x16x32_bf16 v[140:143], a[168:171], a[100:103], v[140:143]
  v_mfma_f32_16x16x32_bf16 v[144:147], a[168:171], a[116:119], v[144:147]
  v_mfma_f32_16x16x32_bf16 v[148:151], a[168:171], a[132:135], v[148:151]
  v_mfma_f32_16x16x32_bf16 v[152:155], a[168:171], a[148:151], v[152:155]
  v_mfma_f32_16x16x32_bf16 v[156:159], a[172:175], a[84:87], v[156:159]
  v_mfma_f32_16x16x32_bf16 v[160:163], a[172:175], a[100:103], v[160:163]
  v_mfma_f32_16x16x32_bf16 v[164:167], a[172:175], a[116:119], v[164:167]
  v_mfma_f32_16x16x32_bf16 v[168:171], a[172:175], a[132:135], v[168:171]
  v_mfma_f32_16x16x32_bf16 v[172:175], a[172:175], a[148:151], v[172:175]
  s_waitcnt vmcnt(63)
  v_mfma_f32_16x16x32_bf16 v[176:179], a[176:179], a[84:87], v[176:179]
  ds_read_b64_tr_b16 a[192:193], v14 offset:16384
  v_mfma_f32_16x16x32_bf16 v[180:183], a[176:179], a[100:103], v[180:183]
  ds_read_b64_tr_b16 a[194:195], v14 offset:20480
  v_mfma_f32_16x16x32_bf16 v[184:187], a[176:179], a[116:119], v[184:187]
  ds_read_b64_tr_b16 a[196:197], v15 offset:16384
  v_mfma_f32_16x16x32_bf16 v[188:191], a[176:179], a[132:135], v[188:191]
  ds_read_b64_tr_b16 a[198:199], v15 offset:20480
  v_mfma_f32_16x16x32_bf16 v[192:195], a[176:179], a[148:151], v[192:195]
  v_mfma_f32_16x16x32_bf16 v[196:199], a[180:183], a[84:87], v[196:199]
  ds_read_b64_tr_b16 a[200:201], v16 offset:16384
  v_mfma_f32_16x16x32_bf16 v[200:203], a[180:183], a[100:103], v[200:203]
  ds_read_b64_tr_b16 a[202:203], v16 offset:20480
  v_mfma_f32_16x16x32_bf16 v[204:207], a[180:183], a[116:119], v[204:207]
  ds_read_b64_tr_b16 a[204:205], v17 offset:16384
  v_mfma_f32_16x16x32_bf16 v[208:211], a[180:183], a[132:135], v[208:211]
  ds_read_b64_tr_b16 a[206:207], v17 offset:20480
  v_mfma_f32_16x16x32_bf16 v[212:215], a[180:183], a[148:151], v[212:215]
  v_mfma_f32_16x16x32_bf16 v[216:219], a[184:187], a[84:87], v[216:219]
  ds_read_b64_tr_b16 a[208:209], v18 offset:16384
  v_mfma_f32_16x16x32_bf16 v[220:223], a[184:187], a[100:103], v[220:223]
  ds_read_b64_tr_b16 a[210:211], v18 offset:20480
  v_mfma_f32_16x16x32_bf16 v[224:227], a[184:187], a[116:119], v[224:227]
  ds_read_b64_tr_b16 a[212:213], v19 offset:16384
  v_mfma_f32_16x16x32_bf16 v[228:231], a[184:187], a[132:135], v[228:231]
  ds_read_b64_tr_b16 a[214:215], v19 offset:20480
  v_mfma_f32_16x16x32_bf16 v[232:235], a[184:187], a[148:151], v[232:235]
  v_mfma_f32_16x16x32_bf16 v[236:239], a[188:191], a[84:87], v[236:239]
  ds_read_b64_tr_b16 a[216:217], v20 offset:16384
  v_mfma_f32_16x16x32_bf16 v[240:243], a[188:191], a[100:103], v[240:243]
  ds_read_b64_tr_b16 a[218:219], v20 offset:20480
  v_mfma_f32_16x16x32_bf16 v[244:247], a[188:191], a[116:119], v[244:247]
  ds_read_b64_tr_b16 a[220:221], v21 offset:16384
  v_mfma_f32_16x16x32_bf16 v[248:251], a[188:191], a[132:135], v[248:251]
  ds_read_b64_tr_b16 a[222:223], v21 offset:20480
  v_mfma_f32_16x16x32_bf16 v[252:255], a[188:191], a[148:151], v[252:255]
  s_waitcnt lgkmcnt(0)
  v_mfma_f32_16x16x32_bf16 v[96:99], a[192:195], a[88:91], v[96:99]
  v_mfma_f32_16x16x32_bf16 v[100:103], a[192:195], a[104:107], v[100:103]
  v_mfma_f32_16x16x32_bf16 v[104:107], a[192:195], a[120:123], v[104:107]
  v_mfma_f32_16x16x32_bf16 v[108:111], a[192:195], a[136:139], v[108:111]
  v_mfma_f32_16x16x32_bf16 v[112:115], a[192:195], a[152:155], v[112:115]
  v_mfma_f32_16x16x32_bf16 v[116:119], a[196:199], a[88:91], v[116:119]
  v_mfma_f32_16x16x32_bf16 v[120:123], a[196:199], a[104:107], v[120:123]
  v_mfma_f32_16x16x32_bf16 v[124:127], a[196:199], a[120:123], v[124:127]
  v_mfma_f32_16x16x32_bf16 v[128:131], a[196:199], a[136:139], v[128:131]
  v_mfma_f32_16x16x32_bf16 v[132:135], a[196:199], a[152:155], v[132:135]
  v_mfma_f32_16x16x32_bf16 v[136:139], a[200:203], a[88:91], v[136:139]
  v_mfma_f32_16x16x32_bf16 v[140:143], a[200:203], a[104:107], v[140:143]
  v_mfma_f32_16x16x32_bf16 v[144:147], a[200:203], a[120:123], v[144:147]
  v_mfma_f32_16x16x32_bf16 v[148:151], a[200:203], a[136:139], v[148:151]
  v_mfma_f32_16x16x32_bf16 v[152:155], a[200:203], a[152:155], v[152:155]
  v_mfma_f32_16x16x32_bf16 v[156:159], a[204:207], a[88:91], v[156:159]
  v_mfma_f32_16x16x32_bf16 v[160:163], a[204:207], a[104:107], v[160:163]
  v_mfma_f32_16x16x32_bf16 v[164:167], a[204:207], a[120:123], v[164:167]
  v_mfma_f32_16x16x32_bf16 v[168:171], a[204:207], a[136:139], v[168:171]
  v_mfma_f32_16x16x32_bf16 v[172:175], a[204:207], a[152:155], v[172:175]
  s_waitcnt vmcnt(0)
  v_mfma_f32_16x16x32_bf16 v[176:179], a[208:211], a[88:91], v[176:179]
  ds_read_b64_tr_b16 a[160:161], v14 offset:24576
  v_mfma_f32_16x16x32_bf16 v[180:183], a[208:211], a[104:107], v[180:183]
  ds_read_b64_tr_b16 a[162:163], v14 offset:28672
  v_mfma_f32_16x16x32_bf16 v[184:187], a[208:211], a[120:123], v[184:187]
  ds_read_b64_tr_b16 a[164:165], v15 offset:24576
  v_mfma_f32_16x16x32_bf16 v[188:191], a[208:211], a[136:139], v[188:191]
  ds_read_b64_tr_b16 a[166:167], v15 offset:28672
  v_mfma_f32_16x16x32_bf16 v[192:195], a[208:211], a[152:155], v[192:195]
  v_mfma_f32_16x16x32_bf16 v[196:199], a[212:215], a[88:91], v[196:199]
  ds_read_b64_tr_b16 a[168:169], v16 offset:24576
  v_mfma_f32_16x16x32_bf16 v[200:203], a[212:215], a[104:107], v[200:203]
  ds_read_b64_tr_b16 a[170:171], v16 offset:28672
  v_mfma_f32_16x16x32_bf16 v[204:207], a[212:215], a[120:123], v[204:207]
  ds_read_b64_tr_b16 a[172:173], v17 offset:24576
  v_mfma_f32_16x16x32_bf16 v[208:211], a[212:215], a[136:139], v[208:211]
  ds_read_b64_tr_b16 a[174:175], v17 offset:28672
  v_mfma_f32_16x16x32_bf16 v[212:215], a[212:215], a[152:155], v[212:215]
  v_mfma_f32_16x16x32_bf16 v[216:219], a[216:219], a[88:91], v[216:219]
  ds_read_b64_tr_b16 a[176:177], v18 offset:24576
  v_mfma_f32_16x16x32_bf16 v[220:223], a[216:219], a[104:107], v[220:223]
  ds_read_b64_tr_b16 a[178:179], v18 offset:28672
  v_mfma_f32_16x16x32_bf16 v[224:227], a[216:219], a[120:123], v[224:227]
  ds_read_b64_tr_b16 a[180:181], v19 offset:24576
  v_mfma_f32_16x16x32_bf16 v[228:231], a[216:219], a[136:139], v[228:231]
  ds_read_b64_tr_b16 a[182:183], v19 offset:28672
  v_mfma_f32_16x16x32_bf16 v[232:235], a[216:219], a[152:155], v[232:235]
  v_mfma_f32_16x16x32_bf16 v[236:239], a[220:223], a[88:91], v[236:239]
  ds_read_b64_tr_b16 a[184:185], v20 offset:24576
  v_mfma_f32_16x16x32_bf16 v[240:243], a[220:223], a[104:107], v[240:243]
  ds_read_b64_tr_b16 a[186:187], v20 offset:28672
  v_mfma_f32_16x16x32_bf16 v[244:247], a[220:223], a[120:123], v[244:247]
  ds_read_b64_tr_b16 a[188:189], v21 offset:24576
  v_mfma_f32_16x16x32_bf16 v[248:251], a[220:223], a[136:139], v[248:251]
  ds_read_b64_tr_b16 a[190:191], v21 offset:28672
  v_mfma_f32_16x16x32_bf16 v[252:255], a[220:223], a[152:155], v[252:255]
  s_waitcnt lgkmcnt(0)
  v_mfma_f32_16x16x32_bf16 v[96:99], a[160:163], a[92:95], v[96:99]
  v_mfma_f32_16x16x32_bf16 v[100:103], a[160:163], a[108:111], v[100:103]
  v_mfma_f32_16x16x32_bf16 v[104:107], a[160:163], a[124:127], v[104:107]
  v_mfma_f32_16x16x32_bf16 v[108:111], a[160:163], a[140:143], v[108:111]
  v_mfma_f32_16x16x32_bf16 v[112:115], a[160:163], a[156:159], v[112:115]
  v_mfma_f32_16x16x32_bf16 v[116:119], a[164:167], a[92:95], v[116:119]
  v_mfma_f32_16x16x32_bf16 v[120:123], a[164:167], a[108:111], v[120:123]
  v_mfma_f32_16x16x32_bf16 v[124:127], a[164:167], a[124:127], v[124:127]
  v_mfma_f32_16x16x32_bf16 v[128:131], a[164:167], a[140:143], v[128:131]
  v_mfma_f32_16x16x32_bf16 v[132:135], a[164:167], a[156:159], v[132:135]
  v_mfma_f32_16x16x32_bf16 v[136:139], a[168:171], a[92:95], v[136:139]
  v_mfma_f32_16x16x32_bf16 v[140:143], a[168:171], a[108:111], v[140:143]
  v_mfma_f32_16x16x32_bf16 v[144:147], a[168:171], a[124:127], v[144:147]
  v_mfma_f32_16x16x32_bf16 v[148:151], a[168:171], a[140:143], v[148:151]
  v_mfma_f32_16x16x32_bf16 v[152:155], a[168:171], a[156:159], v[152:155]
  v_mfma_f32_16x16x32_bf16 v[156:159], a[172:175], a[92:95], v[156:159]
  v_mfma_f32_16x16x32_bf16 v[160:163], a[172:175], a[108:111], v[160:163]
  v_mfma_f32_16x16x32_bf16 v[164:167], a[172:175], a[124:127], v[164:167]
  v_mfma_f32_16x16x32_bf16 v[168:171], a[172:175], a[140:143], v[168:171]
  v_mfma_f32_16x16x32_bf16 v[172:175], a[172:175], a[156:159], v[172:175]
  v_mfma_f32_16x16x32_bf16 v[176:179], a[176:179], a[92:95], v[176:179]
  v_mfma_f32_16x16x32_bf16 v[180:183], a[176:179], a[108:111], v[180:183]
  v_mfma_f32_16x16x32_bf16 v[184:187], a[176:179], a[124:127], v[184:187]
  v_mfma_f32_16x16x32_bf16 v[188:191], a[176:179], a[140:143], v[188:191]
  v_mfma_f32_16x16x32_bf16 v[192:195], a[176:179], a[156:159], v[192:195]
  v_mfma_f32_16x16x32_bf16 v[196:199], a[180:183], a[92:95], v[196:199]
  v_mfma_f32_16x16x32_bf16 v[200:203], a[180:183], a[108:111], v[200:203]
  v_mfma_f32_16x16x32_bf16 v[204:207], a[180:183], a[124:127], v[204:207]
  v_mfma_f32_16x16x32_bf16 v[208:211], a[180:183], a[140:143], v[208:211]
  v_mfma_f32_16x16x32_bf16 v[212:215], a[180:183], a[156:159], v[212:215]
  v_mfma_f32_16x16x32_bf16 v[216:219], a[184:187], a[92:95], v[216:219]
  v_mfma_f32_16x16x32_bf16 v[220:223], a[184:187], a[108:111], v[220:223]
  v_mfma_f32_16x16x32_bf16 v[224:227], a[184:187], a[124:127], v[224:227]
  v_mfma_f32_16x16x32_bf16 v[228:231], a[184:187], a[140:143], v[228:231]
  v_mfma_f32_16x16x32_bf16 v[232:235], a[184:187], a[156:159], v[232:235]
  v_mfma_f32_16x16x32_bf16 v[236:239], a[188:191], a[92:95], v[236:239]
  v_mfma_f32_16x16x32_bf16 v[240:243], a[188:191], a[108:111], v[240:243]
  v_mfma_f32_16x16x32_bf16 v[244:247], a[188:191], a[124:127], v[244:247]
  v_mfma_f32_16x16x32_bf16 v[248:251], a[188:191], a[140:143], v[248:251]
  v_mfma_f32_16x16x32_bf16 v[252:255], a[188:191], a[156:159], v[252:255]
  s_nop 7
  s_lshl_b32 s65, s100, 7
  s_add_u32 s65, s65, 33554464
  s_lshl_b32 s66, s34, 2
  s_add_u32 s65, s65, s66
  v_mov_b32 v6, 1
  v_mov_b32 v7, s65
  v_cmp_eq_u32 vcc, 0, v0
  s_and_saveexec_b64 s[94:95], vcc
  buffer_store_dword v6, v7, s[4:7], 0 offen sc1
  s_mov_b64 exec, s[94:95]
  s_add_u32 s65, s64, 24576
  v_add_u32 v8, s65, v35
  v_cvt_pk_bf16_f32 v40, v136, v137
  v_cvt_pk_bf16_f32 v41, v138, v139
  v_cvt_pk_bf16_f32 v42, v156, v157
  v_cvt_pk_bf16_f32 v43, v158, v159
  ds_write_b128 v8, v[40:43] offset:0
  v_cvt_pk_bf16_f32 v44, v140, v141
  v_cvt_pk_bf16_f32 v45, v142, v143
  v_cvt_pk_bf16_f32 v46, v160, v161
  v_cvt_pk_bf16_f32 v47, v162, v163
  ds_write_b128 v8, v[44:47] offset:1024
  v_cvt_pk_bf16_f32 v48, v144, v145
  v_cvt_pk_bf16_f32 v49, v146, v147
  v_cvt_pk_bf16_f32 v50, v164, v165
  v_cvt_pk_bf16_f32 v51, v166, v167
  ds_write_b128 v8, v[48:51] offset:2048
  v_cvt_pk_bf16_f32 v52, v148, v149
  v_cvt_pk_bf16_f32 v53, v150, v151
  v_cvt_pk_bf16_f32 v54, v168, v169
  v_cvt_pk_bf16_f32 v55, v170, v171
  ds_write_b128 v8, v[52:55] offset:3072
  v_cvt_pk_bf16_f32 v56, v152, v153
  v_cvt_pk_bf16_f32 v57, v154, v155
  v_cvt_pk_bf16_f32 v58, v172, v173
  v_cvt_pk_bf16_f32 v59, v174, v175
  ds_write_b128 v8, v[56:59] offset:4096
  v_cvt_pk_bf16_f32 v60, v176, v177
  v_cvt_pk_bf16_f32 v61, v178, v179
  v_cvt_pk_bf16_f32 v62, v196, v197
  v_cvt_pk_bf16_f32 v63, v198, v199
  ds_write_b128 v8, v[60:63] offset:5120
  v_cvt_pk_bf16_f32 v64, v180, v181
  v_cvt_pk_bf16_f32 v65, v182, v183
  v_cvt_pk_bf16_f32 v66, v200, v201
  v_cvt_pk_bf16_f32 v67, v202, v203
  ds_write_b128 v8, v[64:67] offset:6144
  v_cvt_pk_bf16_f32 v68, v184, v185
  v_cvt_pk_bf16_f32 v69, v186, v187
  v_cvt_pk_bf16_f32 v70, v204, v205
  v_cvt_pk_bf16_f32 v71, v206, v207
  ds_write_b128 v8, v[68:71] offset:7168
  v_cvt_pk_bf16_f32 v40, v188, v189
  v_cvt_pk_bf16_f32 v41, v190, v191
  v_cvt_pk_bf16_f32 v42, v208, v209
  v_cvt_pk_bf16_f32 v43, v210, v211
  ds_write_b128 v8, v[40:43] offset:8192
  v_cvt_pk_bf16_f32 v44, v192, v193
  v_cvt_pk_bf16_f32 v45, v194, v195
  v_cvt_pk_bf16_f32 v46, v212, v213
  v_cvt_pk_bf16_f32 v47, v214, v215
  ds_write_b128 v8, v[44:47] offset:9216
  v_cvt_pk_bf16_f32 v48, v216, v217
  v_cvt_pk_bf16_f32 v49, v218, v219
  v_cvt_pk_bf16_f32 v50, v236, v237
  v_cvt_pk_bf16_f32 v51, v238, v239
  ds_write_b128 v8, v[48:51] offset:10240
  v_cvt_pk_bf16_f32 v52, v220, v221
  v_cvt_pk_bf16_f32 v53, v222, v223
  v_cvt_pk_bf16_f32 v54, v240, v241
  v_cvt_pk_bf16_f32 v55, v242, v243
  ds_write_b128 v8, v[52:55] offset:11264
  v_cvt_pk_bf16_f32 v56, v224, v225
  v_cvt_pk_bf16_f32 v57, v226, v227
  v_cvt_pk_bf16_f32 v58, v244, v245
  v_cvt_pk_bf16_f32 v59, v246, v247
  ds_write_b128 v8, v[56:59] offset:12288
  v_cvt_pk_bf16_f32 v60, v228, v229
  v_cvt_pk_bf16_f32 v61, v230, v231
  v_cvt_pk_bf16_f32 v62, v248, v249
  v_cvt_pk_bf16_f32 v63, v250, v251
  ds_write_b128 v8, v[60:63] offset:13312
  v_cvt_pk_bf16_f32 v64, v232, v233
  v_cvt_pk_bf16_f32 v65, v234, v235
  v_cvt_pk_bf16_f32 v66, v252, v253
  v_cvt_pk_bf16_f32 v67, v254, v255
  ds_write_b128 v8, v[64:67] offset:14336
  s_sub_u32 s65, s34, 1
  s_and_b32 s65, s65, 3
  s_mul_i32 s65, s65, 40960
  s_add_u32 s65, s65, 24576
  v_add_u32 v1, s65, v35
  s_sub_u32 s65, s34, 2
  s_and_b32 s65, s65, 3
  s_mul_i32 s65, s65, 40960
  s_add_u32 s65, s65, 29696
  v_add_u32 v8, s65, v35
  s_sub_u32 s65, s34, 3
  s_and_b32 s65, s65, 3
  s_mul_i32 s65, s65, 40960
  s_add_u32 s65, s65, 34816
  v_add_u32 v9, s65, v35
  v_mov_b32 v2, 0
  v_mov_b32 v3, 0
  v_accvgpr_read_b32 v4, a248
  v_accvgpr_read_b32 v5, a249
  v_mov_b32 v6, 0
  v_mov_b32 v7, 0
  s_waitcnt lgkmcnt(0)
  s_barrier
  ds_read_b128 a[160:163], v1 offset:0
  ds_read_b128 a[164:167], v1 offset:1024
  ds_read_b128 a[168:171], v1 offset:2048
  ds_read_b128 a[172:175], v1 offset:3072
  ds_read_b128 a[176:179], v1 offset:4096
  ds_read_b128 a[180:183], v8 offset:0
  ds_read_b128 a[184:187], v8 offset:1024
  ds_read_b128 a[188:191], v8 offset:2048
  ds_read_b128 a[192:195], v8 offset:3072
  ds_read_b128 a[196:199], v8 offset:4096
  ds_read_b128 a[200:203], v9 offset:0
  ds_read_b128 a[204:207], v9 offset:1024
  ds_read_b128 a[208:211], v9 offset:2048
  ds_read_b128 a[212:215], v9 offset:3072
  ds_read_b128 a[216:219], v9 offset:4096
  s_waitcnt lgkmcnt(10)
  v_mfma_f32_16x16x32_bf16 v[96:99], v[4:7], a[160:163], v[96:99]
  v_mfma_f32_16x16x32_bf16 v[116:119], v[2:5], a[160:163], v[116:119]
  v_mfma_f32_16x16x32_bf16 v[100:103], v[4:7], a[164:167], v[100:103]
  v_mfma_f32_16x16x32_bf16 v[120:123], v[2:5], a[164:167], v[120:123]
  v_mfma_f32_16x16x32_bf16 v[104:107], v[4:7], a[168:171], v[104:107]
  v_mfma_f32_16x16x32_bf16 v[124:127], v[2:5], a[168:171], v[124:127]
  v_mfma_f32_16x16x32_bf16 v[108:111], v[4:7], a[172:175], v[108:111]
  v_mfma_f32_16x16x32_bf16 v[128:131], v[2:5], a[172:175], v[128:131]
  v_mfma_f32_16x16x32_bf16 v[112:115], v[4:7], a[176:179], v[112:115]
  v_mfma_f32_16x16x32_bf16 v[132:135], v[2:5], a[176:179], v[132:135]
  s_waitcnt lgkmcnt(5)
  v_mfma_f32_16x16x32_bf16 v[96:99], v[4:7], a[180:183], v[96:99]
  v_mfma_f32_16x16x32_bf16 v[116:119], v[2:5], a[180:183], v[116:119]
  v_mfma_f32_16x16x32_bf16 v[100:103], v[4:7], a[184:187], v[100:103]
  v_mfma_f32_16x16x32_bf16 v[120:123], v[2:5], a[184:187], v[120:123]
  v_mfma_f32_16x16x32_bf16 v[104:107], v[4:7], a[188:191], v[104:107]
  v_mfma_f32_16x16x32_bf16 v[124:127], v[2:5], a[188:191], v[124:127]
  v_mfma_f32_16x16x32_bf16 v[108:111], v[4:7], a[192:195], v[108:111]
  v_mfma_f32_16x16x32_bf16 v[128:131], v[2:5], a[192:195], v[128:131]
  v_mfma_f32_16x16x32_bf16 v[112:115], v[4:7], a[196:199], v[112:115]
  v_mfma_f32_16x16x32_bf16 v[132:135], v[2:5], a[196:199], v[132:135]
  s_waitcnt lgkmcnt(0)
  v_mfma_f32_16x16x32_bf16 v[96:99], v[4:7], a[200:203], v[96:99]
  v_mfma_f32_16x16x32_bf16 v[116:119], v[2:5], a[200:203], v[116:119]
  v_mfma_f32_16x16x32_bf16 v[100:103], v[4:7], a[204:207], v[100:103]
  v_mfma_f32_16x16x32_bf16 v[120:123], v[2:5], a[204:207], v[120:123]
  v_mfma_f32_16x16x32_bf16 v[104:107], v[4:7], a[208:211], v[104:107]
  v_mfma_f32_16x16x32_bf16 v[124:127], v[2:5], a[208:211], v[124:127]
  v_mfma_f32_16x16x32_bf16 v[108:111], v[4:7], a[212:215], v[108:111]
  v_mfma_f32_16x16x32_bf16 v[128:131], v[2:5], a[212:215], v[128:131]
  v_mfma_f32_16x16x32_bf16 v[112:115], v[4:7], a[216:219], v[112:115]
  v_mfma_f32_16x16x32_bf16 v[132:135], v[2:5], a[216:219], v[132:135]
  s_nop 7
  v_cvt_pk_bf16_f32 v64, v96, v97
  v_cvt_pk_bf16_f32 v65, v98, v99
  v_cvt_pk_bf16_f32 v66, v116, v117
  v_cvt_pk_bf16_f32 v67, v118, v119
  v_cvt_pk_bf16_f32 v68, v100, v101
  v_cvt_pk_bf16_f32 v69, v102, v103
  v_cvt_pk_bf16_f32 v70, v120, v121
  v_cvt_pk_bf16_f32 v71, v122, v123
  v_cvt_pk_bf16_f32 v72, v104, v105
  v_cvt_pk_bf16_f32 v73, v106, v107
  v_cvt_pk_bf16_f32 v74, v124, v125
  v_cvt_pk_bf16_f32 v75, v126, v127
  v_cvt_pk_bf16_f32 v76, v108, v109
  v_cvt_pk_bf16_f32 v77, v110, v111
  v_cvt_pk_bf16_f32 v78, v128, v129
  v_cvt_pk_bf16_f32 v79, v130, v131
  v_cvt_pk_bf16_f32 v80, v112, v113
  v_cvt_pk_bf16_f32 v81, v114, v115
  v_cvt_pk_bf16_f32 v82, v132, v133
  v_cvt_pk_bf16_f32 v83, v134, v135
  s_mul_i32 s65, s34, 5120
  buffer_store_dwordx4 v[64:67], v35, s[56:59], s65 offen offset:0 sc1
  buffer_store_dwordx4 v[68:71], v35, s[56:59], s65 offen offset:1024 sc1
  buffer_store_dwordx4 v[72:75], v35, s[56:59], s65 offen offset:2048 sc1
  buffer_store_dwordx4 v[76:79], v35, s[56:59], s65 offen offset:3072 sc1
  s_add_u32 s65, s65, 4096
  buffer_store_dwordx4 v[80:83], v35, s[56:59], s65 offen sc1
  s_lshl_b32 s98, s34, 3
  s_add_u32 s71, s98, s37
  s_mul_i32 s69, s71, 13
  s_lshr_b32 s69, s69, 6
  s_min_u32 s69, s69, 3
  s_cmp_ge_u32 s71, 20
  s_cbranch_scc0 L_s2has
  s_waitcnt vmcnt(0)
  s_lshl_b32 s65, s100, 7
  s_add_u32 s65, s65, 33554480
  s_lshl_b32 s66, s34, 2
  s_add_u32 s65, s65, s66
  v_mov_b32 v6, 1
  v_mov_b32 v7, s65
  v_cmp_eq_u32 vcc, 0, v0
  s_and_saveexec_b64 s[94:95], vcc
  buffer_store_dword v6, v7, s[4:7], 0 offen sc1
  s_mov_b64 exec, s[94:95]
  s_branch L_s2done
L_s2has:
  s_andn2_b32 s65, s100, 7
  s_lshl_b32 s65, s65, 7
  s_lshl_b32 s66, s69, 2
  s_add_u32 s65, s65, s66
  s_add_u32 s65, s65, 33554464
  v_and_b32 v38, 7, v0
  v_lshlrev_b32 v38, 7, v38
  v_add_u32 v38, s65, v38
  s_mov_b32 s73, 1
  s_mov_b32 s99, 0
L_pl_22_sp:
  buffer_load_dword v39, v38, s[4:7], 0 offen sc1
  s_waitcnt vmcnt(0)
  v_cmp_ne_u32 vcc, s73, v39
  s_nop 1
  s_cbranch_vccz L_pl_22_ok
  s_sleep 1
  s_add_u32 s99, s99, 1
  s_cmp_lt_u32 s99, 32768
  s_cbranch_scc1 L_pl_22_sp
L_pl_22_ok:
  s_lshl_b32 s65, s100, 7
  s_add_u32 s65, s65, 33554480
  s_lshl_b32 s66, s34, 2
  s_add_u32 s65, s65, s66
  v_mov_b32 v6, 1
  v_mov_b32 v7, s65
  v_cmp_eq_u32 vcc, 0, v0
  s_and_saveexec_b64 s[94:95], vcc
  buffer_store_dword v6, v7, s[4:7], 0 offen sc1
  s_mov_b64 exec, s[94:95]
  s_lshl_b32 s65, s40, 3
  s_add_u32 s65, s65, s35
  s_lshl_b32 s65, s65, 2
  s_add_u32 s65, s65, s38
  s_mul_i32 s65, s65, 163840
  s_add_u32 s65, s65, 16777216
  s_add_u32 s44, s32, s65
  s_addc_u32 s45, s33, 0
  s_and_b32 s45, s45, 0xffff
  s_mov_b32 s46, 163840
  s_mov_b32 s47, 0x20000
  s_lshl_b32 s66, s71, 10
  buffer_load_dwordx4 v[96:99], v35, s[44:47], s66 offen sc1
  s_add_u32 s66, s66, 20480
  buffer_load_dwordx4 v[100:103], v35, s[44:47], s66 offen sc1
  s_add_u32 s66, s66, 20480
  buffer_load_dwordx4 v[104:107], v35, s[44:47], s66 offen sc1
  s_add_u32 s66, s66, 20480
  buffer_load_dwordx4 v[108:111], v35, s[44:47], s66 offen sc1
  s_add_u32 s66, s66, 20480
  buffer_load_dwordx4 v[112:115], v35, s[44:47], s66 offen sc1
  s_add_u32 s66, s66, 20480
  buffer_load_dwordx4 v[116:119], v35, s[44:47], s66 offen sc1
  s_add_u32 s66, s66, 20480
  buffer_load_dwordx4 v[120:123], v35, s[44:47], s66 offen sc1
  s_add_u32 s66, s66, 20480
  buffer_load_dwordx4 v[124:127], v35, s[44:47], s66 offen sc1
  s_add_u32 s66, s66, 20480
  s_mul_i32 s68, s69, 5
  s_sub_u32 s68, s71, s68
  s_mul_i32 s65, s35, 163840
  s_lshl_b32 s66, s40, 10
  s_add_u32 s65, s65, s66
  s_lshl_b32 s66, s38, 8
  s_add_u32 s65, s65, s66
  s_lshl_b32 s66, s69, 6
  s_add_u32 s65, s65, s66
  s_add_u32 s48, s28, s65
  s_addc_u32 s49, s29, 0
  s_and_b32 s49, s49, 0xffff
  s_mov_b32 s50, 161856
  s_mov_b32 s51, 0x20000
  s_lshl_b32 s68, s68, 15
  v_mov_b32 v128, 0
  v_mov_b32 v129, 0
  v_mov_b32 v130, 0
  v_mov_b32 v131, 0
  v_mov_b32 v132, 0
  v_mov_b32 v133, 0
  v_mov_b32 v134, 0
  v_mov_b32 v135, 0
  s_waitcnt vmcnt(7)
  v_lshlrev_b32 v136, 16, v96
  v_and_b32 v137, 0xffff0000, v96
  v_add_f32 v128, v128, v136
  v_add_f32 v129, v129, v137
  v_lshlrev_b32 v136, 16, v97
  v_and_b32 v137, 0xffff0000, v97
  v_add_f32 v130, v130, v136
  v_add_f32 v131, v131, v137
  v_lshlrev_b32 v136, 16, v98
  v_and_b32 v137, 0xffff0000, v98
  v_add_f32 v132, v132, v136
  v_add_f32 v133, v133, v137
  v_lshlrev_b32 v136, 16, v99
  v_and_b32 v137, 0xffff0000, v99
  v_add_f32 v134, v134, v136
  v_add_f32 v135, v135, v137
  s_waitcnt vmcnt(6)
  v_lshlrev_b32 v136, 16, v100
  v_and_b32 v137, 0xffff0000, v100
  v_add_f32 v128, v128, v136
  v_add_f32 v129, v129, v137
  v_lshlrev_b32 v136, 16, v101
  v_and_b32 v137, 0xffff0000, v101
  v_add_f32 v130, v130, v136
  v_add_f32 v131, v131, v137
  v_lshlrev_b32 v136, 16, v102
  v_and_b32 v137, 0xffff0000, v102
  v_add_f32 v132, v132, v136
  v_add_f32 v133, v133, v137
  v_lshlrev_b32 v136, 16, v103
  v_and_b32 v137, 0xffff0000, v103
  v_add_f32 v134, v134, v136
  v_add_f32 v135, v135, v137
  s_waitcnt vmcnt(5)
  v_lshlrev_b32 v136, 16, v104
  v_and_b32 v137, 0xffff0000, v104
  v_add_f32 v128, v128, v136
  v_add_f32 v129, v129, v137
  v_lshlrev_b32 v136, 16, v105
  v_and_b32 v137, 0xffff0000, v105
  v_add_f32 v130, v130, v136
  v_add_f32 v131, v131, v137
  v_lshlrev_b32 v136, 16, v106
  v_and_b32 v137, 0xffff0000, v106
  v_add_f32 v132, v132, v136
  v_add_f32 v133, v133, v137
  v_lshlrev_b32 v136, 16, v107
  v_and_b32 v137, 0xffff0000, v107
  v_add_f32 v134, v134, v136
  v_add_f32 v135, v135, v137
  s_waitcnt vmcnt(4)
  v_lshlrev_b32 v136, 16, v108
  v_and_b32 v137, 0xffff0000, v108
  v_add_f32 v128, v128, v136
  v_add_f32 v129, v129, v137
  v_lshlrev_b32 v136, 16, v109
  v_and_b32 v137, 0xffff0000, v109
  v_add_f32 v130, v130, v136
  v_add_f32 v131, v131, v137
  v_lshlrev_b32 v136, 16, v110
  v_and_b32 v137, 0xffff0000, v110
  v_add_f32 v132, v132, v136
  v_add_f32 v133, v133, v137
  v_lshlrev_b32 v136, 16, v111
  v_and_b32 v137, 0xffff0000, v111
  v_add_f32 v134, v134, v136
  v_add_f32 v135, v135, v137
  s_waitcnt vmcnt(3)
  v_lshlrev_b32 v136, 16, v112
  v_and_b32 v137, 0xffff0000, v112
  v_add_f32 v128, v128, v136
  v_add_f32 v129, v129, v137
  v_lshlrev_b32 v136, 16, v113
  v_and_b32 v137, 0xffff0000, v113
  v_add_f32 v130, v130, v136
  v_add_f32 v131, v131, v137
  v_lshlrev_b32 v136, 16, v114
  v_and_b32 v137, 0xffff0000, v114
  v_add_f32 v132, v132, v136
  v_add_f32 v133, v133, v137
  v_lshlrev_b32 v136, 16, v115
  v_and_b32 v137, 0xffff0000, v115
  v_add_f32 v134, v134, v136
  v_add_f32 v135, v135, v137
  s_waitcnt vmcnt(2)
  v_lshlrev_b32 v136, 16, v116
  v_and_b32 v137, 0xffff0000, v116
  v_add_f32 v128, v128, v136
  v_add_f32 v129, v129, v137
  v_lshlrev_b32 v136, 16, v117
  v_and_b32 v137, 0xffff0000, v117
  v_add_f32 v130, v130, v136
  v_add_f32 v131, v131, v137
  v_lshlrev_b32 v136, 16, v118
  v_and_b32 v137, 0xffff0000, v118
  v_add_f32 v132, v132, v136
  v_add_f32 v133, v133, v137
  v_lshlrev_b32 v136, 16, v119
  v_and_b32 v137, 0xffff0000, v119
  v_add_f32 v134, v134, v136
  v_add_f32 v135, v135, v137
  s_waitcnt vmcnt(1)
  v_lshlrev_b32 v136, 16, v120
  v_and_b32 v137, 0xffff0000, v120
  v_add_f32 v128, v128, v136
  v_add_f32 v129, v129, v137
  v_lshlrev_b32 v136, 16, v121
  v_and_b32 v137, 0xffff0000, v121
  v_add_f32 v130, v130, v136
  v_add_f32 v131, v131, v137
  v_lshlrev_b32 v136, 16, v122
  v_and_b32 v137, 0xffff0000, v122
  v_add_f32 v132, v132, v136
  v_add_f32 v133, v133, v137
  v_lshlrev_b32 v136, 16, v123
  v_and_b32 v137, 0xffff0000, v123
  v_add_f32 v134, v134, v136
  v_add_f32 v135, v135, v137
  s_waitcnt vmcnt(0)
  v_lshlrev_b32 v136, 16, v124
  v_and_b32 v137, 0xffff0000, v124
  v_add_f32 v128, v128, v136
  v_add_f32 v129, v129, v137
  v_lshlrev_b32 v136, 16, v125
  v_and_b32 v137, 0xffff0000, v125
  v_add_f32 v130, v130, v136
  v_add_f32 v131, v131, v137
  v_lshlrev_b32 v136, 16, v126
  v_and_b32 v137, 0xffff0000, v126
  v_add_f32 v132, v132, v136
  v_add_f32 v133, v133, v137
  v_lshlrev_b32 v136, 16, v127
  v_and_b32 v137, 0xffff0000, v127
  v_add_f32 v134, v134, v136
  v_add_f32 v135, v135, v137
  v_cvt_pk_bf16_f32 v140, v128, v129
  v_cvt_pk_bf16_f32 v141, v130, v131
  v_cvt_pk_bf16_f32 v142, v132, v133
  v_cvt_pk_bf16_f32 v143, v134, v135
  v_and_b32 v144, 15, v0
  v_lshlrev_b32 v144, 11, v144
  v_lshrrev_b32 v145, 4, v0
  v_lshl_add_u32 v144, v145, 3, v144
  buffer_store_dwordx2 v[140:141], v144, s[48:51], s68 offen
  buffer_store_dwordx2 v[142:143], v144, s[48:51], s68 offen offset:32
  s_andn2_b32 s65, s100, 7
  s_lshl_b32 s65, s65, 7
  s_lshl_b32 s66, s69, 2
  s_add_u32 s65, s65, s66
  s_add_u32 s65, s65, 33554480
  v_and_b32 v38, 7, v0
  v_lshlrev_b32 v38, 7, v38
  v_add_u32 v38, s65, v38
  s_mov_b32 s73, 1
  s_mov_b32 s99, 0
L_pl_23_sp:
  buffer_load_dword v39, v38, s[4:7], 0 offen sc1
  s_waitcnt vmcnt(0)
  v_cmp_ne_u32 vcc, s73, v39
  s_nop 1
  s_cbranch_vccz L_pl_23_ok
  s_sleep 1
  s_add_u32 s99, s99, 1
  s_cmp_lt_u32 s99, 32768
  s_cbranch_scc1 L_pl_23_sp
L_pl_23_ok:
  s_lshl_b32 s65, s39, 3
  s_add_u32 s65, s65, s35
  s_lshl_b32 s65, s65, 2
  s_add_u32 s65, s65, s38
  s_mul_i32 s65, s65, 163840
  s_add_u32 s65, s65, 16777216
  s_add_u32 s44, s32, s65
  s_addc_u32 s45, s33, 0
  s_and_b32 s45, s45, 0xffff
  s_mov_b32 s46, 163840
  s_mov_b32 s47, 0x20000
  s_lshl_b32 s66, s71, 10
  buffer_load_dwordx4 v[96:99], v35, s[44:47], s66 offen sc1
  s_add_u32 s66, s66, 20480
  buffer_load_dwordx4 v[100:103], v35, s[44:47], s66 offen sc1
  s_add_u32 s66, s66, 20480
  buffer_load_dwordx4 v[104:107], v35, s[44:47], s66 offen sc1
  s_add_u32 s66, s66, 20480
  buffer_load_dwordx4 v[108:111], v35, s[44:47], s66 offen sc1
  s_add_u32 s66, s66, 20480
  buffer_load_dwordx4 v[112:115], v35, s[44:47], s66 offen sc1
  s_add_u32 s66, s66, 20480
  buffer_load_dwordx4 v[116:119], v35, s[44:47], s66 offen sc1
  s_add_u32 s66, s66, 20480
  buffer_load_dwordx4 v[120:123], v35, s[44:47], s66 offen sc1
  s_add_u32 s66, s66, 20480
  buffer_load_dwordx4 v[124:127], v35, s[44:47], s66 offen sc1
  s_add_u32 s66, s66, 20480
  s_mul_i32 s68, s69, 5
  s_sub_u32 s68, s71, s68
  s_mul_i32 s65, s35, 163840
  s_lshl_b32 s66, s39, 10
  s_add_u32 s65, s65, s66
  s_lshl_b32 s66, s38, 8
  s_add_u32 s65, s65, s66
  s_lshl_b32 s66, s69, 6
  s_add_u32 s65, s65, s66
  s_add_u32 s48, s28, s65
  s_addc_u32 s49, s29, 0
  s_and_b32 s49, s49, 0xffff
  s_mov_b32 s50, 161856
  s_mov_b32 s51, 0x20000
  s_lshl_b32 s68, s68, 15
  v_mov_b32 v128, 0
  v_mov_b32 v129, 0
  v_mov_b32 v130, 0
  v_mov_b32 v131, 0
  v_mov_b32 v132, 0
  v_mov_b32 v133, 0
  v_mov_b32 v134, 0
  v_mov_b32 v135, 0
  s_waitcnt vmcnt(7)
  v_lshlrev_b32 v136, 16, v96
  v_and_b32 v137, 0xffff0000, v96
  v_add_f32 v128, v128, v136
  v_add_f32 v129, v129, v137
  v_lshlrev_b32 v136, 16, v97
  v_and_b32 v137, 0xffff0000, v97
  v_add_f32 v130, v130, v136
  v_add_f32 v131, v131, v137
  v_lshlrev_b32 v136, 16, v98
  v_and_b32 v137, 0xffff0000, v98
  v_add_f32 v132, v132, v136
  v_add_f32 v133, v133, v137
  v_lshlrev_b32 v136, 16, v99
  v_and_b32 v137, 0xffff0000, v99
  v_add_f32 v134, v134, v136
  v_add_f32 v135, v135, v137
  s_waitcnt vmcnt(6)
  v_lshlrev_b32 v136, 16, v100
  v_and_b32 v137, 0xffff0000, v100
  v_add_f32 v128, v128, v136
  v_add_f32 v129, v129, v137
  v_lshlrev_b32 v136, 16, v101
  v_and_b32 v137, 0xffff0000, v101
  v_add_f32 v130, v130, v136
  v_add_f32 v131, v131, v137
  v_lshlrev_b32 v136, 16, v102
  v_and_b32 v137, 0xffff0000, v102
  v_add_f32 v132, v132, v136
  v_add_f32 v133, v133, v137
  v_lshlrev_b32 v136, 16, v103
  v_and_b32 v137, 0xffff0000, v103
  v_add_f32 v134, v134, v136
  v_add_f32 v135, v135, v137
  s_waitcnt vmcnt(5)
  v_lshlrev_b32 v136, 16, v104
  v_and_b32 v137, 0xffff0000, v104
  v_add_f32 v128, v128, v136
  v_add_f32 v129, v129, v137
  v_lshlrev_b32 v136, 16, v105
  v_and_b32 v137, 0xffff0000, v105
  v_add_f32 v130, v130, v136
  v_add_f32 v131, v131, v137
  v_lshlrev_b32 v136, 16, v106
  v_and_b32 v137, 0xffff0000, v106
  v_add_f32 v132, v132, v136
  v_add_f32 v133, v133, v137
  v_lshlrev_b32 v136, 16, v107
  v_and_b32 v137, 0xffff0000, v107
  v_add_f32 v134, v134, v136
  v_add_f32 v135, v135, v137
  s_waitcnt vmcnt(4)
  v_lshlrev_b32 v136, 16, v108
  v_and_b32 v137, 0xffff0000, v108
  v_add_f32 v128, v128, v136
  v_add_f32 v129, v129, v137
  v_lshlrev_b32 v136, 16, v109
  v_and_b32 v137, 0xffff0000, v109
  v_add_f32 v130, v130, v136
  v_add_f32 v131, v131, v137
  v_lshlrev_b32 v136, 16, v110
  v_and_b32 v137, 0xffff0000, v110
  v_add_f32 v132, v132, v136
  v_add_f32 v133, v133, v137
  v_lshlrev_b32 v136, 16, v111
  v_and_b32 v137, 0xffff0000, v111
  v_add_f32 v134, v134, v136
  v_add_f32 v135, v135, v137
  s_waitcnt vmcnt(3)
  v_lshlrev_b32 v136, 16, v112
  v_and_b32 v137, 0xffff0000, v112
  v_add_f32 v128, v128, v136
  v_add_f32 v129, v129, v137
  v_lshlrev_b32 v136, 16, v113
  v_and_b32 v137, 0xffff0000, v113
  v_add_f32 v130, v130, v136
  v_add_f32 v131, v131, v137
  v_lshlrev_b32 v136, 16, v114
  v_and_b32 v137, 0xffff0000, v114
  v_add_f32 v132, v132, v136
  v_add_f32 v133, v133, v137
  v_lshlrev_b32 v136, 16, v115
  v_and_b32 v137, 0xffff0000, v115
  v_add_f32 v134, v134, v136
  v_add_f32 v135, v135, v137
  s_waitcnt vmcnt(2)
  v_lshlrev_b32 v136, 16, v116
  v_and_b32 v137, 0xffff0000, v116
  v_add_f32 v128, v128, v136
  v_add_f32 v129, v129, v137
  v_lshlrev_b32 v136, 16, v117
  v_and_b32 v137, 0xffff0000, v117
  v_add_f32 v130, v130, v136
  v_add_f32 v131, v131, v137
  v_lshlrev_b32 v136, 16, v118
  v_and_b32 v137, 0xffff0000, v118
  v_add_f32 v132, v132, v136
  v_add_f32 v133, v133, v137
  v_lshlrev_b32 v136, 16, v119
  v_and_b32 v137, 0xffff0000, v119
  v_add_f32 v134, v134, v136
  v_add_f32 v135, v135, v137
  s_waitcnt vmcnt(1)
  v_lshlrev_b32 v136, 16, v120
  v_and_b32 v137, 0xffff0000, v120
  v_add_f32 v128, v128, v136
  v_add_f32 v129, v129, v137
  v_lshlrev_b32 v136, 16, v121
  v_and_b32 v137, 0xffff0000, v121
  v_add_f32 v130, v130, v136
  v_add_f32 v131, v131, v137
  v_lshlrev_b32 v136, 16, v122
  v_and_b32 v137, 0xffff0000, v122
  v_add_f32 v132, v132, v136
  v_add_f32 v133, v133, v137
  v_lshlrev_b32 v136, 16, v123
  v_and_b32 v137, 0xffff0000, v123
  v_add_f32 v134, v134, v136
  v_add_f32 v135, v135, v137
  s_waitcnt vmcnt(0)
  v_lshlrev_b32 v136, 16, v124
  v_and_b32 v137, 0xffff0000, v124
  v_add_f32 v128, v128, v136
  v_add_f32 v129, v129, v137
  v_lshlrev_b32 v136, 16, v125
  v_and_b32 v137, 0xffff0000, v125
  v_add_f32 v130, v130, v136
  v_add_f32 v131, v131, v137
  v_lshlrev_b32 v136, 16, v126
  v_and_b32 v137, 0xffff0000, v126
  v_add_f32 v132, v132, v136
  v_add_f32 v133, v133, v137
  v_lshlrev_b32 v136, 16, v127
  v_and_b32 v137, 0xffff0000, v127
  v_add_f32 v134, v134, v136
  v_add_f32 v135, v135, v137
  v_cvt_pk_bf16_f32 v140, v128, v129
  v_cvt_pk_bf16_f32 v141, v130, v131
  v_cvt_pk_bf16_f32 v142, v132, v133
  v_cvt_pk_bf16_f32 v143, v134, v135
  v_and_b32 v144, 15, v0
  v_lshlrev_b32 v144, 11, v144
  v_lshrrev_b32 v145, 4, v0
  v_lshl_add_u32 v144, v145, 3, v144
  buffer_store_dwordx2 v[140:141], v144, s[48:51], s68 offen
  buffer_store_dwordx2 v[142:143], v144, s[48:51], s68 offen offset:32
L_s2done:
  s_waitcnt vmcnt(0)
L1_end:
  s_endpgm
L_rsq:
  s_add_u32 s65, s64, 24576
  v_add_u32 v8, s65, v35
  v_cvt_pk_bf16_f32 v40, v136, v137
  v_cvt_pk_bf16_f32 v41, v138, v139
  v_cvt_pk_bf16_f32 v42, v156, v157
  v_cvt_pk_bf16_f32 v43, v158, v159
  ds_write_b128 v8, v[40:43] offset:0
  v_cvt_pk_bf16_f32 v44, v140, v141
  v_cvt_pk_bf16_f32 v45, v142, v143
  v_cvt_pk_bf16_f32 v46, v160, v161
  v_cvt_pk_bf16_f32 v47, v162, v163
  ds_write_b128 v8, v[44:47] offset:1024
  v_cvt_pk_bf16_f32 v48, v144, v145
  v_cvt_pk_bf16_f32 v49, v146, v147
  v_cvt_pk_bf16_f32 v50, v164, v165
  v_cvt_pk_bf16_f32 v51, v166, v167
  ds_write_b128 v8, v[48:51] offset:2048
  v_cvt_pk_bf16_f32 v52, v148, v149
  v_cvt_pk_bf16_f32 v53, v150, v151
  v_cvt_pk_bf16_f32 v54, v168, v169
  v_cvt_pk_bf16_f32 v55, v170, v171
  ds_write_b128 v8, v[52:55] offset:3072
  v_cvt_pk_bf16_f32 v56, v152, v153
  v_cvt_pk_bf16_f32 v57, v154, v155
  v_cvt_pk_bf16_f32 v58, v172, v173
  v_cvt_pk_bf16_f32 v59, v174, v175
  ds_write_b128 v8, v[56:59] offset:4096
  v_cvt_pk_bf16_f32 v60, v176, v177
  v_cvt_pk_bf16_f32 v61, v178, v179
  v_cvt_pk_bf16_f32 v62, v196, v197
  v_cvt_pk_bf16_f32 v63, v198, v199
  ds_write_b128 v8, v[60:63] offset:5120
  v_cvt_pk_bf16_f32 v64, v180, v181
  v_cvt_pk_bf16_f32 v65, v182, v183
  v_cvt_pk_bf16_f32 v66, v200, v201
  v_cvt_pk_bf16_f32 v67, v202, v203
  ds_write_b128 v8, v[64:67] offset:6144
  v_cvt_pk_bf16_f32 v68, v184, v185
  v_cvt_pk_bf16_f32 v69, v186, v187
  v_cvt_pk_bf16_f32 v70, v204, v205
  v_cvt_pk_bf16_f32 v71, v206, v207
  ds_write_b128 v8, v[68:71] offset:7168
  v_cvt_pk_bf16_f32 v40, v188, v189
  v_cvt_pk_bf16_f32 v41, v190, v191
  v_cvt_pk_bf16_f32 v42, v208, v209
  v_cvt_pk_bf16_f32 v43, v210, v211
  ds_write_b128 v8, v[40:43] offset:8192
  v_cvt_pk_bf16_f32 v44, v192, v193
  v_cvt_pk_bf16_f32 v45, v194, v195
  v_cvt_pk_bf16_f32 v46, v212, v213
  v_cvt_pk_bf16_f32 v47, v214, v215
  ds_write_b128 v8, v[44:47] offset:9216
  v_cvt_pk_bf16_f32 v48, v216, v217
  v_cvt_pk_bf16_f32 v49, v218, v219
  v_cvt_pk_bf16_f32 v50, v236, v237
  v_cvt_pk_bf16_f32 v51, v238, v239
  ds_write_b128 v8, v[48:51] offset:10240
  v_cvt_pk_bf16_f32 v52, v220, v221
  v_cvt_pk_bf16_f32 v53, v222, v223
  v_cvt_pk_bf16_f32 v54, v240, v241
  v_cvt_pk_bf16_f32 v55, v242, v243
  ds_write_b128 v8, v[52:55] offset:11264
  v_cvt_pk_bf16_f32 v56, v224, v225
  v_cvt_pk_bf16_f32 v57, v226, v227
  v_cvt_pk_bf16_f32 v58, v244, v245
  v_cvt_pk_bf16_f32 v59, v246, v247
  ds_write_b128 v8, v[56:59] offset:12288
  v_cvt_pk_bf16_f32 v60, v228, v229
  v_cvt_pk_bf16_f32 v61, v230, v231
  v_cvt_pk_bf16_f32 v62, v248, v249
  v_cvt_pk_bf16_f32 v63, v250, v251
  ds_write_b128 v8, v[60:63] offset:13312
  v_cvt_pk_bf16_f32 v64, v232, v233
  v_cvt_pk_bf16_f32 v65, v234, v235
  v_cvt_pk_bf16_f32 v66, v252, v253
  v_cvt_pk_bf16_f32 v67, v254, v255
  ds_write_b128 v8, v[64:67] offset:14336
  s_sub_u32 s65, s34, 1
  s_and_b32 s65, s65, 3
  s_mul_i32 s65, s65, 40960
  s_add_u32 s65, s65, 24576
  v_add_u32 v1, s65, v35
  s_sub_u32 s65, s34, 2
  s_and_b32 s65, s65, 3
  s_mul_i32 s65, s65, 40960
  s_add_u32 s65, s65, 29696
  v_add_u32 v8, s65, v35
  s_sub_u32 s65, s34, 3
  s_and_b32 s65, s65, 3
  s_mul_i32 s65, s65, 40960
  s_add_u32 s65, s65, 34816
  v_add_u32 v9, s65, v35
  v_mov_b32 v2, 0
  v_mov_b32 v3, 0
  v_accvgpr_read_b32 v4, a248
  v_accvgpr_read_b32 v5, a249
  v_mov_b32 v6, 0
  v_mov_b32 v7, 0
  s_waitcnt lgkmcnt(0)
  s_barrier
  ds_read_b128 a[160:163], v1 offset:0
  ds_read_b128 a[164:167], v1 offset:1024
  ds_read_b128 a[168:171], v1 offset:2048
  ds_read_b128 a[172:175], v1 offset:3072
  ds_read_b128 a[176:179], v1 offset:4096
  ds_read_b128 a[180:183], v8 offset:0
  ds_read_b128 a[184:187], v8 offset:1024
  ds_read_b128 a[188:191], v8 offset:2048
  ds_read_b128 a[192:195], v8 offset:3072
  ds_read_b128 a[196:199], v8 offset:4096
  ds_read_b128 a[200:203], v9 offset:0
  ds_read_b128 a[204:207], v9 offset:1024
  ds_read_b128 a[208:211], v9 offset:2048
  ds_read_b128 a[212:215], v9 offset:3072
  ds_read_b128 a[216:219], v9 offset:4096
  s_add_u32 m0, s64, 16384
  s_add_u32 s65, s69, 0
  buffer_load_dwordx4 v22, s[52:55], s65 offen offset:0 lds
  buffer_load_dwordx4 v23, s[52:55], s65 offen offset:1024 lds
  buffer_load_dwordx4 v24, s[52:55], s65 offen offset:2048 lds
  buffer_load_dwordx4 v25, s[52:55], s65 offen offset:3072 lds
  s_add_u32 m0, s64, 20480
  s_add_u32 s65, s69, 4096
  buffer_load_dwordx4 v22, s[52:55], s65 offen offset:0 lds
  buffer_load_dwordx4 v23, s[52:55], s65 offen offset:1024 lds
  buffer_load_dwordx4 v24, s[52:55], s65 offen offset:2048 lds
  buffer_load_dwordx4 v25, s[52:55], s65 offen offset:3072 lds
  s_add_u32 s69, s69, 32768
  s_waitcnt lgkmcnt(10)
  v_mfma_f32_16x16x32_bf16 v[96:99], v[4:7], a[160:163], v[96:99]
  v_mfma_f32_16x16x32_bf16 v[116:119], v[2:5], a[160:163], v[116:119]
  v_mfma_f32_16x16x32_bf16 v[100:103], v[4:7], a[164:167], v[100:103]
  v_mfma_f32_16x16x32_bf16 v[120:123], v[2:5], a[164:167], v[120:123]
  v_mfma_f32_16x16x32_bf16 v[104:107], v[4:7], a[168:171], v[104:107]
  v_mfma_f32_16x16x32_bf16 v[124:127], v[2:5], a[168:171], v[124:127]
  v_mfma_f32_16x16x32_bf16 v[108:111], v[4:7], a[172:175], v[108:111]
  v_mfma_f32_16x16x32_bf16 v[128:131], v[2:5], a[172:175], v[128:131]
  v_mfma_f32_16x16x32_bf16 v[112:115], v[4:7], a[176:179], v[112:115]
  v_mfma_f32_16x16x32_bf16 v[132:135], v[2:5], a[176:179], v[132:135]
  s_waitcnt lgkmcnt(5)
  v_mfma_f32_16x16x32_bf16 v[96:99], v[4:7], a[180:183], v[96:99]
  v_mfma_f32_16x16x32_bf16 v[116:119], v[2:5], a[180:183], v[116:119]
  v_mfma_f32_16x16x32_bf16 v[100:103], v[4:7], a[184:187], v[100:103]
  v_mfma_f32_16x16x32_bf16 v[120:123], v[2:5], a[184:187], v[120:123]
  v_mfma_f32_16x16x32_bf16 v[104:107], v[4:7], a[188:191], v[104:107]
  v_mfma_f32_16x16x32_bf16 v[124:127], v[2:5], a[188:191], v[124:127]
  v_mfma_f32_16x16x32_bf16 v[108:111], v[4:7], a[192:195], v[108:111]
  v_mfma_f32_16x16x32_bf16 v[128:131], v[2:5], a[192:195], v[128:131]
  v_mfma_f32_16x16x32_bf16 v[112:115], v[4:7], a[196:199], v[112:115]
  v_mfma_f32_16x16x32_bf16 v[132:135], v[2:5], a[196:199], v[132:135]
  s_waitcnt lgkmcnt(0)
  v_mfma_f32_16x16x32_bf16 v[96:99], v[4:7], a[200:203], v[96:99]
  v_mfma_f32_16x16x32_bf16 v[116:119], v[2:5], a[200:203], v[116:119]
  v_mfma_f32_16x16x32_bf16 v[100:103], v[4:7], a[204:207], v[100:103]
  v_mfma_f32_16x16x32_bf16 v[120:123], v[2:5], a[204:207], v[120:123]
  v_mfma_f32_16x16x32_bf16 v[104:107], v[4:7], a[208:211], v[104:107]
  v_mfma_f32_16x16x32_bf16 v[124:127], v[2:5], a[208:211], v[124:127]
  v_mfma_f32_16x16x32_bf16 v[108:111], v[4:7], a[212:215], v[108:111]
  v_mfma_f32_16x16x32_bf16 v[128:131], v[2:5], a[212:215], v[128:131]
  v_mfma_f32_16x16x32_bf16 v[112:115], v[4:7], a[216:219], v[112:115]
  v_mfma_f32_16x16x32_bf16 v[132:135], v[2:5], a[216:219], v[132:135]
  s_nop 7
  s_setpc_b64 s[96:97]
L_rso:
  s_add_u32 s65, s64, 24576
  v_add_u32 v8, s65, v35
  v_and_b32 v95, 15, v0
  v_lshlrev_b32 v95, 2, v95
  s_add_u32 s65, s64, 39936
  v_add_u32 v94, s65, v95
  ds_write_b32 v94, a224 offset:0
  ds_write_b32 v94, a228 offset:64
  ds_write_b32 v94, a232 offset:128
  ds_write_b32 v94, a236 offset:192
  ds_write_b32 v94, a240 offset:256
  v_cvt_pk_bf16_f32 v40, v136, v137
  v_cvt_pk_bf16_f32 v41, v138, v139
  v_cvt_pk_bf16_f32 v42, v156, v157
  v_cvt_pk_bf16_f32 v43, v158, v159
  ds_write_b128 v8, v[40:43] offset:0
  v_cvt_pk_bf16_f32 v44, v140, v141
  v_cvt_pk_bf16_f32 v45, v142, v143
  v_cvt_pk_bf16_f32 v46, v160, v161
  v_cvt_pk_bf16_f32 v47, v162, v163
  ds_write_b128 v8, v[44:47] offset:1024
  v_cvt_pk_bf16_f32 v48, v144, v145
  v_cvt_pk_bf16_f32 v49, v146, v147
  v_cvt_pk_bf16_f32 v50, v164, v165
  v_cvt_pk_bf16_f32 v51, v166, v167
  ds_write_b128 v8, v[48:51] offset:2048
  v_cvt_pk_bf16_f32 v52, v148, v149
  v_cvt_pk_bf16_f32 v53, v150, v151
  v_cvt_pk_bf16_f32 v54, v168, v169
  v_cvt_pk_bf16_f32 v55, v170, v171
  ds_write_b128 v8, v[52:55] offset:3072
  v_cvt_pk_bf16_f32 v56, v152, v153
  v_cvt_pk_bf16_f32 v57, v154, v155
  v_cvt_pk_bf16_f32 v58, v172, v173
  v_cvt_pk_bf16_f32 v59, v174, v175
  ds_write_b128 v8, v[56:59] offset:4096
  v_cvt_pk_bf16_f32 v60, v176, v177
  v_cvt_pk_bf16_f32 v61, v178, v179
  v_cvt_pk_bf16_f32 v62, v196, v197
  v_cvt_pk_bf16_f32 v63, v198, v199
  ds_write_b128 v8, v[60:63] offset:5120
  v_cvt_pk_bf16_f32 v64, v180, v181
  v_cvt_pk_bf16_f32 v65, v182, v183
  v_cvt_pk_bf16_f32 v66, v200, v201
  v_cvt_pk_bf16_f32 v67, v202, v203
  ds_write_b128 v8, v[64:67] offset:6144
  v_cvt_pk_bf16_f32 v68, v184, v185
  v_cvt_pk_bf16_f32 v69, v186, v187
  v_cvt_pk_bf16_f32 v70, v204, v205
  v_cvt_pk_bf16_f32 v71, v206, v207
  ds_write_b128 v8, v[68:71] offset:7168
  v_cvt_pk_bf16_f32 v40, v188, v189
  v_cvt_pk_bf16_f32 v41, v190, v191
  v_cvt_pk_bf16_f32 v42, v208, v209
  v_cvt_pk_bf16_f32 v43, v210, v211
  ds_write_b128 v8, v[40:43] offset:8192
  v_cvt_pk_bf16_f32 v44, v192, v193
  v_cvt_pk_bf16_f32 v45, v194, v195
  v_cvt_pk_bf16_f32 v46, v212, v213
  v_cvt_pk_bf16_f32 v47, v214, v215
  ds_write_b128 v8, v[44:47] offset:9216
  v_cvt_pk_bf16_f32 v48, v216, v217
  v_cvt_pk_bf16_f32 v49, v218, v219
  v_cvt_pk_bf16_f32 v50, v236, v237
  v_cvt_pk_bf16_f32 v51, v238, v239
  ds_write_b128 v8, v[48:51] offset:10240
  v_cvt_pk_bf16_f32 v52, v220, v221
  v_cvt_pk_bf16_f32 v53, v222, v223
  v_cvt_pk_bf16_f32 v54, v240, v241
  v_cvt_pk_bf16_f32 v55, v242, v243
  ds_write_b128 v8, v[52:55] offset:11264
  v_cvt_pk_bf16_f32 v56, v224, v225
  v_cvt_pk_bf16_f32 v57, v226, v227
  v_cvt_pk_bf16_f32 v58, v244, v245
  v_cvt_pk_bf16_f32 v59, v246, v247
  ds_write_b128 v8, v[56:59] offset:12288
  v_cvt_pk_bf16_f32 v60, v228, v229
  v_cvt_pk_bf16_f32 v61, v230, v231
  v_cvt_pk_bf16_f32 v62, v248, v249
  v_cvt_pk_bf16_f32 v63, v250, v251
  ds_write_b128 v8, v[60:63] offset:13312
  v_cvt_pk_bf16_f32 v64, v232, v233
  v_cvt_pk_bf16_f32 v65, v234, v235
  v_cvt_pk_bf16_f32 v66, v252, v253
  v_cvt_pk_bf16_f32 v67, v254, v255
  ds_write_b128 v8, v[64:67] offset:14336
  s_sub_u32 s65, s34, 1
  s_and_b32 s65, s65, 3
  s_mul_i32 s65, s65, 40960
  s_add_u32 s65, s65, 24576
  v_add_u32 v1, s65, v35
  s_sub_u32 s65, s34, 2
  s_and_b32 s65, s65, 3
  s_mul_i32 s65, s65, 40960
  s_add_u32 s65, s65, 29696
  v_add_u32 v8, s65, v35
  s_sub_u32 s65, s34, 3
  s_and_b32 s65, s65, 3
  s_mul_i32 s65, s65, 40960
  s_add_u32 s65, s65, 34816
  v_add_u32 v9, s65, v35
  v_mov_b32 v2, 0
  v_mov_b32 v3, 0
  v_accvgpr_read_b32 v4, a248
  v_accvgpr_read_b32 v5, a249
  v_mov_b32 v6, 0
  v_mov_b32 v7, 0
  s_waitcnt lgkmcnt(0)
  s_barrier
  ds_read_b128 a[160:163], v1 offset:0
  ds_read_b128 a[164:167], v1 offset:1024
  ds_read_b128 a[168:171], v1 offset:2048
  ds_read_b128 a[172:175], v1 offset:3072
  ds_read_b128 a[176:179], v1 offset:4096
  ds_read_b128 a[180:183], v8 offset:0
  ds_read_b128 a[184:187], v8 offset:1024
  ds_read_b128 a[188:191], v8 offset:2048
  ds_read_b128 a[192:195], v8 offset:3072
  ds_read_b128 a[196:199], v8 offset:4096
  ds_read_b128 a[200:203], v9 offset:0
  ds_read_b128 a[204:207], v9 offset:1024
  ds_read_b128 a[208:211], v9 offset:2048
  ds_read_b128 a[212:215], v9 offset:3072
  ds_read_b128 a[216:219], v9 offset:4096
  s_waitcnt lgkmcnt(10)
  v_mfma_f32_16x16x32_bf16 v[96:99], v[4:7], a[160:163], v[96:99]
  v_mfma_f32_16x16x32_bf16 v[116:119], v[2:5], a[160:163], v[116:119]
  v_mfma_f32_16x16x32_bf16 v[100:103], v[4:7], a[164:167], v[100:103]
  v_mfma_f32_16x16x32_bf16 v[120:123], v[2:5], a[164:167], v[120:123]
  v_mfma_f32_16x16x32_bf16 v[104:107], v[4:7], a[168:171], v[104:107]
  v_mfma_f32_16x16x32_bf16 v[124:127], v[2:5], a[168:171], v[124:127]
  v_mfma_f32_16x16x32_bf16 v[108:111], v[4:7], a[172:175], v[108:111]
  v_mfma_f32_16x16x32_bf16 v[128:131], v[2:5], a[172:175], v[128:131]
  v_mfma_f32_16x16x32_bf16 v[112:115], v[4:7], a[176:179], v[112:115]
  v_mfma_f32_16x16x32_bf16 v[132:135], v[2:5], a[176:179], v[132:135]
  s_waitcnt lgkmcnt(5)
  v_mfma_f32_16x16x32_bf16 v[96:99], v[4:7], a[180:183], v[96:99]
  v_mfma_f32_16x16x32_bf16 v[116:119], v[2:5], a[180:183], v[116:119]
  v_mfma_f32_16x16x32_bf16 v[100:103], v[4:7], a[184:187], v[100:103]
  v_mfma_f32_16x16x32_bf16 v[120:123], v[2:5], a[184:187], v[120:123]
  v_mfma_f32_16x16x32_bf16 v[104:107], v[4:7], a[188:191], v[104:107]
  v_mfma_f32_16x16x32_bf16 v[124:127], v[2:5], a[188:191], v[124:127]
  v_mfma_f32_16x16x32_bf16 v[108:111], v[4:7], a[192:195], v[108:111]
  v_mfma_f32_16x16x32_bf16 v[128:131], v[2:5], a[192:195], v[128:131]
  v_mfma_f32_16x16x32_bf16 v[112:115], v[4:7], a[196:199], v[112:115]
  v_mfma_f32_16x16x32_bf16 v[132:135], v[2:5], a[196:199], v[132:135]
  s_waitcnt lgkmcnt(0)
  v_add_u32 v95, 39936, v95
  ds_read_b32 v64, v95 offset:0
  ds_read_b32 v65, v95 offset:64
  ds_read_b32 v66, v95 offset:128
  ds_read_b32 v67, v95 offset:192
  ds_read_b32 v68, v95 offset:256
  v_add_u32 v95, 40960, v95
  ds_read_b32 v69, v95 offset:0
  ds_read_b32 v70, v95 offset:64
  ds_read_b32 v71, v95 offset:128
  ds_read_b32 v72, v95 offset:192
  ds_read_b32 v73, v95 offset:256
  v_add_u32 v95, 40960, v95
  ds_read_b32 v74, v95 offset:0
  ds_read_b32 v75, v95 offset:64
  ds_read_b32 v76, v95 offset:128
  ds_read_b32 v77, v95 offset:192
  ds_read_b32 v78, v95 offset:256
  v_add_u32 v95, 40960, v95
  ds_read_b32 v79, v95 offset:0
  ds_read_b32 v80, v95 offset:64
  ds_read_b32 v81, v95 offset:128
  ds_read_b32 v82, v95 offset:192
  ds_read_b32 v83, v95 offset:256
  v_mfma_f32_16x16x32_bf16 v[96:99], v[4:7], a[200:203], v[96:99]
  v_mfma_f32_16x16x32_bf16 v[116:119], v[2:5], a[200:203], v[116:119]
  v_mfma_f32_16x16x32_bf16 v[100:103], v[4:7], a[204:207], v[100:103]
  v_mfma_f32_16x16x32_bf16 v[120:123], v[2:5], a[204:207], v[120:123]
  v_mfma_f32_16x16x32_bf16 v[104:107], v[4:7], a[208:211], v[104:107]
  v_mfma_f32_16x16x32_bf16 v[124:127], v[2:5], a[208:211], v[124:127]
  v_mfma_f32_16x16x32_bf16 v[108:111], v[4:7], a[212:215], v[108:111]
  v_mfma_f32_16x16x32_bf16 v[128:131], v[2:5], a[212:215], v[128:131]
  v_mfma_f32_16x16x32_bf16 v[112:115], v[4:7], a[216:219], v[112:115]
  v_mfma_f32_16x16x32_bf16 v[132:135], v[2:5], a[216:219], v[132:135]
  s_waitcnt lgkmcnt(0)
  v_add_f32 v64, v64, v69
  v_add_f32 v74, v74, v79
  v_add_f32 v65, v65, v70
  v_add_f32 v75, v75, v80
  v_add_f32 v66, v66, v71
  v_add_f32 v76, v76, v81
  v_add_f32 v67, v67, v72
  v_add_f32 v77, v77, v82
  v_add_f32 v68, v68, v73
  v_add_f32 v78, v78, v83
  v_add_f32 v84, v64, v74
  v_add_f32 v85, v65, v75
  v_add_f32 v86, v66, v76
  v_add_f32 v87, v67, v77
  v_add_f32 v88, v68, v78
  s_setpc_b64 s[96:97]
L_fb:
  s_mov_b32 s76, s52
  s_mov_b32 s77, s53
  s_mov_b32 s78, s54
  s_mov_b32 s79, s55
  s_mov_b32 s80, s56
  s_mov_b32 s81, s57
  s_mov_b32 s82, s58
  s_mov_b32 s83, s59
  s_mov_b32 s84, s69
  s_mov_b32 s85, s70
  s_waitcnt vmcnt(0) lgkmcnt(0)
  s_barrier
  s_cmp_eq_u32 s2, 0
  s_cselect_b32 s52, s10, s20
  s_cselect_b32 s53, s11, s21
  s_cselect_b32 s56, s12, s22
  s_cselect_b32 s57, s13, s23
  s_lshl_b32 s65, s35, 3
  s_add_u32 s65, s65, s37
  s_lshl_b32 s66, s35, 5
  s_add_u32 s66, s66, s36
  s_cmp_eq_u32 s2, 0
  s_cselect_b32 s65, s65, s66
  s_lshr_b32 s66, s65, 13
  s_lshl_b32 s65, s65, 19
  s_add_u32 s52, s52, s65
  s_addc_u32 s53, s53, s66
  s_and_b32 s53, s53, 0xffff
  s_mov_b32 s54, 524288
  s_mov_b32 s55, 0x20000
  s_add_u32 s56, s56, s65
  s_addc_u32 s57, s57, s66
  s_and_b32 s57, s57, 0xffff
  s_mov_b32 s58, 524288
  s_mov_b32 s59, 0x20000
  s_mov_b32 s69, s72
  s_mov_b32 s70, s72
  v_mov_b32 v84, 0xff800000
  v_mov_b32 v85, 0xff800000
  v_mov_b32 v86, 0xff800000
  v_mov_b32 v87, 0xff800000
  v_mov_b32 v88, 0xff800000
  s_mov_b32 s71, 0
L_fb1:
  s_add_u32 m0, s64, 24576
  s_add_u32 s65, s69, 0
  buffer_load_dwordx4 v22, s[52:55], s65 offen offset:0 lds
  buffer_load_dwordx4 v23, s[52:55], s65 offen offset:1024 lds
  buffer_load_dwordx4 v24, s[52:55], s65 offen offset:2048 lds
  buffer_load_dwordx4 v25, s[52:55], s65 offen offset:3072 lds
  s_add_u32 m0, s64, 28672
  s_add_u32 s65, s69, 4096
  buffer_load_dwordx4 v22, s[52:55], s65 offen offset:0 lds
  buffer_load_dwordx4 v23, s[52:55], s65 offen offset:1024 lds
  buffer_load_dwordx4 v24, s[52:55], s65 offen offset:2048 lds
  buffer_load_dwordx4 v25, s[52:55], s65 offen offset:3072 lds
  s_add_u32 s69, s69, 32768
  s_waitcnt vmcnt(0)
  ds_read_b128 a[160:163], v10 offset:24576
  ds_read_b128 a[164:167], v11 offset:24576
  ds_read_b128 a[168:171], v12 offset:24576
  ds_read_b128 a[172:175], v13 offset:24576
  ds_read_b128 a[176:179], v10 offset:28672
  ds_read_b128 a[180:183], v11 offset:28672
  ds_read_b128 a[184:187], v12 offset:28672
  ds_read_b128 a[188:191], v13 offset:28672
  s_waitcnt lgkmcnt(0)
  v_mfma_f32_16x16x32_bf16 v[96:99], a[160:163], a[0:3], 0
  v_mfma_f32_16x16x32_bf16 v[96:99], a[164:167], a[4:7], v[96:99]
  v_mfma_f32_16x16x32_bf16 v[96:99], a[168:171], a[8:11], v[96:99]
  v_mfma_f32_16x16x32_bf16 v[96:99], a[172:175], a[12:15], v[96:99]
  v_mfma_f32_16x16x32_bf16 v[100:103], a[176:179], a[0:3], 0
  v_mfma_f32_16x16x32_bf16 v[100:103], a[180:183], a[4:7], v[100:103]
  v_mfma_f32_16x16x32_bf16 v[100:103], a[184:187], a[8:11], v[100:103]
  v_mfma_f32_16x16x32_bf16 v[100:103], a[188:191], a[12:15], v[100:103]
  v_mfma_f32_16x16x32_bf16 v[104:107], a[160:163], a[16:19], 0
  v_mfma_f32_16x16x32_bf16 v[104:107], a[164:167], a[20:23], v[104:107]
  v_mfma_f32_16x16x32_bf16 v[104:107], a[168:171], a[24:27], v[104:107]
  v_mfma_f32_16x16x32_bf16 v[104:107], a[172:175], a[28:31], v[104:107]
  v_mfma_f32_16x16x32_bf16 v[108:111], a[176:179], a[16:19], 0
  v_mfma_f32_16x16x32_bf16 v[108:111], a[180:183], a[20:23], v[108:111]
  v_mfma_f32_16x16x32_bf16 v[108:111], a[184:187], a[24:27], v[108:111]
  v_mfma_f32_16x16x32_bf16 v[108:111], a[188:191], a[28:31], v[108:111]
  v_mfma_f32_16x16x32_bf16 v[112:115], a[160:163], a[32:35], 0
  v_mfma_f32_16x16x32_bf16 v[112:115], a[164:167], a[36:39], v[112:115]
  v_mfma_f32_16x16x32_bf16 v[112:115], a[168:171], a[40:43], v[112:115]
  v_mfma_f32_16x16x32_bf16 v[112:115], a[172:175], a[44:47], v[112:115]
  v_mfma_f32_16x16x32_bf16 v[116:119], a[176:179], a[32:35], 0
  v_mfma_f32_16x16x32_bf16 v[116:119], a[180:183], a[36:39], v[116:119]
  v_mfma_f32_16x16x32_bf16 v[116:119], a[184:187], a[40:43], v[116:119]
  v_mfma_f32_16x16x32_bf16 v[116:119], a[188:191], a[44:47], v[116:119]
  v_mfma_f32_16x16x32_bf16 v[120:123], a[160:163], a[48:51], 0
  v_mfma_f32_16x16x32_bf16 v[120:123], a[164:167], a[52:55], v[120:123]
  v_mfma_f32_16x16x32_bf16 v[120:123], a[168:171], a[56:59], v[120:123]
  v_mfma_f32_16x16x32_bf16 v[120:123], a[172:175], a[60:63], v[120:123]
  v_mfma_f32_16x16x32_bf16 v[124:127], a[176:179], a[48:51], 0
  v_mfma_f32_16x16x32_bf16 v[124:127], a[180:183], a[52:55], v[124:127]
  v_mfma_f32_16x16x32_bf16 v[124:127], a[184:187], a[56:59], v[124:127]
  v_mfma_f32_16x16x32_bf16 v[124:127], a[188:191], a[60:63], v[124:127]
  v_mfma_f32_16x16x32_bf16 v[128:131], a[160:163], a[64:67], 0
  v_mfma_f32_16x16x32_bf16 v[128:131], a[164:167], a[68:71], v[128:131]
  v_mfma_f32_16x16x32_bf16 v[128:131], a[168:171], a[72:75], v[128:131]
  v_mfma_f32_16x16x32_bf16 v[128:131], a[172:175], a[76:79], v[128:131]
  v_mfma_f32_16x16x32_bf16 v[132:135], a[176:179], a[64:67], 0
  v_mfma_f32_16x16x32_bf16 v[132:135], a[180:183], a[68:71], v[132:135]
  v_mfma_f32_16x16x32_bf16 v[132:135], a[184:187], a[72:75], v[132:135]
  v_mfma_f32_16x16x32_bf16 v[132:135], a[188:191], a[76:79], v[132:135]
  s_nop 7
  s_nop 7
  v_max3_f32 v84, v84, v96, v97
  v_max3_f32 v84, v84, v98, v99
  v_max3_f32 v84, v84, v100, v101
  v_max3_f32 v84, v84, v102, v103
  v_max3_f32 v85, v85, v104, v105
  v_max3_f32 v85, v85, v106, v107
  v_max3_f32 v85, v85, v108, v109
  v_max3_f32 v85, v85, v110, v111
  v_max3_f32 v86, v86, v112, v113
  v_max3_f32 v86, v86, v114, v115
  v_max3_f32 v86, v86, v116, v117
  v_max3_f32 v86, v86, v118, v119
  v_max3_f32 v87, v87, v120, v121
  v_max3_f32 v87, v87, v122, v123
  v_max3_f32 v87, v87, v124, v125
  v_max3_f32 v87, v87, v126, v127
  v_max3_f32 v88, v88, v128, v129
  v_max3_f32 v88, v88, v130, v131
  v_max3_f32 v88, v88, v132, v133
  v_max3_f32 v88, v88, v134, v135
  s_add_u32 s71, s71, 1
  s_cmp_lt_u32 s71, 16
  s_cbranch_scc1 L_fb1
  v_lshlrev_b32 v1, 2, v0
  s_add_u32 s65, s64, 32768
  v_add_u32 v2, s65, v1
  ds_write_b32 v2, v84 offset:0
  ds_write_b32 v2, v85 offset:256
  ds_write_b32 v2, v86 offset:512
  ds_write_b32 v2, v87 offset:768
  ds_write_b32 v2, v88 offset:1024
  s_waitcnt lgkmcnt(0)
  s_barrier
  v_and_b32 v1, 15, v0
  v_lshlrev_b32 v1, 2, v1
  v_add_u32 v2, 32768, v1
  ds_read_b32 v96, v2 offset:0
  ds_read_b32 v97, v2 offset:64
  ds_read_b32 v98, v2 offset:128
  ds_read_b32 v99, v2 offset:192
  s_waitcnt lgkmcnt(0)
  v_max3_f32 v84, v84, v96, v97
  v_max3_f32 v84, v84, v98, v99
  ds_read_b32 v96, v2 offset:256
  ds_read_b32 v97, v2 offset:320
  ds_read_b32 v98, v2 offset:384
  ds_read_b32 v99, v2 offset:448
  s_waitcnt lgkmcnt(0)
  v_max3_f32 v85, v85, v96, v97
  v_max3_f32 v85, v85, v98, v99
  ds_read_b32 v96, v2 offset:512
  ds_read_b32 v97, v2 offset:576
  ds_read_b32 v98, v2 offset:640
  ds_read_b32 v99, v2 offset:704
  s_waitcnt lgkmcnt(0)
  v_max3_f32 v86, v86, v96, v97
  v_max3_f32 v86, v86, v98, v99
  ds_read_b32 v96, v2 offset:768
  ds_read_b32 v97, v2 offset:832
  ds_read_b32 v98, v2 offset:896
  ds_read_b32 v99, v2 offset:960
  s_waitcnt lgkmcnt(0)
  v_max3_f32 v87, v87, v96, v97
  v_max3_f32 v87, v87, v98, v99
  ds_read_b32 v96, v2 offset:1024
  ds_read_b32 v97, v2 offset:1088
  ds_read_b32 v98, v2 offset:1152
  ds_read_b32 v99, v2 offset:1216
  s_waitcnt lgkmcnt(0)
  v_max3_f32 v88, v88, v96, v97
  v_max3_f32 v88, v88, v98, v99
  v_add_u32 v2, 73728, v1
  ds_read_b32 v96, v2 offset:0
  ds_read_b32 v97, v2 offset:64
  ds_read_b32 v98, v2 offset:128
  ds_read_b32 v99, v2 offset:192
  s_waitcnt lgkmcnt(0)
  v_max3_f32 v84, v84, v96, v97
  v_max3_f32 v84, v84, v98, v99
  ds_read_b32 v96, v2 offset:256
  ds_read_b32 v97, v2 offset:320
  ds_read_b32 v98, v2 offset:384
  ds_read_b32 v99, v2 offset:448
  s_waitcnt lgkmcnt(0)
  v_max3_f32 v85, v85, v96, v97
  v_max3_f32 v85, v85, v98, v99
  ds_read_b32 v96, v2 offset:512
  ds_read_b32 v97, v2 offset:576
  ds_read_b32 v98, v2 offset:640
  ds_read_b32 v99, v2 offset:704
  s_waitcnt lgkmcnt(0)
  v_max3_f32 v86, v86, v96, v97
  v_max3_f32 v86, v86, v98, v99
  ds_read_b32 v96, v2 offset:768
  ds_read_b32 v97, v2 offset:832
  ds_read_b32 v98, v2 offset:896
  ds_read_b32 v99, v2 offset:960
  s_waitcnt lgkmcnt(0)
  v_max3_f32 v87, v87, v96, v97
  v_max3_f32 v87, v87, v98, v99
  ds_read_b32 v96, v2 offset:1024
  ds_read_b32 v97, v2 offset:1088
  ds_read_b32 v98, v2 offset:1152
  ds_read_b32 v99, v2 offset:1216
  s_waitcnt lgkmcnt(0)
  v_max3_f32 v88, v88, v96, v97
  v_max3_f32 v88, v88, v98, v99
  v_add_u32 v2, 114688, v1
  ds_read_b32 v96, v2 offset:0
  ds_read_b32 v97, v2 offset:64
  ds_read_b32 v98, v2 offset:128
  ds_read_b32 v99, v2 offset:192
  s_waitcnt lgkmcnt(0)
  v_max3_f32 v84, v84, v96, v97
  v_max3_f32 v84, v84, v98, v99
  ds_read_b32 v96, v2 offset:256
  ds_read_b32 v97, v2 offset:320
  ds_read_b32 v98, v2 offset:384
  ds_read_b32 v99, v2 offset:448
  s_waitcnt lgkmcnt(0)
  v_max3_f32 v85, v85, v96, v97
  v_max3_f32 v85, v85, v98, v99
  ds_read_b32 v96, v2 offset:512
  ds_read_b32 v97, v2 offset:576
  ds_read_b32 v98, v2 offset:640
  ds_read_b32 v99, v2 offset:704
  s_waitcnt lgkmcnt(0)
  v_max3_f32 v86, v86, v96, v97
  v_max3_f32 v86, v86, v98, v99
  ds_read_b32 v96, v2 offset:768
  ds_read_b32 v97, v2 offset:832
  ds_read_b32 v98, v2 offset:896
  ds_read_b32 v99, v2 offset:960
  s_waitcnt lgkmcnt(0)
  v_max3_f32 v87, v87, v96, v97
  v_max3_f32 v87, v87, v98, v99
  ds_read_b32 v96, v2 offset:1024
  ds_read_b32 v97, v2 offset:1088
  ds_read_b32 v98, v2 offset:1152
  ds_read_b32 v99, v2 offset:1216
  s_waitcnt lgkmcnt(0)
  v_max3_f32 v88, v88, v96, v97
  v_max3_f32 v88, v88, v98, v99
  v_add_u32 v2, 155648, v1
  ds_read_b32 v96, v2 offset:0
  ds_read_b32 v97, v2 offset:64
  ds_read_b32 v98, v2 offset:128
  ds_read_b32 v99, v2 offset:192
  s_waitcnt lgkmcnt(0)
  v_max3_f32 v84, v84, v96, v97
  v_max3_f32 v84, v84, v98, v99
  ds_read_b32 v96, v2 offset:256
  ds_read_b32 v97, v2 offset:320
  ds_read_b32 v98, v2 offset:384
  ds_read_b32 v99, v2 offset:448
  s_waitcnt lgkmcnt(0)
  v_max3_f32 v85, v85, v96, v97
  v_max3_f32 v85, v85, v98, v99
  ds_read_b32 v96, v2 offset:512
  ds_read_b32 v97, v2 offset:576
  ds_read_b32 v98, v2 offset:640
  ds_read_b32 v99, v2 offset:704
  s_waitcnt lgkmcnt(0)
  v_max3_f32 v86, v86, v96, v97
  v_max3_f32 v86, v86, v98, v99
  ds_read_b32 v96, v2 offset:768
  ds_read_b32 v97, v2 offset:832
  ds_read_b32 v98, v2 offset:896
  ds_read_b32 v99, v2 offset:960
  s_waitcnt lgkmcnt(0)
  v_max3_f32 v87, v87, v96, v97
  v_max3_f32 v87, v87, v98, v99
  ds_read_b32 v96, v2 offset:1024
  ds_read_b32 v97, v2 offset:1088
  ds_read_b32 v98, v2 offset:1152
  ds_read_b32 v99, v2 offset:1216
  s_waitcnt lgkmcnt(0)
  v_max3_f32 v88, v88, v96, v97
  v_max3_f32 v88, v88, v98, v99
  s_barrier
  v_mov_b32 v89, v84
  v_mov_b32 v90, v85
  v_mov_b32 v91, v86
  v_mov_b32 v92, v87
  v_mov_b32 v93, v88
  v_mov_b32 v4, 0
  v_mov_b32 v5, 0
  v_mov_b32 v6, 0
  v_mov_b32 v7, 0
  s_nop 1
  v_mfma_f32_16x16x32_bf16 v[96:99], v[4:7], v[4:7], 0
  v_mfma_f32_16x16x32_bf16 v[100:103], v[4:7], v[4:7], 0
  v_mfma_f32_16x16x32_bf16 v[104:107], v[4:7], v[4:7], 0
  v_mfma_f32_16x16x32_bf16 v[108:111], v[4:7], v[4:7], 0
  v_mfma_f32_16x16x32_bf16 v[112:115], v[4:7], v[4:7], 0
  v_mfma_f32_16x16x32_bf16 v[116:119], v[4:7], v[4:7], 0
  v_mfma_f32_16x16x32_bf16 v[120:123], v[4:7], v[4:7], 0
  v_mfma_f32_16x16x32_bf16 v[124:127], v[4:7], v[4:7], 0
  v_mfma_f32_16x16x32_bf16 v[128:131], v[4:7], v[4:7], 0
  v_mfma_f32_16x16x32_bf16 v[132:135], v[4:7], v[4:7], 0
  v_mfma_f32_16x16x32_bf16 v[136:139], v[4:7], v[4:7], 0
  v_mfma_f32_16x16x32_bf16 v[140:143], v[4:7], v[4:7], 0
  v_mfma_f32_16x16x32_bf16 v[144:147], v[4:7], v[4:7], 0
  v_mfma_f32_16x16x32_bf16 v[148:151], v[4:7], v[4:7], 0
  v_mfma_f32_16x16x32_bf16 v[152:155], v[4:7], v[4:7], 0
  v_mfma_f32_16x16x32_bf16 v[156:159], v[4:7], v[4:7], 0
  v_mfma_f32_16x16x32_bf16 v[160:163], v[4:7], v[4:7], 0
  v_mfma_f32_16x16x32_bf16 v[164:167], v[4:7], v[4:7], 0
  v_mfma_f32_16x16x32_bf16 v[168:171], v[4:7], v[4:7], 0
  v_mfma_f32_16x16x32_bf16 v[172:175], v[4:7], v[4:7], 0
  v_mfma_f32_16x16x32_bf16 v[176:179], v[4:7], v[4:7], 0
  v_mfma_f32_16x16x32_bf16 v[180:183], v[4:7], v[4:7], 0
  v_mfma_f32_16x16x32_bf16 v[184:187], v[4:7], v[4:7], 0
  v_mfma_f32_16x16x32_bf16 v[188:191], v[4:7], v[4:7], 0
  v_mfma_f32_16x16x32_bf16 v[192:195], v[4:7], v[4:7], 0
  v_mfma_f32_16x16x32_bf16 v[196:199], v[4:7], v[4:7], 0
  v_mfma_f32_16x16x32_bf16 v[200:203], v[4:7], v[4:7], 0
  v_mfma_f32_16x16x32_bf16 v[204:207], v[4:7], v[4:7], 0
  v_mfma_f32_16x16x32_bf16 v[208:211], v[4:7], v[4:7], 0
  v_mfma_f32_16x16x32_bf16 v[212:215], v[4:7], v[4:7], 0
  v_mfma_f32_16x16x32_bf16 v[216:219], v[4:7], v[4:7], 0
  v_mfma_f32_16x16x32_bf16 v[220:223], v[4:7], v[4:7], 0
  v_mfma_f32_16x16x32_bf16 v[224:227], v[4:7], v[4:7], 0
  v_mfma_f32_16x16x32_bf16 v[228:231], v[4:7], v[4:7], 0
  v_mfma_f32_16x16x32_bf16 v[232:235], v[4:7], v[4:7], 0
  v_mfma_f32_16x16x32_bf16 v[236:239], v[4:7], v[4:7], 0
  v_mfma_f32_16x16x32_bf16 v[240:243], v[4:7], v[4:7], 0
  v_mfma_f32_16x16x32_bf16 v[244:247], v[4:7], v[4:7], 0
  v_mfma_f32_16x16x32_bf16 v[248:251], v[4:7], v[4:7], 0
  v_mfma_f32_16x16x32_bf16 v[252:255], v[4:7], v[4:7], 0
  v_mfma_f32_16x16x32_bf16 a[224:227], v[4:7], v[4:7], 0
  v_mfma_f32_16x16x32_bf16 a[228:231], v[4:7], v[4:7], 0
  v_mfma_f32_16x16x32_bf16 a[232:235], v[4:7], v[4:7], 0
  v_mfma_f32_16x16x32_bf16 a[236:239], v[4:7], v[4:7], 0
  v_mfma_f32_16x16x32_bf16 a[240:243], v[4:7], v[4:7], 0
  s_mov_b32 s69, s72
  s_mov_b32 s70, s72
  s_mov_b32 s71, 0
L_fb2:
  s_add_u32 m0, s64, 24576
  s_add_u32 s65, s69, 0
  buffer_load_dwordx4 v22, s[52:55], s65 offen offset:0 lds
  buffer_load_dwordx4 v23, s[52:55], s65 offen offset:1024 lds
  buffer_load_dwordx4 v24, s[52:55], s65 offen offset:2048 lds
  buffer_load_dwordx4 v25, s[52:55], s65 offen offset:3072 lds
  s_add_u32 m0, s64, 28672
  s_add_u32 s65, s69, 4096
  buffer_load_dwordx4 v22, s[52:55], s65 offen offset:0 lds
  buffer_load_dwordx4 v23, s[52:55], s65 offen offset:1024 lds
  buffer_load_dwordx4 v24, s[52:55], s65 offen offset:2048 lds
  buffer_load_dwordx4 v25, s[52:55], s65 offen offset:3072 lds
  s_add_u32 s69, s69, 32768
  s_add_u32 m0, s64, 32768
  s_add_u32 s66, s70, 0
  buffer_load_dwordx4 v26, s[56:59], s66 offen offset:0 lds
  buffer_load_dwordx4 v27, s[56:59], s66 offen offset:1024 lds
  buffer_load_dwordx4 v26, s[56:59], s66 offen offset:2048 lds
  buffer_load_dwordx4 v27, s[56:59], s66 offen offset:3072 lds
  s_add_u32 m0, s64, 36864
  s_add_u32 s66, s70, 4096
  buffer_load_dwordx4 v26, s[56:59], s66 offen offset:0 lds
  buffer_load_dwordx4 v27, s[56:59], s66 offen offset:1024 lds
  buffer_load_dwordx4 v26, s[56:59], s66 offen offset:2048 lds
  buffer_load_dwordx4 v27, s[56:59], s66 offen offset:3072 lds
  s_add_u32 s70, s70, 32768
  s_waitcnt vmcnt(0)
  ds_read_b128 a[160:163], v10 offset:24576
  ds_read_b128 a[164:167], v11 offset:24576
  ds_read_b128 a[168:171], v12 offset:24576
  ds_read_b128 a[172:175], v13 offset:24576
  ds_read_b128 a[176:179], v10 offset:28672
  ds_read_b128 a[180:183], v11 offset:28672
  ds_read_b128 a[184:187], v12 offset:28672
  ds_read_b128 a[188:191], v13 offset:28672
  ds_read_b64_tr_b16 a[192:193], v14 offset:32768
  ds_read_b64_tr_b16 a[194:195], v14 offset:36864
  ds_read_b64_tr_b16 a[196:197], v15 offset:32768
  ds_read_b64_tr_b16 a[198:199], v15 offset:36864
  ds_read_b64_tr_b16 a[200:201], v16 offset:32768
  ds_read_b64_tr_b16 a[202:203], v16 offset:36864
  ds_read_b64_tr_b16 a[204:205], v17 offset:32768
  ds_read_b64_tr_b16 a[206:207], v17 offset:36864
  ds_read_b64_tr_b16 a[208:209], v18 offset:32768
  ds_read_b64_tr_b16 a[210:211], v18 offset:36864
  ds_read_b64_tr_b16 a[212:213], v19 offset:32768
  ds_read_b64_tr_b16 a[214:215], v19 offset:36864
  ds_read_b64_tr_b16 a[216:217], v20 offset:32768
  ds_read_b64_tr_b16 a[218:219], v20 offset:36864
  ds_read_b64_tr_b16 a[220:221], v21 offset:32768
  ds_read_b64_tr_b16 a[222:223], v21 offset:36864
  s_waitcnt lgkmcnt(0)
  v_mfma_f32_16x16x32_bf16 v[40:43], a[160:163], a[0:3], 0
  v_mfma_f32_16x16x32_bf16 v[40:43], a[164:167], a[4:7], v[40:43]
  v_mfma_f32_16x16x32_bf16 v[40:43], a[168:171], a[8:11], v[40:43]
  v_mfma_f32_16x16x32_bf16 v[40:43], a[172:175], a[12:15], v[40:43]
  v_mfma_f32_16x16x32_bf16 v[44:47], a[176:179], a[0:3], 0
  v_mfma_f32_16x16x32_bf16 v[44:47], a[180:183], a[4:7], v[44:47]
  v_mfma_f32_16x16x32_bf16 v[44:47], a[184:187], a[8:11], v[44:47]
  v_mfma_f32_16x16x32_bf16 v[44:47], a[188:191], a[12:15], v[44:47]
  s_nop 7
  s_nop 7
  v_sub_f32 v40, v40, v89
  v_sub_f32 v41, v41, v89
  v_sub_f32 v42, v42, v89
  v_sub_f32 v43, v43, v89
  v_sub_f32 v44, v44, v89
  v_sub_f32 v45, v45, v89
  v_sub_f32 v46, v46, v89
  v_sub_f32 v47, v47, v89
  v_exp_f32 v40, v40
  s_nop 0
  v_exp_f32 v41, v41
  s_nop 0
  v_exp_f32 v42, v42
  s_nop 0
  v_exp_f32 v43, v43
  s_nop 0
  v_cvt_pk_bf16_f32 v64, v40, v41
  s_nop 0
  v_cvt_pk_bf16_f32 v65, v42, v43
  s_nop 0
  v_exp_f32 v44, v44
  s_nop 0
  v_exp_f32 v45, v45
  s_nop 0
  v_exp_f32 v46, v46
  s_nop 0
  v_exp_f32 v47, v47
  s_nop 0
  v_cvt_pk_bf16_f32 v66, v44, v45
  s_nop 0
  v_cvt_pk_bf16_f32 v67, v46, v47
  s_nop 0
  v_mfma_f32_16x16x32_bf16 v[48:51], a[160:163], a[16:19], 0
  v_mfma_f32_16x16x32_bf16 v[48:51], a[164:167], a[20:23], v[48:51]
  v_mfma_f32_16x16x32_bf16 v[48:51], a[168:171], a[24:27], v[48:51]
  v_mfma_f32_16x16x32_bf16 v[48:51], a[172:175], a[28:31], v[48:51]
  v_mfma_f32_16x16x32_bf16 v[52:55], a[176:179], a[16:19], 0
  v_mfma_f32_16x16x32_bf16 v[52:55], a[180:183], a[20:23], v[52:55]
  v_mfma_f32_16x16x32_bf16 v[52:55], a[184:187], a[24:27], v[52:55]
  v_mfma_f32_16x16x32_bf16 v[52:55], a[188:191], a[28:31], v[52:55]
  s_nop 7
  s_nop 7
  v_sub_f32 v48, v48, v90
  v_sub_f32 v49, v49, v90
  v_sub_f32 v50, v50, v90
  v_sub_f32 v51, v51, v90
  v_sub_f32 v52, v52, v90
  v_sub_f32 v53, v53, v90
  v_sub_f32 v54, v54, v90
  v_sub_f32 v55, v55, v90
  v_exp_f32 v48, v48
  s_nop 0
  v_exp_f32 v49, v49
  s_nop 0
  v_exp_f32 v50, v50
  s_nop 0
  v_exp_f32 v51, v51
  s_nop 0
  v_cvt_pk_bf16_f32 v68, v48, v49
  s_nop 0
  v_cvt_pk_bf16_f32 v69, v50, v51
  s_nop 0
  v_exp_f32 v52, v52
  s_nop 0
  v_exp_f32 v53, v53
  s_nop 0
  v_exp_f32 v54, v54
  s_nop 0
  v_exp_f32 v55, v55
  s_nop 0
  v_cvt_pk_bf16_f32 v70, v52, v53
  s_nop 0
  v_cvt_pk_bf16_f32 v71, v54, v55
  s_nop 0
  v_mfma_f32_16x16x32_bf16 v[56:59], a[160:163], a[32:35], 0
  v_mfma_f32_16x16x32_bf16 v[56:59], a[164:167], a[36:39], v[56:59]
  v_mfma_f32_16x16x32_bf16 v[56:59], a[168:171], a[40:43], v[56:59]
  v_mfma_f32_16x16x32_bf16 v[56:59], a[172:175], a[44:47], v[56:59]
  v_mfma_f32_16x16x32_bf16 v[60:63], a[176:179], a[32:35], 0
  v_mfma_f32_16x16x32_bf16 v[60:63], a[180:183], a[36:39], v[60:63]
  v_mfma_f32_16x16x32_bf16 v[60:63], a[184:187], a[40:43], v[60:63]
  v_mfma_f32_16x16x32_bf16 v[60:63], a[188:191], a[44:47], v[60:63]
  s_nop 7
  s_nop 7
  v_sub_f32 v56, v56, v91
  v_sub_f32 v57, v57, v91
  v_sub_f32 v58, v58, v91
  v_sub_f32 v59, v59, v91
  v_sub_f32 v60, v60, v91
  v_sub_f32 v61, v61, v91
  v_sub_f32 v62, v62, v91
  v_sub_f32 v63, v63, v91
  v_exp_f32 v56, v56
  s_nop 0
  v_exp_f32 v57, v57
  s_nop 0
  v_exp_f32 v58, v58
  s_nop 0
  v_exp_f32 v59, v59
  s_nop 0
  v_cvt_pk_bf16_f32 v72, v56, v57
  s_nop 0
  v_cvt_pk_bf16_f32 v73, v58, v59
  s_nop 0
  v_exp_f32 v60, v60
  s_nop 0
  v_exp_f32 v61, v61
  s_nop 0
  v_exp_f32 v62, v62
  s_nop 0
  v_exp_f32 v63, v63
  s_nop 0
  v_cvt_pk_bf16_f32 v74, v60, v61
  s_nop 0
  v_cvt_pk_bf16_f32 v75, v62, v63
  s_nop 0
  v_mfma_f32_16x16x32_bf16 v[40:43], a[160:163], a[48:51], 0
  v_mfma_f32_16x16x32_bf16 v[40:43], a[164:167], a[52:55], v[40:43]
  v_mfma_f32_16x16x32_bf16 v[40:43], a[168:171], a[56:59], v[40:43]
  v_mfma_f32_16x16x32_bf16 v[40:43], a[172:175], a[60:63], v[40:43]
  v_mfma_f32_16x16x32_bf16 v[44:47], a[176:179], a[48:51], 0
  v_mfma_f32_16x16x32_bf16 v[44:47], a[180:183], a[52:55], v[44:47]
  v_mfma_f32_16x16x32_bf16 v[44:47], a[184:187], a[56:59], v[44:47]
  v_mfma_f32_16x16x32_bf16 v[44:47], a[188:191], a[60:63], v[44:47]
  s_nop 7
  s_nop 7
  v_sub_f32 v40, v40, v92
  v_sub_f32 v41, v41, v92
  v_sub_f32 v42, v42, v92
  v_sub_f32 v43, v43, v92
  v_sub_f32 v44, v44, v92
  v_sub_f32 v45, v45, v92
  v_sub_f32 v46, v46, v92
  v_sub_f32 v47, v47, v92
  v_exp_f32 v40, v40
  s_nop 0
  v_exp_f32 v41, v41
  s_nop 0
  v_exp_f32 v42, v42
  s_nop 0
  v_exp_f32 v43, v43
  s_nop 0
  v_cvt_pk_bf16_f32 v76, v40, v41
  s_nop 0
  v_cvt_pk_bf16_f32 v77, v42, v43
  s_nop 0
  v_exp_f32 v44, v44
  s_nop 0
  v_exp_f32 v45, v45
  s_nop 0
  v_exp_f32 v46, v46
  s_nop 0
  v_exp_f32 v47, v47
  s_nop 0
  v_cvt_pk_bf16_f32 v78, v44, v45
  s_nop 0
  v_cvt_pk_bf16_f32 v79, v46, v47
  s_nop 0
  v_mfma_f32_16x16x32_bf16 v[48:51], a[160:163], a[64:67], 0
  v_mfma_f32_16x16x32_bf16 v[48:51], a[164:167], a[68:71], v[48:51]
  v_mfma_f32_16x16x32_bf16 v[48:51], a[168:171], a[72:75], v[48:51]
  v_mfma_f32_16x16x32_bf16 v[48:51], a[172:175], a[76:79], v[48:51]
  v_mfma_f32_16x16x32_bf16 v[52:55], a[176:179], a[64:67], 0
  v_mfma_f32_16x16x32_bf16 v[52:55], a[180:183], a[68:71], v[52:55]
  v_mfma_f32_16x16x32_bf16 v[52:55], a[184:187], a[72:75], v[52:55]
  v_mfma_f32_16x16x32_bf16 v[52:55], a[188:191], a[76:79], v[52:55]
  s_nop 7
  s_nop 7
  v_sub_f32 v48, v48, v93
  v_sub_f32 v49, v49, v93
  v_sub_f32 v50, v50, v93
  v_sub_f32 v51, v51, v93
  v_sub_f32 v52, v52, v93
  v_sub_f32 v53, v53, v93
  v_sub_f32 v54, v54, v93
  v_sub_f32 v55, v55, v93
  v_exp_f32 v48, v48
  s_nop 0
  v_exp_f32 v49, v49
  s_nop 0
  v_exp_f32 v50, v50
  s_nop 0
  v_exp_f32 v51, v51
  s_nop 0
  v_cvt_pk_bf16_f32 v80, v48, v49
  s_nop 0
  v_cvt_pk_bf16_f32 v81, v50, v51
  s_nop 0
  v_exp_f32 v52, v52
  s_nop 0
  v_exp_f32 v53, v53
  s_nop 0
  v_exp_f32 v54, v54
  s_nop 0
  v_exp_f32 v55, v55
  s_nop 0
  v_cvt_pk_bf16_f32 v82, v52, v53
  s_nop 0
  v_cvt_pk_bf16_f32 v83, v54, v55
  s_nop 0
  s_nop 3
  v_mfma_f32_16x16x32_bf16 v[96:99], a[192:195], v[64:67], v[96:99]
  v_mfma_f32_16x16x32_bf16 v[116:119], a[196:199], v[64:67], v[116:119]
  v_mfma_f32_16x16x32_bf16 v[136:139], a[200:203], v[64:67], v[136:139]
  v_mfma_f32_16x16x32_bf16 v[156:159], a[204:207], v[64:67], v[156:159]
  v_mfma_f32_16x16x32_bf16 v[176:179], a[208:211], v[64:67], v[176:179]
  v_mfma_f32_16x16x32_bf16 v[196:199], a[212:215], v[64:67], v[196:199]
  v_mfma_f32_16x16x32_bf16 v[216:219], a[216:219], v[64:67], v[216:219]
  v_mfma_f32_16x16x32_bf16 v[236:239], a[220:223], v[64:67], v[236:239]
  v_mfma_f32_16x16x32_bf16 a[224:227], a[244:247], v[64:67], a[224:227]
  v_mfma_f32_16x16x32_bf16 v[100:103], a[192:195], v[68:71], v[100:103]
  v_mfma_f32_16x16x32_bf16 v[120:123], a[196:199], v[68:71], v[120:123]
  v_mfma_f32_16x16x32_bf16 v[140:143], a[200:203], v[68:71], v[140:143]
  v_mfma_f32_16x16x32_bf16 v[160:163], a[204:207], v[68:71], v[160:163]
  v_mfma_f32_16x16x32_bf16 v[180:183], a[208:211], v[68:71], v[180:183]
  v_mfma_f32_16x16x32_bf16 v[200:203], a[212:215], v[68:71], v[200:203]
  v_mfma_f32_16x16x32_bf16 v[220:223], a[216:219], v[68:71], v[220:223]
  v_mfma_f32_16x16x32_bf16 v[240:243], a[220:223], v[68:71], v[240:243]
  v_mfma_f32_16x16x32_bf16 a[228:231], a[244:247], v[68:71], a[228:231]
  v_mfma_f32_16x16x32_bf16 v[104:107], a[192:195], v[72:75], v[104:107]
  v_mfma_f32_16x16x32_bf16 v[124:127], a[196:199], v[72:75], v[124:127]
  v_mfma_f32_16x16x32_bf16 v[144:147], a[200:203], v[72:75], v[144:147]
  v_mfma_f32_16x16x32_bf16 v[164:167], a[204:207], v[72:75], v[164:167]
  v_mfma_f32_16x16x32_bf16 v[184:187], a[208:211], v[72:75], v[184:187]
  v_mfma_f32_16x16x32_bf16 v[204:207], a[212:215], v[72:75], v[204:207]
  v_mfma_f32_16x16x32_bf16 v[224:227], a[216:219], v[72:75], v[224:227]
  v_mfma_f32_16x16x32_bf16 v[244:247], a[220:223], v[72:75], v[244:247]
  v_mfma_f32_16x16x32_bf16 a[232:235], a[244:247], v[72:75], a[232:235]
  v_mfma_f32_16x16x32_bf16 v[108:111], a[192:195], v[76:79], v[108:111]
  v_mfma_f32_16x16x32_bf16 v[128:131], a[196:199], v[76:79], v[128:131]
  v_mfma_f32_16x16x32_bf16 v[148:151], a[200:203], v[76:79], v[148:151]
  v_mfma_f32_16x16x32_bf16 v[168:171], a[204:207], v[76:79], v[168:171]
  v_mfma_f32_16x16x32_bf16 v[188:191], a[208:211], v[76:79], v[188:191]
  v_mfma_f32_16x16x32_bf16 v[208:211], a[212:215], v[76:79], v[208:211]
  v_mfma_f32_16x16x32_bf16 v[228:231], a[216:219], v[76:79], v[228:231]
  v_mfma_f32_16x16x32_bf16 v[248:251], a[220:223], v[76:79], v[248:251]
  v_mfma_f32_16x16x32_bf16 a[236:239], a[244:247], v[76:79], a[236:239]
  v_mfma_f32_16x16x32_bf16 v[112:115], a[192:195], v[80:83], v[112:115]
  v_mfma_f32_16x16x32_bf16 v[132:135], a[196:199], v[80:83], v[132:135]
  v_mfma_f32_16x16x32_bf16 v[152:155], a[200:203], v[80:83], v[152:155]
  v_mfma_f32_16x16x32_bf16 v[172:175], a[204:207], v[80:83], v[172:175]
  v_mfma_f32_16x16x32_bf16 v[192:195], a[208:211], v[80:83], v[192:195]
  v_mfma_f32_16x16x32_bf16 v[212:215], a[212:215], v[80:83], v[212:215]
  v_mfma_f32_16x16x32_bf16 v[232:235], a[216:219], v[80:83], v[232:235]
  v_mfma_f32_16x16x32_bf16 v[252:255], a[220:223], v[80:83], v[252:255]
  v_mfma_f32_16x16x32_bf16 a[240:243], a[244:247], v[80:83], a[240:243]
  s_add_u32 s71, s71, 1
  s_cmp_lt_u32 s71, 16
  s_cbranch_scc1 L_fb2
  s_nop 7
  s_nop 7
  s_call_b64 s[96:97], L_rso
  v_rcp_f32 v84, v84
  v_rcp_f32 v85, v85
  v_rcp_f32 v86, v86
  v_rcp_f32 v87, v87
  v_rcp_f32 v88, v88
  s_nop 0
  v_mul_f32 v96, v84, v96
  v_mul_f32 v97, v84, v97
  v_mul_f32 v98, v84, v98
  v_mul_f32 v99, v84, v99
  v_mul_f32 v116, v84, v116
  v_mul_f32 v117, v84, v117
  v_mul_f32 v118, v84, v118
  v_mul_f32 v119, v84, v119
  v_mul_f32 v100, v85, v100
  v_mul_f32 v101, v85, v101
  v_mul_f32 v102, v85, v102
  v_mul_f32 v103, v85, v103
  v_mul_f32 v120, v85, v120
  v_mul_f32 v121, v85, v121
  v_mul_f32 v122, v85, v122
  v_mul_f32 v123, v85, v123
  v_mul_f32 v104, v86, v104
  v_mul_f32 v105, v86, v105
  v_mul_f32 v106, v86, v106
  v_mul_f32 v107, v86, v107
  v_mul_f32 v124, v86, v124
  v_mul_f32 v125, v86, v125
  v_mul_f32 v126, v86, v126
  v_mul_f32 v127, v86, v127
  v_mul_f32 v108, v87, v108
  v_mul_f32 v109, v87, v109
  v_mul_f32 v110, v87, v110
  v_mul_f32 v111, v87, v111
  v_mul_f32 v128, v87, v128
  v_mul_f32 v129, v87, v129
  v_mul_f32 v130, v87, v130
  v_mul_f32 v131, v87, v131
  v_mul_f32 v112, v88, v112
  v_mul_f32 v113, v88, v113
  v_mul_f32 v114, v88, v114
  v_mul_f32 v115, v88, v115
  v_mul_f32 v132, v88, v132
  v_mul_f32 v133, v88, v133
  v_mul_f32 v134, v88, v134
  v_mul_f32 v135, v88, v135
  v_cvt_pk_bf16_f32 v64, v96, v97
  v_cvt_pk_bf16_f32 v65, v98, v99
  v_cvt_pk_bf16_f32 v66, v116, v117
  v_cvt_pk_bf16_f32 v67, v118, v119
  v_cvt_pk_bf16_f32 v68, v100, v101
  v_cvt_pk_bf16_f32 v69, v102, v103
  v_cvt_pk_bf16_f32 v70, v120, v121
  v_cvt_pk_bf16_f32 v71, v122, v123
  v_cvt_pk_bf16_f32 v72, v104, v105
  v_cvt_pk_bf16_f32 v73, v106, v107
  v_cvt_pk_bf16_f32 v74, v124, v125
  v_cvt_pk_bf16_f32 v75, v126, v127
  v_cvt_pk_bf16_f32 v76, v108, v109
  v_cvt_pk_bf16_f32 v77, v110, v111
  v_cvt_pk_bf16_f32 v78, v128, v129
  v_cvt_pk_bf16_f32 v79, v130, v131
  v_cvt_pk_bf16_f32 v80, v112, v113
  v_cvt_pk_bf16_f32 v81, v114, v115
  v_cvt_pk_bf16_f32 v82, v132, v133
  v_cvt_pk_bf16_f32 v83, v134, v135
  s_mul_i32 s65, s34, 5120
  buffer_store_dwordx4 v[64:67], v35, s[60:63], s65 offen offset:0 sc1
  buffer_store_dwordx4 v[68:71], v35, s[60:63], s65 offen offset:1024 sc1
  buffer_store_dwordx4 v[72:75], v35, s[60:63], s65 offen offset:2048 sc1
  buffer_store_dwordx4 v[76:79], v35, s[60:63], s65 offen offset:3072 sc1
  s_add_u32 s65, s65, 4096
  buffer_store_dwordx4 v[80:83], v35, s[60:63], s65 offen sc1
  s_waitcnt vmcnt(0) lgkmcnt(0)
  s_barrier
  s_mov_b32 s52, s76
  s_mov_b32 s53, s77
  s_mov_b32 s54, s78
  s_mov_b32 s55, s79
  s_mov_b32 s56, s80
  s_mov_b32 s57, s81
  s_mov_b32 s58, s82
  s_mov_b32 s59, s83
  s_mov_b32 s69, s84
  s_mov_b32 s70, s85
  s_setpc_b64 s[92:93]
.p2align 6
L_attA:
L_attA_l:
  s_waitcnt vmcnt(16)
  s_lshl_b32 s98, s71, 1
  s_add_u32 s98, s98, 4
  s_and_b32 s99, s98, 15
  s_lshl_b32 s67, s34, 2
  s_add_u32 s67, s67, s38
  s_cmp_eq_u32 s99, s67
  s_cbranch_scc0 L_pf_24
  s_lshl_b32 s98, s98, 15
  buffer_load_dword v6, v1, s[52:55], s98 offen
  buffer_load_dword v7, v1, s[56:59], s98 offen
  s_add_u32 s98, s98, 8192
  buffer_load_dword v6, v1, s[52:55], s98 offen
  buffer_load_dword v7, v1, s[56:59], s98 offen
  s_add_u32 s98, s98, 8192
  buffer_load_dword v6, v1, s[52:55], s98 offen
  buffer_load_dword v7, v1, s[56:59], s98 offen
  s_add_u32 s98, s98, 8192
  buffer_load_dword v6, v1, s[52:55], s98 offen
  buffer_load_dword v7, v1, s[56:59], s98 offen
  s_add_u32 s98, s98, 8192
L_pf_24:
  buffer_load_dword v39, v38, s[4:7], 0 offen sc1
  v_mfma_f32_16x16x32_bf16 v[40:43], a[160:163], a[0:3], 0
  ds_read_b64_tr_b16 a[192:193], v14 offset:8192
  ds_read_b64_tr_b16 a[194:195], v14 offset:12288
  v_mfma_f32_16x16x32_bf16 v[40:43], a[164:167], a[4:7], v[40:43]
  ds_read_b64_tr_b16 a[196:197], v15 offset:8192
  ds_read_b64_tr_b16 a[198:199], v15 offset:12288
  v_mfma_f32_16x16x32_bf16 v[40:43], a[168:171], a[8:11], v[40:43]
  ds_read_b64_tr_b16 a[200:201], v16 offset:8192
  ds_read_b64_tr_b16 a[202:203], v16 offset:12288
  v_mfma_f32_16x16x32_bf16 v[40:43], a[172:175], a[12:15], v[40:43]
  ds_read_b64_tr_b16 a[204:205], v17 offset:8192
  ds_read_b64_tr_b16 a[206:207], v17 offset:12288
  v_mfma_f32_16x16x32_bf16 v[44:47], a[176:179], a[0:3], 0
  ds_read_b64_tr_b16 a[208:209], v18 offset:8192
  ds_read_b64_tr_b16 a[210:211], v18 offset:12288
  v_mfma_f32_16x16x32_bf16 v[44:47], a[180:183], a[4:7], v[44:47]
  ds_read_b64_tr_b16 a[212:213], v19 offset:8192
  ds_read_b64_tr_b16 a[214:215], v19 offset:12288
  v_mfma_f32_16x16x32_bf16 v[44:47], a[184:187], a[8:11], v[44:47]
  s_add_u32 m0, s64, 0
  s_add_u32 s65, s69, 0
  v_mfma_f32_16x16x32_bf16 v[44:47], a[188:191], a[12:15], v[44:47]
  buffer_load_dwordx4 v22, s[52:55], s65 offen offset:0 lds
  v_mfma_f32_16x16x32_bf16 v[48:51], a[160:163], a[16:19], 0
  v_exp_f32 v40, v40
  v_exp_f32 v41, v41
  v_exp_f32 v42, v42
  v_mfma_f32_16x16x32_bf16 v[48:51], a[164:167], a[20:23], v[48:51]
  v_exp_f32 v43, v43
  v_cvt_pk_bf16_f32 v64, v40, v41
  v_mfma_f32_16x16x32_bf16 v[48:51], a[168:171], a[24:27], v[48:51]
  v_cvt_pk_bf16_f32 v65, v42, v43
  v_exp_f32 v44, v44
  v_mfma_f32_16x16x32_bf16 v[48:51], a[172:175], a[28:31], v[48:51]
  v_exp_f32 v45, v45
  v_exp_f32 v46, v46
  v_mfma_f32_16x16x32_bf16 v[52:55], a[176:179], a[16:19], 0
  v_exp_f32 v47, v47
  v_cvt_pk_bf16_f32 v66, v44, v45
  v_cvt_pk_bf16_f32 v67, v46, v47
  v_mfma_f32_16x16x32_bf16 v[52:55], a[180:183], a[20:23], v[52:55]
  ds_read_b64_tr_b16 a[216:217], v20 offset:8192
  ds_read_b64_tr_b16 a[218:219], v20 offset:12288
  v_mfma_f32_16x16x32_bf16 v[52:55], a[184:187], a[24:27], v[52:55]
  ds_read_b64_tr_b16 a[220:221], v21 offset:8192
  ds_read_b64_tr_b16 a[222:223], v21 offset:12288
  v_mfma_f32_16x16x32_bf16 v[52:55], a[188:191], a[28:31], v[52:55]
  buffer_load_dwordx4 v23, s[52:55], s65 offen offset:1024 lds
  buffer_load_dwordx4 v24, s[52:55], s65 offen offset:2048 lds
  v_mfma_f32_16x16x32_bf16 v[56:59], a[160:163], a[32:35], 0
  v_exp_f32 v48, v48
  v_exp_f32 v49, v49
  v_mfma_f32_16x16x32_bf16 v[56:59], a[164:167], a[36:39], v[56:59]
  v_exp_f32 v50, v50
  v_exp_f32 v51, v51
  v_mfma_f32_16x16x32_bf16 v[56:59], a[168:171], a[40:43], v[56:59]
  v_cvt_pk_bf16_f32 v68, v48, v49
  v_cvt_pk_bf16_f32 v69, v50, v51
  v_mfma_f32_16x16x32_bf16 v[56:59], a[172:175], a[44:47], v[56:59]
  v_exp_f32 v52, v52
  v_exp_f32 v53, v53
  v_mfma_f32_16x16x32_bf16 v[60:63], a[176:179], a[32:35], 0
  v_exp_f32 v54, v54
  v_exp_f32 v55, v55
  v_mfma_f32_16x16x32_bf16 v[60:63], a[180:183], a[36:39], v[60:63]
  v_cvt_pk_bf16_f32 v70, v52, v53
  v_cvt_pk_bf16_f32 v71, v54, v55
  v_mfma_f32_16x16x32_bf16 v[60:63], a[184:187], a[40:43], v[60:63]
  buffer_load_dwordx4 v25, s[52:55], s65 offen offset:3072 lds
  s_add_u32 m0, s64, 4096
  v_mfma_f32_16x16x32_bf16 v[60:63], a[188:191], a[44:47], v[60:63]
  s_add_u32 s65, s69, 4096
  v_mfma_f32_16x16x32_bf16 v[40:43], a[160:163], a[48:51], 0
  v_exp_f32 v56, v56
  v_exp_f32 v57, v57
  v_mfma_f32_16x16x32_bf16 v[40:43], a[164:167], a[52:55], v[40:43]
  v_exp_f32 v58, v58
  v_exp_f32 v59, v59
  v_mfma_f32_16x16x32_bf16 v[40:43], a[168:171], a[56:59], v[40:43]
  v_cvt_pk_bf16_f32 v72, v56, v57
  v_cvt_pk_bf16_f32 v73, v58, v59
  v_mfma_f32_16x16x32_bf16 v[40:43], a[172:175], a[60:63], v[40:43]
  v_exp_f32 v60, v60
  v_mfma_f32_16x16x32_bf16 v[44:47], a[176:179], a[48:51], 0
  v_exp_f32 v61, v61
  v_exp_f32 v62, v62
  v_mfma_f32_16x16x32_bf16 v[44:47], a[180:183], a[52:55], v[44:47]
  v_exp_f32 v63, v63
  v_cvt_pk_bf16_f32 v74, v60, v61
  v_mfma_f32_16x16x32_bf16 v[44:47], a[184:187], a[56:59], v[44:47]
  v_cvt_pk_bf16_f32 v75, v62, v63
  buffer_load_dwordx4 v22, s[52:55], s65 offen offset:0 lds
  v_mfma_f32_16x16x32_bf16 v[44:47], a[188:191], a[60:63], v[44:47]
  buffer_load_dwordx4 v23, s[52:55], s65 offen offset:1024 lds
  v_mfma_f32_16x16x32_bf16 v[48:51], a[160:163], a[64:67], 0
  v_exp_f32 v40, v40
  v_exp_f32 v41, v41
  v_mfma_f32_16x16x32_bf16 v[48:51], a[164:167], a[68:71], v[48:51]
  v_exp_f32 v42, v42
  v_exp_f32 v43, v43
  v_mfma_f32_16x16x32_bf16 v[48:51], a[168:171], a[72:75], v[48:51]
  v_cvt_pk_bf16_f32 v76, v40, v41
  v_cvt_pk_bf16_f32 v77, v42, v43
  v_mfma_f32_16x16x32_bf16 v[48:51], a[172:175], a[76:79], v[48:51]
  v_exp_f32 v44, v44
  v_exp_f32 v45, v45
  v_mfma_f32_16x16x32_bf16 v[52:55], a[176:179], a[64:67], 0
  v_exp_f32 v46, v46
  v_exp_f32 v47, v47
  v_mfma_f32_16x16x32_bf16 v[52:55], a[180:183], a[68:71], v[52:55]
  v_cvt_pk_bf16_f32 v78, v44, v45
  v_cvt_pk_bf16_f32 v79, v46, v47
  v_mfma_f32_16x16x32_bf16 v[52:55], a[184:187], a[72:75], v[52:55]
  buffer_load_dwordx4 v24, s[52:55], s65 offen offset:2048 lds
  buffer_load_dwordx4 v25, s[52:55], s65 offen offset:3072 lds
  v_mfma_f32_16x16x32_bf16 v[52:55], a[188:191], a[76:79], v[52:55]
  s_add_u32 s69, s69, 32768
  s_waitcnt lgkmcnt(0)
  s_cmp_eq_u32 s71, 0
  s_cbranch_scc1 L_pv_25_f
  v_mfma_f32_16x16x32_bf16 v[96:99], a[192:195], v[64:67], v[96:99]
  v_exp_f32 v48, v48
  v_exp_f32 v49, v49
  v_mfma_f32_16x16x32_bf16 v[116:119], a[196:199], v[64:67], v[116:119]
  v_exp_f32 v50, v50
  v_mfma_f32_16x16x32_bf16 v[136:139], a[200:203], v[64:67], v[136:139]
  v_exp_f32 v51, v51
  v_mfma_f32_16x16x32_bf16 v[156:159], a[204:207], v[64:67], v[156:159]
  v_cvt_pk_bf16_f32 v80, v48, v49
  v_cvt_pk_bf16_f32 v81, v50, v51
  v_mfma_f32_16x16x32_bf16 v[176:179], a[208:211], v[64:67], v[176:179]
  v_exp_f32 v52, v52
  v_mfma_f32_16x16x32_bf16 v[196:199], a[212:215], v[64:67], v[196:199]
  v_exp_f32 v53, v53
  v_mfma_f32_16x16x32_bf16 v[216:219], a[216:219], v[64:67], v[216:219]
  v_exp_f32 v54, v54
  v_exp_f32 v55, v55
  v_mfma_f32_16x16x32_bf16 v[236:239], a[220:223], v[64:67], v[236:239]
  v_cvt_pk_bf16_f32 v82, v52, v53
  v_mfma_f32_16x16x32_bf16 a[224:227], a[244:247], v[64:67], a[224:227]
  v_cvt_pk_bf16_f32 v83, v54, v55
  s_waitcnt vmcnt(17)
  v_mfma_f32_16x16x32_bf16 v[100:103], a[192:195], v[68:71], v[100:103]
  ds_read_b128 a[160:163], v10 offset:16384
  ds_read_b128 a[164:167], v11 offset:16384
  v_mfma_f32_16x16x32_bf16 v[120:123], a[196:199], v[68:71], v[120:123]
  ds_read_b128 a[168:171], v12 offset:16384
  v_mfma_f32_16x16x32_bf16 v[140:143], a[200:203], v[68:71], v[140:143]
  ds_read_b128 a[172:175], v13 offset:16384
  v_mfma_f32_16x16x32_bf16 v[160:163], a[204:207], v[68:71], v[160:163]
  ds_read_b128 a[176:179], v10 offset:20480
  ds_read_b128 a[180:183], v11 offset:20480
  v_mfma_f32_16x16x32_bf16 v[180:183], a[208:211], v[68:71], v[180:183]
  ds_read_b128 a[184:187], v12 offset:20480
  v_mfma_f32_16x16x32_bf16 v[200:203], a[212:215], v[68:71], v[200:203]
  ds_read_b128 a[188:191], v13 offset:20480
  v_mfma_f32_16x16x32_bf16 v[220:223], a[216:219], v[68:71], v[220:223]
  s_add_u32 m0, s64, 8192
  s_add_u32 s66, s70, 0
  v_mfma_f32_16x16x32_bf16 v[240:243], a[220:223], v[68:71], v[240:243]
  buffer_load_dwordx4 v26, s[56:59], s66 offen offset:0 lds
  v_mfma_f32_16x16x32_bf16 a[228:231], a[244:247], v[68:71], a[228:231]
  buffer_load_dwordx4 v27, s[56:59], s66 offen offset:1024 lds
  v_mfma_f32_16x16x32_bf16 v[104:107], a[192:195], v[72:75], v[104:107]
  buffer_load_dwordx4 v26, s[56:59], s66 offen offset:2048 lds
  v_mfma_f32_16x16x32_bf16 v[124:127], a[196:199], v[72:75], v[124:127]
  v_mfma_f32_16x16x32_bf16 v[144:147], a[200:203], v[72:75], v[144:147]
  buffer_load_dwordx4 v27, s[56:59], s66 offen offset:3072 lds
  v_mfma_f32_16x16x32_bf16 v[164:167], a[204:207], v[72:75], v[164:167]
  v_mfma_f32_16x16x32_bf16 v[184:187], a[208:211], v[72:75], v[184:187]
  s_add_u32 m0, s64, 12288
  v_mfma_f32_16x16x32_bf16 v[204:207], a[212:215], v[72:75], v[204:207]
  v_mfma_f32_16x16x32_bf16 v[224:227], a[216:219], v[72:75], v[224:227]
  s_add_u32 s66, s70, 4096
  v_mfma_f32_16x16x32_bf16 v[244:247], a[220:223], v[72:75], v[244:247]
  v_mfma_f32_16x16x32_bf16 a[232:235], a[244:247], v[72:75], a[232:235]
  v_mfma_f32_16x16x32_bf16 v[108:111], a[192:195], v[76:79], v[108:111]
  buffer_load_dwordx4 v26, s[56:59], s66 offen offset:0 lds
  v_mfma_f32_16x16x32_bf16 v[128:131], a[196:199], v[76:79], v[128:131]
  buffer_load_dwordx4 v27, s[56:59], s66 offen offset:1024 lds
  v_mfma_f32_16x16x32_bf16 v[148:151], a[200:203], v[76:79], v[148:151]
  v_mfma_f32_16x16x32_bf16 v[168:171], a[204:207], v[76:79], v[168:171]
  buffer_load_dwordx4 v26, s[56:59], s66 offen offset:2048 lds
  v_mfma_f32_16x16x32_bf16 v[188:191], a[208:211], v[76:79], v[188:191]
  v_mfma_f32_16x16x32_bf16 v[208:211], a[212:215], v[76:79], v[208:211]
  buffer_load_dwordx4 v27, s[56:59], s66 offen offset:3072 lds
  v_mfma_f32_16x16x32_bf16 v[228:231], a[216:219], v[76:79], v[228:231]
  v_mfma_f32_16x16x32_bf16 v[248:251], a[220:223], v[76:79], v[248:251]
  s_add_u32 s70, s70, 32768
  v_mfma_f32_16x16x32_bf16 a[236:239], a[244:247], v[76:79], a[236:239]
  v_mfma_f32_16x16x32_bf16 v[112:115], a[192:195], v[80:83], v[112:115]
  v_mfma_f32_16x16x32_bf16 v[132:135], a[196:199], v[80:83], v[132:135]
  v_mfma_f32_16x16x32_bf16 v[152:155], a[200:203], v[80:83], v[152:155]
  v_mfma_f32_16x16x32_bf16 v[172:175], a[204:207], v[80:83], v[172:175]
  v_mfma_f32_16x16x32_bf16 v[192:195], a[208:211], v[80:83], v[192:195]
  v_mfma_f32_16x16x32_bf16 v[212:215], a[212:215], v[80:83], v[212:215]
  v_mfma_f32_16x16x32_bf16 v[232:235], a[216:219], v[80:83], v[232:235]
  v_mfma_f32_16x16x32_bf16 v[252:255], a[220:223], v[80:83], v[252:255]
  v_mfma_f32_16x16x32_bf16 a[240:243], a[244:247], v[80:83], a[240:243]
  s_branch L_pv_25_e
L_pv_25_f:
  v_mfma_f32_16x16x32_bf16 v[96:99], a[192:195], v[64:67], 0
  v_exp_f32 v48, v48
  v_exp_f32 v49, v49
  v_mfma_f32_16x16x32_bf16 v[116:119], a[196:199], v[64:67], 0
  v_exp_f32 v50, v50
  v_mfma_f32_16x16x32_bf16 v[136:139], a[200:203], v[64:67], 0
  v_exp_f32 v51, v51
  v_mfma_f32_16x16x32_bf16 v[156:159], a[204:207], v[64:67], 0
  v_cvt_pk_bf16_f32 v80, v48, v49
  v_cvt_pk_bf16_f32 v81, v50, v51
  v_mfma_f32_16x16x32_bf16 v[176:179], a[208:211], v[64:67], 0
  v_exp_f32 v52, v52
  v_mfma_f32_16x16x32_bf16 v[196:199], a[212:215], v[64:67], 0
  v_exp_f32 v53, v53
  v_mfma_f32_16x16x32_bf16 v[216:219], a[216:219], v[64:67], 0
  v_exp_f32 v54, v54
  v_exp_f32 v55, v55
  v_mfma_f32_16x16x32_bf16 v[236:239], a[220:223], v[64:67], 0
  v_cvt_pk_bf16_f32 v82, v52, v53
  v_mfma_f32_16x16x32_bf16 a[224:227], a[244:247], v[64:67], 0
  v_cvt_pk_bf16_f32 v83, v54, v55
  s_waitcnt vmcnt(17)
  v_mfma_f32_16x16x32_bf16 v[100:103], a[192:195], v[68:71], 0
  ds_read_b128 a[160:163], v10 offset:16384
  ds_read_b128 a[164:167], v11 offset:16384
  v_mfma_f32_16x16x32_bf16 v[120:123], a[196:199], v[68:71], 0
  ds_read_b128 a[168:171], v12 offset:16384
  v_mfma_f32_16x16x32_bf16 v[140:143], a[200:203], v[68:71], 0
  ds_read_b128 a[172:175], v13 offset:16384
  v_mfma_f32_16x16x32_bf16 v[160:163], a[204:207], v[68:71], 0
  ds_read_b128 a[176:179], v10 offset:20480
  ds_read_b128 a[180:183], v11 offset:20480
  v_mfma_f32_16x16x32_bf16 v[180:183], a[208:211], v[68:71], 0
  ds_read_b128 a[184:187], v12 offset:20480
  v_mfma_f32_16x16x32_bf16 v[200:203], a[212:215], v[68:71], 0
  ds_read_b128 a[188:191], v13 offset:20480
  v_mfma_f32_16x16x32_bf16 v[220:223], a[216:219], v[68:71], 0
  s_add_u32 m0, s64, 8192
  s_add_u32 s66, s70, 0
  v_mfma_f32_16x16x32_bf16 v[240:243], a[220:223], v[68:71], 0
  buffer_load_dwordx4 v26, s[56:59], s66 offen offset:0 lds
  v_mfma_f32_16x16x32_bf16 a[228:231], a[244:247], v[68:71], 0
  buffer_load_dwordx4 v27, s[56:59], s66 offen offset:1024 lds
  v_mfma_f32_16x16x32_bf16 v[104:107], a[192:195], v[72:75], 0
  buffer_load_dwordx4 v26, s[56:59], s66 offen offset:2048 lds
  v_mfma_f32_16x16x32_bf16 v[124:127], a[196:199], v[72:75], 0
  v_mfma_f32_16x16x32_bf16 v[144:147], a[200:203], v[72:75], 0
  buffer_load_dwordx4 v27, s[56:59], s66 offen offset:3072 lds
  v_mfma_f32_16x16x32_bf16 v[164:167], a[204:207], v[72:75], 0
  v_mfma_f32_16x16x32_bf16 v[184:187], a[208:211], v[72:75], 0
  s_add_u32 m0, s64, 12288
  v_mfma_f32_16x16x32_bf16 v[204:207], a[212:215], v[72:75], 0
  v_mfma_f32_16x16x32_bf16 v[224:227], a[216:219], v[72:75], 0
  s_add_u32 s66, s70, 4096
  v_mfma_f32_16x16x32_bf16 v[244:247], a[220:223], v[72:75], 0
  v_mfma_f32_16x16x32_bf16 a[232:235], a[244:247], v[72:75], 0
  v_mfma_f32_16x16x32_bf16 v[108:111], a[192:195], v[76:79], 0
  buffer_load_dwordx4 v26, s[56:59], s66 offen offset:0 lds
  v_mfma_f32_16x16x32_bf16 v[128:131], a[196:199], v[76:79], 0
  buffer_load_dwordx4 v27, s[56:59], s66 offen offset:1024 lds
  v_mfma_f32_16x16x32_bf16 v[148:151], a[200:203], v[76:79], 0
  v_mfma_f32_16x16x32_bf16 v[168:171], a[204:207], v[76:79], 0
  buffer_load_dwordx4 v26, s[56:59], s66 offen offset:2048 lds
  v_mfma_f32_16x16x32_bf16 v[188:191], a[208:211], v[76:79], 0
  v_mfma_f32_16x16x32_bf16 v[208:211], a[212:215], v[76:79], 0
  buffer_load_dwordx4 v27, s[56:59], s66 offen offset:3072 lds
  v_mfma_f32_16x16x32_bf16 v[228:231], a[216:219], v[76:79], 0
  v_mfma_f32_16x16x32_bf16 v[248:251], a[220:223], v[76:79], 0
  s_add_u32 s70, s70, 32768
  v_mfma_f32_16x16x32_bf16 a[236:239], a[244:247], v[76:79], 0
  v_mfma_f32_16x16x32_bf16 v[112:115], a[192:195], v[80:83], 0
  v_mfma_f32_16x16x32_bf16 v[132:135], a[196:199], v[80:83], 0
  v_mfma_f32_16x16x32_bf16 v[152:155], a[200:203], v[80:83], 0
  v_mfma_f32_16x16x32_bf16 v[172:175], a[204:207], v[80:83], 0
  v_mfma_f32_16x16x32_bf16 v[192:195], a[208:211], v[80:83], 0
  v_mfma_f32_16x16x32_bf16 v[212:215], a[212:215], v[80:83], 0
  v_mfma_f32_16x16x32_bf16 v[232:235], a[216:219], v[80:83], 0
  v_mfma_f32_16x16x32_bf16 v[252:255], a[220:223], v[80:83], 0
  v_mfma_f32_16x16x32_bf16 a[240:243], a[244:247], v[80:83], 0
L_pv_25_e:
  s_waitcnt lgkmcnt(0)
  s_waitcnt vmcnt(17)
  s_lshl_b32 s98, s71, 1
  s_add_u32 s98, s98, 5
  s_and_b32 s99, s98, 15
  s_lshl_b32 s67, s34, 2
  s_add_u32 s67, s67, s38
  s_cmp_eq_u32 s99, s67
  s_cbranch_scc0 L_pf_26
  s_lshl_b32 s98, s98, 15
  buffer_load_dword v8, v1, s[52:55], s98 offen
  buffer_load_dword v9, v1, s[56:59], s98 offen
  s_add_u32 s98, s98, 8192
  buffer_load_dword v8, v1, s[52:55], s98 offen
  buffer_load_dword v9, v1, s[56:59], s98 offen
  s_add_u32 s98, s98, 8192
  buffer_load_dword v8, v1, s[52:55], s98 offen
  buffer_load_dword v9, v1, s[56:59], s98 offen
  s_add_u32 s98, s98, 8192
  buffer_load_dword v8, v1, s[52:55], s98 offen
  buffer_load_dword v9, v1, s[56:59], s98 offen
  s_add_u32 s98, s98, 8192
L_pf_26:
  v_mfma_f32_16x16x32_bf16 v[40:43], a[160:163], a[0:3], 0
  ds_read_b64_tr_b16 a[192:193], v14 offset:24576
  ds_read_b64_tr_b16 a[194:195], v14 offset:28672
  v_mfma_f32_16x16x32_bf16 v[40:43], a[164:167], a[4:7], v[40:43]
  ds_read_b64_tr_b16 a[196:197], v15 offset:24576
  ds_read_b64_tr_b16 a[198:199], v15 offset:28672
  v_mfma_f32_16x16x32_bf16 v[40:43], a[168:171], a[8:11], v[40:43]
  ds_read_b64_tr_b16 a[200:201], v16 offset:24576
  ds_read_b64_tr_b16 a[202:203], v16 offset:28672
  v_mfma_f32_16x16x32_bf16 v[40:43], a[172:175], a[12:15], v[40:43]
  ds_read_b64_tr_b16 a[204:205], v17 offset:24576
  ds_read_b64_tr_b16 a[206:207], v17 offset:28672
  v_mfma_f32_16x16x32_bf16 v[44:47], a[176:179], a[0:3], 0
  ds_read_b64_tr_b16 a[208:209], v18 offset:24576
  ds_read_b64_tr_b16 a[210:211], v18 offset:28672
  v_mfma_f32_16x16x32_bf16 v[44:47], a[180:183], a[4:7], v[44:47]
  ds_read_b64_tr_b16 a[212:213], v19 offset:24576
  ds_read_b64_tr_b16 a[214:215], v19 offset:28672
  v_mfma_f32_16x16x32_bf16 v[44:47], a[184:187], a[8:11], v[44:47]
  s_add_u32 m0, s64, 16384
  s_add_u32 s65, s69, 0
  v_mfma_f32_16x16x32_bf16 v[44:47], a[188:191], a[12:15], v[44:47]
  buffer_load_dwordx4 v22, s[52:55], s65 offen offset:0 lds
  v_mfma_f32_16x16x32_bf16 v[48:51], a[160:163], a[16:19], 0
  v_exp_f32 v40, v40
  v_exp_f32 v41, v41
  v_exp_f32 v42, v42
  v_mfma_f32_16x16x32_bf16 v[48:51], a[164:167], a[20:23], v[48:51]
  v_exp_f32 v43, v43
  v_cvt_pk_bf16_f32 v64, v40, v41
  v_mfma_f32_16x16x32_bf16 v[48:51], a[168:171], a[24:27], v[48:51]
  v_cvt_pk_bf16_f32 v65, v42, v43
  v_exp_f32 v44, v44
  v_mfma_f32_16x16x32_bf16 v[48:51], a[172:175], a[28:31], v[48:51]
  v_exp_f32 v45, v45
  v_exp_f32 v46, v46
  v_mfma_f32_16x16x32_bf16 v[52:55], a[176:179], a[16:19], 0
  v_exp_f32 v47, v47
  v_cvt_pk_bf16_f32 v66, v44, v45
  v_cvt_pk_bf16_f32 v67, v46, v47
  v_mfma_f32_16x16x32_bf16 v[52:55], a[180:183], a[20:23], v[52:55]
  ds_read_b64_tr_b16 a[216:217], v20 offset:24576
  ds_read_b64_tr_b16 a[218:219], v20 offset:28672
  v_mfma_f32_16x16x32_bf16 v[52:55], a[184:187], a[24:27], v[52:55]
  ds_read_b64_tr_b16 a[220:221], v21 offset:24576
  ds_read_b64_tr_b16 a[222:223], v21 offset:28672
  v_mfma_f32_16x16x32_bf16 v[52:55], a[188:191], a[28:31], v[52:55]
  buffer_load_dwordx4 v23, s[52:55], s65 offen offset:1024 lds
  buffer_load_dwordx4 v24, s[52:55], s65 offen offset:2048 lds
  v_mfma_f32_16x16x32_bf16 v[56:59], a[160:163], a[32:35], 0
  v_exp_f32 v48, v48
  v_exp_f32 v49, v49
  v_mfma_f32_16x16x32_bf16 v[56:59], a[164:167], a[36:39], v[56:59]
  v_exp_f32 v50, v50
  v_exp_f32 v51, v51
  v_mfma_f32_16x16x32_bf16 v[56:59], a[168:171], a[40:43], v[56:59]
  v_cvt_pk_bf16_f32 v68, v48, v49
  v_cvt_pk_bf16_f32 v69, v50, v51
  v_mfma_f32_16x16x32_bf16 v[56:59], a[172:175], a[44:47], v[56:59]
  v_exp_f32 v52, v52
  v_exp_f32 v53, v53
  v_mfma_f32_16x16x32_bf16 v[60:63], a[176:179], a[32:35], 0
  v_exp_f32 v54, v54
  v_exp_f32 v55, v55
  v_mfma_f32_16x16x32_bf16 v[60:63], a[180:183], a[36:39], v[60:63]
  v_cvt_pk_bf16_f32 v70, v52, v53
  v_cvt_pk_bf16_f32 v71, v54, v55
  v_mfma_f32_16x16x32_bf16 v[60:63], a[184:187], a[40:43], v[60:63]
  buffer_load_dwordx4 v25, s[52:55], s65 offen offset:3072 lds
  s_add_u32 m0, s64, 20480
  v_mfma_f32_16x16x32_bf16 v[60:63], a[188:191], a[44:47], v[60:63]
  s_add_u32 s65, s69, 4096
  v_mfma_f32_16x16x32_bf16 v[40:43], a[160:163], a[48:51], 0
  v_exp_f32 v56, v56
  v_exp_f32 v57, v57
  v_mfma_f32_16x16x32_bf16 v[40:43], a[164:167], a[52:55], v[40:43]
  v_exp_f32 v58, v58
  v_exp_f32 v59, v59
  v_mfma_f32_16x16x32_bf16 v[40:43], a[168:171], a[56:59], v[40:43]
  v_cvt_pk_bf16_f32 v72, v56, v57
  v_cvt_pk_bf16_f32 v73, v58, v59
  v_mfma_f32_16x16x32_bf16 v[40:43], a[172:175], a[60:63], v[40:43]
  v_exp_f32 v60, v60
  v_mfma_f32_16x16x32_bf16 v[44:47], a[176:179], a[48:51], 0
  v_exp_f32 v61, v61
  v_exp_f32 v62, v62
  v_mfma_f32_16x16x32_bf16 v[44:47], a[180:183], a[52:55], v[44:47]
  v_exp_f32 v63, v63
  v_cvt_pk_bf16_f32 v74, v60, v61
  v_mfma_f32_16x16x32_bf16 v[44:47], a[184:187], a[56:59], v[44:47]
  v_cvt_pk_bf16_f32 v75, v62, v63
  buffer_load_dwordx4 v22, s[52:55], s65 offen offset:0 lds
  v_mfma_f32_16x16x32_bf16 v[44:47], a[188:191], a[60:63], v[44:47]
  buffer_load_dwordx4 v23, s[52:55], s65 offen offset:1024 lds
  v_mfma_f32_16x16x32_bf16 v[48:51], a[160:163], a[64:67], 0
  v_exp_f32 v40, v40
  v_exp_f32 v41, v41
  v_mfma_f32_16x16x32_bf16 v[48:51], a[164:167], a[68:71], v[48:51]
  v_exp_f32 v42, v42
  v_exp_f32 v43, v43
  v_mfma_f32_16x16x32_bf16 v[48:51], a[168:171], a[72:75], v[48:51]
  v_cvt_pk_bf16_f32 v76, v40, v41
  v_cvt_pk_bf16_f32 v77, v42, v43
  v_mfma_f32_16x16x32_bf16 v[48:51], a[172:175], a[76:79], v[48:51]
  v_exp_f32 v44, v44
  v_exp_f32 v45, v45
  v_mfma_f32_16x16x32_bf16 v[52:55], a[176:179], a[64:67], 0
  v_exp_f32 v46, v46
  v_exp_f32 v47, v47
  v_mfma_f32_16x16x32_bf16 v[52:55], a[180:183], a[68:71], v[52:55]
  v_cvt_pk_bf16_f32 v78, v44, v45
  v_cvt_pk_bf16_f32 v79, v46, v47
  v_mfma_f32_16x16x32_bf16 v[52:55], a[184:187], a[72:75], v[52:55]
  buffer_load_dwordx4 v24, s[52:55], s65 offen offset:2048 lds
  buffer_load_dwordx4 v25, s[52:55], s65 offen offset:3072 lds
  v_mfma_f32_16x16x32_bf16 v[52:55], a[188:191], a[76:79], v[52:55]
  s_add_u32 s69, s69, 32768
  s_waitcnt lgkmcnt(0)
  v_mfma_f32_16x16x32_bf16 v[96:99], a[192:195], v[64:67], v[96:99]
  v_exp_f32 v48, v48
  v_exp_f32 v49, v49
  v_mfma_f32_16x16x32_bf16 v[116:119], a[196:199], v[64:67], v[116:119]
  v_exp_f32 v50, v50
  v_mfma_f32_16x16x32_bf16 v[136:139], a[200:203], v[64:67], v[136:139]
  v_exp_f32 v51, v51
  v_mfma_f32_16x16x32_bf16 v[156:159], a[204:207], v[64:67], v[156:159]
  v_cvt_pk_bf16_f32 v80, v48, v49
  v_cvt_pk_bf16_f32 v81, v50, v51
  v_mfma_f32_16x16x32_bf16 v[176:179], a[208:211], v[64:67], v[176:179]
  v_exp_f32 v52, v52
  v_mfma_f32_16x16x32_bf16 v[196:199], a[212:215], v[64:67], v[196:199]
  v_exp_f32 v53, v53
  v_mfma_f32_16x16x32_bf16 v[216:219], a[216:219], v[64:67], v[216:219]
  v_exp_f32 v54, v54
  v_exp_f32 v55, v55
  v_mfma_f32_16x16x32_bf16 v[236:239], a[220:223], v[64:67], v[236:239]
  v_cvt_pk_bf16_f32 v82, v52, v53
  v_mfma_f32_16x16x32_bf16 a[224:227], a[244:247], v[64:67], a[224:227]
  v_cvt_pk_bf16_f32 v83, v54, v55
  s_waitcnt vmcnt(16)
  v_mfma_f32_16x16x32_bf16 v[100:103], a[192:195], v[68:71], v[100:103]
  ds_read_b128 a[160:163], v10 offset:0
  ds_read_b128 a[164:167], v11 offset:0
  v_mfma_f32_16x16x32_bf16 v[120:123], a[196:199], v[68:71], v[120:123]
  ds_read_b128 a[168:171], v12 offset:0
  v_mfma_f32_16x16x32_bf16 v[140:143], a[200:203], v[68:71], v[140:143]
  ds_read_b128 a[172:175], v13 offset:0
  v_mfma_f32_16x16x32_bf16 v[160:163], a[204:207], v[68:71], v[160:163]
  ds_read_b128 a[176:179], v10 offset:4096
  ds_read_b128 a[180:183], v11 offset:4096
  v_mfma_f32_16x16x32_bf16 v[180:183], a[208:211], v[68:71], v[180:183]
  ds_read_b128 a[184:187], v12 offset:4096
  v_mfma_f32_16x16x32_bf16 v[200:203], a[212:215], v[68:71], v[200:203]
  ds_read_b128 a[188:191], v13 offset:4096
  v_mfma_f32_16x16x32_bf16 v[220:223], a[216:219], v[68:71], v[220:223]
  s_add_u32 m0, s64, 24576
  s_add_u32 s66, s70, 0
  v_mfma_f32_16x16x32_bf16 v[240:243], a[220:223], v[68:71], v[240:243]
  buffer_load_dwordx4 v26, s[56:59], s66 offen offset:0 lds
  v_mfma_f32_16x16x32_bf16 a[228:231], a[244:247], v[68:71], a[228:231]
  buffer_load_dwordx4 v27, s[56:59], s66 offen offset:1024 lds
  v_mfma_f32_16x16x32_bf16 v[104:107], a[192:195], v[72:75], v[104:107]
  buffer_load_dwordx4 v26, s[56:59], s66 offen offset:2048 lds
  v_mfma_f32_16x16x32_bf16 v[124:127], a[196:199], v[72:75], v[124:127]
  v_mfma_f32_16x16x32_bf16 v[144:147], a[200:203], v[72:75], v[144:147]
  buffer_load_dwordx4 v27, s[56:59], s66 offen offset:3072 lds
  v_mfma_f32_16x16x32_bf16 v[164:167], a[204:207], v[72:75], v[164:167]
  v_mfma_f32_16x16x32_bf16 v[184:187], a[208:211], v[72:75], v[184:187]
  s_add_u32 m0, s64, 28672
  v_mfma_f32_16x16x32_bf16 v[204:207], a[212:215], v[72:75], v[204:207]
  v_mfma_f32_16x16x32_bf16 v[224:227], a[216:219], v[72:75], v[224:227]
  s_add_u32 s66, s70, 4096
  v_mfma_f32_16x16x32_bf16 v[244:247], a[220:223], v[72:75], v[244:247]
  v_mfma_f32_16x16x32_bf16 a[232:235], a[244:247], v[72:75], a[232:235]
  v_mfma_f32_16x16x32_bf16 v[108:111], a[192:195], v[76:79], v[108:111]
  buffer_load_dwordx4 v26, s[56:59], s66 offen offset:0 lds
  v_mfma_f32_16x16x32_bf16 v[128:131], a[196:199], v[76:79], v[128:131]
  buffer_load_dwordx4 v27, s[56:59], s66 offen offset:1024 lds
  v_mfma_f32_16x16x32_bf16 v[148:151], a[200:203], v[76:79], v[148:151]
  v_mfma_f32_16x16x32_bf16 v[168:171], a[204:207], v[76:79], v[168:171]
  buffer_load_dwordx4 v26, s[56:59], s66 offen offset:2048 lds
  v_mfma_f32_16x16x32_bf16 v[188:191], a[208:211], v[76:79], v[188:191]
  v_mfma_f32_16x16x32_bf16 v[208:211], a[212:215], v[76:79], v[208:211]
  buffer_load_dwordx4 v27, s[56:59], s66 offen offset:3072 lds
  v_mfma_f32_16x16x32_bf16 v[228:231], a[216:219], v[76:79], v[228:231]
  v_mfma_f32_16x16x32_bf16 v[248:251], a[220:223], v[76:79], v[248:251]
  s_add_u32 s70, s70, 32768
  v_mfma_f32_16x16x32_bf16 a[236:239], a[244:247], v[76:79], a[236:239]
  v_mfma_f32_16x16x32_bf16 v[112:115], a[192:195], v[80:83], v[112:115]
  v_mfma_f32_16x16x32_bf16 v[132:135], a[196:199], v[80:83], v[132:135]
  v_mfma_f32_16x16x32_bf16 v[152:155], a[200:203], v[80:83], v[152:155]
  v_mfma_f32_16x16x32_bf16 v[172:175], a[204:207], v[80:83], v[172:175]
  v_mfma_f32_16x16x32_bf16 v[192:195], a[208:211], v[80:83], v[192:195]
  v_mfma_f32_16x16x32_bf16 v[212:215], a[212:215], v[80:83], v[212:215]
  v_mfma_f32_16x16x32_bf16 v[232:235], a[216:219], v[80:83], v[232:235]
  v_mfma_f32_16x16x32_bf16 v[252:255], a[220:223], v[80:83], v[252:255]
  v_mfma_f32_16x16x32_bf16 a[240:243], a[244:247], v[80:83], a[240:243]
  s_waitcnt lgkmcnt(0)
  s_add_u32 s71, s71, 1
  s_cmp_lt_u32 s71, 7
  s_cbranch_scc1 L_attA_l
  s_setpc_b64 s[96:97]
.p2align 6
L_attB:
L_attB_l:
  s_waitcnt vmcnt(16)
  buffer_load_dword v39, v38, s[4:7], 0 offen sc1
  v_mfma_f32_16x16x32_bf16 v[40:43], a[160:163], a[0:3], 0
  ds_read_b64_tr_b16 a[192:193], v14 offset:8192
  ds_read_b64_tr_b16 a[194:195], v14 offset:12288
  v_mfma_f32_16x16x32_bf16 v[40:43], a[164:167], a[4:7], v[40:43]
  ds_read_b64_tr_b16 a[196:197], v15 offset:8192
  ds_read_b64_tr_b16 a[198:199], v15 offset:12288
  v_mfma_f32_16x16x32_bf16 v[40:43], a[168:171], a[8:11], v[40:43]
  ds_read_b64_tr_b16 a[200:201], v16 offset:8192
  ds_read_b64_tr_b16 a[202:203], v16 offset:12288
  v_mfma_f32_16x16x32_bf16 v[40:43], a[172:175], a[12:15], v[40:43]
  ds_read_b64_tr_b16 a[204:205], v17 offset:8192
  ds_read_b64_tr_b16 a[206:207], v17 offset:12288
  v_mfma_f32_16x16x32_bf16 v[44:47], a[176:179], a[0:3], 0
  ds_read_b64_tr_b16 a[208:209], v18 offset:8192
  ds_read_b64_tr_b16 a[210:211], v18 offset:12288
  v_mfma_f32_16x16x32_bf16 v[44:47], a[180:183], a[4:7], v[44:47]
  ds_read_b64_tr_b16 a[212:213], v19 offset:8192
  ds_read_b64_tr_b16 a[214:215], v19 offset:12288
  v_mfma_f32_16x16x32_bf16 v[44:47], a[184:187], a[8:11], v[44:47]
  s_add_u32 m0, s64, 0
  s_add_u32 s65, s69, 0
  v_mfma_f32_16x16x32_bf16 v[44:47], a[188:191], a[12:15], v[44:47]
  buffer_load_dwordx4 v22, s[52:55], s65 offen offset:0 nt lds
  v_mfma_f32_16x16x32_bf16 v[48:51], a[160:163], a[16:19], 0
  v_exp_f32 v40, v40
  v_exp_f32 v41, v41
  v_exp_f32 v42, v42
  v_mfma_f32_16x16x32_bf16 v[48:51], a[164:167], a[20:23], v[48:51]
  v_exp_f32 v43, v43
  v_cvt_pk_bf16_f32 v64, v40, v41
  v_mfma_f32_16x16x32_bf16 v[48:51], a[168:171], a[24:27], v[48:51]
  v_cvt_pk_bf16_f32 v65, v42, v43
  v_exp_f32 v44, v44
  v_mfma_f32_16x16x32_bf16 v[48:51], a[172:175], a[28:31], v[48:51]
  v_exp_f32 v45, v45
  v_exp_f32 v46, v46
  v_mfma_f32_16x16x32_bf16 v[52:55], a[176:179], a[16:19], 0
  v_exp_f32 v47, v47
  v_cvt_pk_bf16_f32 v66, v44, v45
  v_cvt_pk_bf16_f32 v67, v46, v47
  v_mfma_f32_16x16x32_bf16 v[52:55], a[180:183], a[20:23], v[52:55]
  ds_read_b64_tr_b16 a[216:217], v20 offset:8192
  ds_read_b64_tr_b16 a[218:219], v20 offset:12288
  v_mfma_f32_16x16x32_bf16 v[52:55], a[184:187], a[24:27], v[52:55]
  ds_read_b64_tr_b16 a[220:221], v21 offset:8192
  ds_read_b64_tr_b16 a[222:223], v21 offset:12288
  v_mfma_f32_16x16x32_bf16 v[52:55], a[188:191], a[28:31], v[52:55]
  buffer_load_dwordx4 v23, s[52:55], s65 offen offset:1024 nt lds
  buffer_load_dwordx4 v24, s[52:55], s65 offen offset:2048 nt lds
  v_mfma_f32_16x16x32_bf16 v[56:59], a[160:163], a[32:35], 0
  v_exp_f32 v48, v48
  v_exp_f32 v49, v49
  v_mfma_f32_16x16x32_bf16 v[56:59], a[164:167], a[36:39], v[56:59]
  v_exp_f32 v50, v50
  v_exp_f32 v51, v51
  v_mfma_f32_16x16x32_bf16 v[56:59], a[168:171], a[40:43], v[56:59]
  v_cvt_pk_bf16_f32 v68, v48, v49
  v_cvt_pk_bf16_f32 v69, v50, v51
  v_mfma_f32_16x16x32_bf16 v[56:59], a[172:175], a[44:47], v[56:59]
  v_exp_f32 v52, v52
  v_exp_f32 v53, v53
  v_mfma_f32_16x16x32_bf16 v[60:63], a[176:179], a[32:35], 0
  v_exp_f32 v54, v54
  v_exp_f32 v55, v55
  v_mfma_f32_16x16x32_bf16 v[60:63], a[180:183], a[36:39], v[60:63]
  v_cvt_pk_bf16_f32 v70, v52, v53
  v_cvt_pk_bf16_f32 v71, v54, v55
  v_mfma_f32_16x16x32_bf16 v[60:63], a[184:187], a[40:43], v[60:63]
  buffer_load_dwordx4 v25, s[52:55], s65 offen offset:3072 nt lds
  s_add_u32 m0, s64, 4096
  v_mfma_f32_16x16x32_bf16 v[60:63], a[188:191], a[44:47], v[60:63]
  s_add_u32 s65, s69, 4096
  v_mfma_f32_16x16x32_bf16 v[40:43], a[160:163], a[48:51], 0
  v_exp_f32 v56, v56
  v_exp_f32 v57, v57
  v_mfma_f32_16x16x32_bf16 v[40:43], a[164:167], a[52:55], v[40:43]
  v_exp_f32 v58, v58
  v_exp_f32 v59, v59
  v_mfma_f32_16x16x32_bf16 v[40:43], a[168:171], a[56:59], v[40:43]
  v_cvt_pk_bf16_f32 v72, v56, v57
  v_cvt_pk_bf16_f32 v73, v58, v59
  v_mfma_f32_16x16x32_bf16 v[40:43], a[172:175], a[60:63], v[40:43]
  v_exp_f32 v60, v60
  v_mfma_f32_16x16x32_bf16 v[44:47], a[176:179], a[48:51], 0
  v_exp_f32 v61, v61
  v_exp_f32 v62, v62
  v_mfma_f32_16x16x32_bf16 v[44:47], a[180:183], a[52:55], v[44:47]
  v_exp_f32 v63, v63
  v_cvt_pk_bf16_f32 v74, v60, v61
  v_mfma_f32_16x16x32_bf16 v[44:47], a[184:187], a[56:59], v[44:47]
  v_cvt_pk_bf16_f32 v75, v62, v63
  buffer_load_dwordx4 v22, s[52:55], s65 offen offset:0 nt lds
  v_mfma_f32_16x16x32_bf16 v[44:47], a[188:191], a[60:63], v[44:47]
  buffer_load_dwordx4 v23, s[52:55], s65 offen offset:1024 nt lds
  v_mfma_f32_16x16x32_bf16 v[48:51], a[160:163], a[64:67], 0
  v_exp_f32 v40, v40
  v_exp_f32 v41, v41
  v_mfma_f32_16x16x32_bf16 v[48:51], a[164:167], a[68:71], v[48:51]
  v_exp_f32 v42, v42
  v_exp_f32 v43, v43
  v_mfma_f32_16x16x32_bf16 v[48:51], a[168:171], a[72:75], v[48:51]
  v_cvt_pk_bf16_f32 v76, v40, v41
  v_cvt_pk_bf16_f32 v77, v42, v43
  v_mfma_f32_16x16x32_bf16 v[48:51], a[172:175], a[76:79], v[48:51]
  v_exp_f32 v44, v44
  v_exp_f32 v45, v45
  v_mfma_f32_16x16x32_bf16 v[52:55], a[176:179], a[64:67], 0
  v_exp_f32 v46, v46
  v_exp_f32 v47, v47
  v_mfma_f32_16x16x32_bf16 v[52:55], a[180:183], a[68:71], v[52:55]
  v_cvt_pk_bf16_f32 v78, v44, v45
  v_cvt_pk_bf16_f32 v79, v46, v47
  v_mfma_f32_16x16x32_bf16 v[52:55], a[184:187], a[72:75], v[52:55]
  buffer_load_dwordx4 v24, s[52:55], s65 offen offset:2048 nt lds
  buffer_load_dwordx4 v25, s[52:55], s65 offen offset:3072 nt lds
  v_mfma_f32_16x16x32_bf16 v[52:55], a[188:191], a[76:79], v[52:55]
  s_add_u32 s69, s69, 32768
  s_waitcnt lgkmcnt(0)
  s_cmp_eq_u32 s71, 0
  s_cbranch_scc1 L_pv_30_f
  v_mfma_f32_16x16x32_bf16 v[96:99], a[192:195], v[64:67], v[96:99]
  v_exp_f32 v48, v48
  v_exp_f32 v49, v49
  v_mfma_f32_16x16x32_bf16 v[116:119], a[196:199], v[64:67], v[116:119]
  v_exp_f32 v50, v50
  v_mfma_f32_16x16x32_bf16 v[136:139], a[200:203], v[64:67], v[136:139]
  v_exp_f32 v51, v51
  v_mfma_f32_16x16x32_bf16 v[156:159], a[204:207], v[64:67], v[156:159]
  v_cvt_pk_bf16_f32 v80, v48, v49
  v_cvt_pk_bf16_f32 v81, v50, v51
  v_mfma_f32_16x16x32_bf16 v[176:179], a[208:211], v[64:67], v[176:179]
  v_exp_f32 v52, v52
  v_mfma_f32_16x16x32_bf16 v[196:199], a[212:215], v[64:67], v[196:199]
  v_exp_f32 v53, v53
  v_mfma_f32_16x16x32_bf16 v[216:219], a[216:219], v[64:67], v[216:219]
  v_exp_f32 v54, v54
  v_exp_f32 v55, v55
  v_mfma_f32_16x16x32_bf16 v[236:239], a[220:223], v[64:67], v[236:239]
  v_cvt_pk_bf16_f32 v82, v52, v53
  v_mfma_f32_16x16x32_bf16 a[224:227], a[244:247], v[64:67], a[224:227]
  v_cvt_pk_bf16_f32 v83, v54, v55
  s_waitcnt vmcnt(17)
  v_mfma_f32_16x16x32_bf16 v[100:103], a[192:195], v[68:71], v[100:103]
  ds_read_b128 a[160:163], v10 offset:16384
  ds_read_b128 a[164:167], v11 offset:16384
  v_mfma_f32_16x16x32_bf16 v[120:123], a[196:199], v[68:71], v[120:123]
  ds_read_b128 a[168:171], v12 offset:16384
  v_mfma_f32_16x16x32_bf16 v[140:143], a[200:203], v[68:71], v[140:143]
  ds_read_b128 a[172:175], v13 offset:16384
  v_mfma_f32_16x16x32_bf16 v[160:163], a[204:207], v[68:71], v[160:163]
  ds_read_b128 a[176:179], v10 offset:20480
  ds_read_b128 a[180:183], v11 offset:20480
  v_mfma_f32_16x16x32_bf16 v[180:183], a[208:211], v[68:71], v[180:183]
  ds_read_b128 a[184:187], v12 offset:20480
  v_mfma_f32_16x16x32_bf16 v[200:203], a[212:215], v[68:71], v[200:203]
  ds_read_b128 a[188:191], v13 offset:20480
  v_mfma_f32_16x16x32_bf16 v[220:223], a[216:219], v[68:71], v[220:223]
  s_add_u32 m0, s64, 8192
  s_add_u32 s66, s70, 0
  v_mfma_f32_16x16x32_bf16 v[240:243], a[220:223], v[68:71], v[240:243]
  buffer_load_dwordx4 v26, s[56:59], s66 offen offset:0 nt lds
  v_mfma_f32_16x16x32_bf16 a[228:231], a[244:247], v[68:71], a[228:231]
  buffer_load_dwordx4 v27, s[56:59], s66 offen offset:1024 nt lds
  v_mfma_f32_16x16x32_bf16 v[104:107], a[192:195], v[72:75], v[104:107]
  buffer_load_dwordx4 v26, s[56:59], s66 offen offset:2048 nt lds
  v_mfma_f32_16x16x32_bf16 v[124:127], a[196:199], v[72:75], v[124:127]
  v_mfma_f32_16x16x32_bf16 v[144:147], a[200:203], v[72:75], v[144:147]
  buffer_load_dwordx4 v27, s[56:59], s66 offen offset:3072 nt lds
  v_mfma_f32_16x16x32_bf16 v[164:167], a[204:207], v[72:75], v[164:167]
  v_mfma_f32_16x16x32_bf16 v[184:187], a[208:211], v[72:75], v[184:187]
  s_add_u32 m0, s64, 12288
  v_mfma_f32_16x16x32_bf16 v[204:207], a[212:215], v[72:75], v[204:207]
  v_mfma_f32_16x16x32_bf16 v[224:227], a[216:219], v[72:75], v[224:227]
  s_add_u32 s66, s70, 4096
  v_mfma_f32_16x16x32_bf16 v[244:247], a[220:223], v[72:75], v[244:247]
  v_mfma_f32_16x16x32_bf16 a[232:235], a[244:247], v[72:75], a[232:235]
  v_mfma_f32_16x16x32_bf16 v[108:111], a[192:195], v[76:79], v[108:111]
  buffer_load_dwordx4 v26, s[56:59], s66 offen offset:0 nt lds
  v_mfma_f32_16x16x32_bf16 v[128:131], a[196:199], v[76:79], v[128:131]
  buffer_load_dwordx4 v27, s[56:59], s66 offen offset:1024 nt lds
  v_mfma_f32_16x16x32_bf16 v[148:151], a[200:203], v[76:79], v[148:151]
  v_mfma_f32_16x16x32_bf16 v[168:171], a[204:207], v[76:79], v[168:171]
  buffer_load_dwordx4 v26, s[56:59], s66 offen offset:2048 nt lds
  v_mfma_f32_16x16x32_bf16 v[188:191], a[208:211], v[76:79], v[188:191]
  v_mfma_f32_16x16x32_bf16 v[208:211], a[212:215], v[76:79], v[208:211]
  buffer_load_dwordx4 v27, s[56:59], s66 offen offset:3072 nt lds
  v_mfma_f32_16x16x32_bf16 v[228:231], a[216:219], v[76:79], v[228:231]
  v_mfma_f32_16x16x32_bf16 v[248:251], a[220:223], v[76:79], v[248:251]
  s_add_u32 s70, s70, 32768
  v_mfma_f32_16x16x32_bf16 a[236:239], a[244:247], v[76:79], a[236:239]
  v_mfma_f32_16x16x32_bf16 v[112:115], a[192:195], v[80:83], v[112:115]
  v_mfma_f32_16x16x32_bf16 v[132:135], a[196:199], v[80:83], v[132:135]
  v_mfma_f32_16x16x32_bf16 v[152:155], a[200:203], v[80:83], v[152:155]
  v_mfma_f32_16x16x32_bf16 v[172:175], a[204:207], v[80:83], v[172:175]
  v_mfma_f32_16x16x32_bf16 v[192:195], a[208:211], v[80:83], v[192:195]
  v_mfma_f32_16x16x32_bf16 v[212:215], a[212:215], v[80:83], v[212:215]
  v_mfma_f32_16x16x32_bf16 v[232:235], a[216:219], v[80:83], v[232:235]
  v_mfma_f32_16x16x32_bf16 v[252:255], a[220:223], v[80:83], v[252:255]
  v_mfma_f32_16x16x32_bf16 a[240:243], a[244:247], v[80:83], a[240:243]
  s_branch L_pv_30_e
L_pv_30_f:
  v_mfma_f32_16x16x32_bf16 v[96:99], a[192:195], v[64:67], 0
  v_exp_f32 v48, v48
  v_exp_f32 v49, v49
  v_mfma_f32_16x16x32_bf16 v[116:119], a[196:199], v[64:67], 0
  v_exp_f32 v50, v50
  v_mfma_f32_16x16x32_bf16 v[136:139], a[200:203], v[64:67], 0
  v_exp_f32 v51, v51
  v_mfma_f32_16x16x32_bf16 v[156:159], a[204:207], v[64:67], 0
  v_cvt_pk_bf16_f32 v80, v48, v49
  v_cvt_pk_bf16_f32 v81, v50, v51
  v_mfma_f32_16x16x32_bf16 v[176:179], a[208:211], v[64:67], 0
  v_exp_f32 v52, v52
  v_mfma_f32_16x16x32_bf16 v[196:199], a[212:215], v[64:67], 0
  v_exp_f32 v53, v53
  v_mfma_f32_16x16x32_bf16 v[216:219], a[216:219], v[64:67], 0
  v_exp_f32 v54, v54
  v_exp_f32 v55, v55
  v_mfma_f32_16x16x32_bf16 v[236:239], a[220:223], v[64:67], 0
  v_cvt_pk_bf16_f32 v82, v52, v53
  v_mfma_f32_16x16x32_bf16 a[224:227], a[244:247], v[64:67], 0
  v_cvt_pk_bf16_f32 v83, v54, v55
  s_waitcnt vmcnt(17)
  v_mfma_f32_16x16x32_bf16 v[100:103], a[192:195], v[68:71], 0
  ds_read_b128 a[160:163], v10 offset:16384
  ds_read_b128 a[164:167], v11 offset:16384
  v_mfma_f32_16x16x32_bf16 v[120:123], a[196:199], v[68:71], 0
  ds_read_b128 a[168:171], v12 offset:16384
  v_mfma_f32_16x16x32_bf16 v[140:143], a[200:203], v[68:71], 0
  ds_read_b128 a[172:175], v13 offset:16384
  v_mfma_f32_16x16x32_bf16 v[160:163], a[204:207], v[68:71], 0
  ds_read_b128 a[176:179], v10 offset:20480
  ds_read_b128 a[180:183], v11 offset:20480
  v_mfma_f32_16x16x32_bf16 v[180:183], a[208:211], v[68:71], 0
  ds_read_b128 a[184:187], v12 offset:20480
  v_mfma_f32_16x16x32_bf16 v[200:203], a[212:215], v[68:71], 0
  ds_read_b128 a[188:191], v13 offset:20480
  v_mfma_f32_16x16x32_bf16 v[220:223], a[216:219], v[68:71], 0
  s_add_u32 m0, s64, 8192
  s_add_u32 s66, s70, 0
  v_mfma_f32_16x16x32_bf16 v[240:243], a[220:223], v[68:71], 0
  buffer_load_dwordx4 v26, s[56:59], s66 offen offset:0 nt lds
  v_mfma_f32_16x16x32_bf16 a[228:231], a[244:247], v[68:71], 0
  buffer_load_dwordx4 v27, s[56:59], s66 offen offset:1024 nt lds
  v_mfma_f32_16x16x32_bf16 v[104:107], a[192:195], v[72:75], 0
  buffer_load_dwordx4 v26, s[56:59], s66 offen offset:2048 nt lds
  v_mfma_f32_16x16x32_bf16 v[124:127], a[196:199], v[72:75], 0
  v_mfma_f32_16x16x32_bf16 v[144:147], a[200:203], v[72:75], 0
  buffer_load_dwordx4 v27, s[56:59], s66 offen offset:3072 nt lds
  v_mfma_f32_16x16x32_bf16 v[164:167], a[204:207], v[72:75], 0
  v_mfma_f32_16x16x32_bf16 v[184:187], a[208:211], v[72:75], 0
  s_add_u32 m0, s64, 12288
  v_mfma_f32_16x16x32_bf16 v[204:207], a[212:215], v[72:75], 0
  v_mfma_f32_16x16x32_bf16 v[224:227], a[216:219], v[72:75], 0
  s_add_u32 s66, s70, 4096
  v_mfma_f32_16x16x32_bf16 v[244:247], a[220:223], v[72:75], 0
  v_mfma_f32_16x16x32_bf16 a[232:235], a[244:247], v[72:75], 0
  v_mfma_f32_16x16x32_bf16 v[108:111], a[192:195], v[76:79], 0
  buffer_load_dwordx4 v26, s[56:59], s66 offen offset:0 nt lds
  v_mfma_f32_16x16x32_bf16 v[128:131], a[196:199], v[76:79], 0
  buffer_load_dwordx4 v27, s[56:59], s66 offen offset:1024 nt lds
  v_mfma_f32_16x16x32_bf16 v[148:151], a[200:203], v[76:79], 0
  v_mfma_f32_16x16x32_bf16 v[168:171], a[204:207], v[76:79], 0
  buffer_load_dwordx4 v26, s[56:59], s66 offen offset:2048 nt lds
  v_mfma_f32_16x16x32_bf16 v[188:191], a[208:211], v[76:79], 0
  v_mfma_f32_16x16x32_bf16 v[208:211], a[212:215], v[76:79], 0
  buffer_load_dwordx4 v27, s[56:59], s66 offen offset:3072 nt lds
  v_mfma_f32_16x16x32_bf16 v[228:231], a[216:219], v[76:79], 0
  v_mfma_f32_16x16x32_bf16 v[248:251], a[220:223], v[76:79], 0
  s_add_u32 s70, s70, 32768
  v_mfma_f32_16x16x32_bf16 a[236:239], a[244:247], v[76:79], 0
  v_mfma_f32_16x16x32_bf16 v[112:115], a[192:195], v[80:83], 0
  v_mfma_f32_16x16x32_bf16 v[132:135], a[196:199], v[80:83], 0
  v_mfma_f32_16x16x32_bf16 v[152:155], a[200:203], v[80:83], 0
  v_mfma_f32_16x16x32_bf16 v[172:175], a[204:207], v[80:83], 0
  v_mfma_f32_16x16x32_bf16 v[192:195], a[208:211], v[80:83], 0
  v_mfma_f32_16x16x32_bf16 v[212:215], a[212:215], v[80:83], 0
  v_mfma_f32_16x16x32_bf16 v[232:235], a[216:219], v[80:83], 0
  v_mfma_f32_16x16x32_bf16 v[252:255], a[220:223], v[80:83], 0
  v_mfma_f32_16x16x32_bf16 a[240:243], a[244:247], v[80:83], 0
L_pv_30_e:
  s_waitcnt lgkmcnt(0)
  s_waitcnt vmcnt(17)
  v_mfma_f32_16x16x32_bf16 v[40:43], a[160:163], a[0:3], 0
  ds_read_b64_tr_b16 a[192:193], v14 offset:24576
  ds_read_b64_tr_b16 a[194:195], v14 offset:28672
  v_mfma_f32_16x16x32_bf16 v[40:43], a[164:167], a[4:7], v[40:43]
  ds_read_b64_tr_b16 a[196:197], v15 offset:24576
  ds_read_b64_tr_b16 a[198:199], v15 offset:28672
  v_mfma_f32_16x16x32_bf16 v[40:43], a[168:171], a[8:11], v[40:43]
  ds_read_b64_tr_b16 a[200:201], v16 offset:24576
  ds_read_b64_tr_b16 a[202:203], v16 offset:28672
  v_mfma_f32_16x16x32_bf16 v[40:43], a[172:175], a[12:15], v[40:43]
  ds_read_b64_tr_b16 a[204:205], v17 offset:24576
  ds_read_b64_tr_b16 a[206:207], v17 offset:28672
  v_mfma_f32_16x16x32_bf16 v[44:47], a[176:179], a[0:3], 0
  ds_read_b64_tr_b16 a[208:209], v18 offset:24576
  ds_read_b64_tr_b16 a[210:211], v18 offset:28672
  v_mfma_f32_16x16x32_bf16 v[44:47], a[180:183], a[4:7], v[44:47]
  ds_read_b64_tr_b16 a[212:213], v19 offset:24576
  ds_read_b64_tr_b16 a[214:215], v19 offset:28672
  v_mfma_f32_16x16x32_bf16 v[44:47], a[184:187], a[8:11], v[44:47]
  s_add_u32 m0, s64, 16384
  s_add_u32 s65, s69, 0
  v_mfma_f32_16x16x32_bf16 v[44:47], a[188:191], a[12:15], v[44:47]
  buffer_load_dwordx4 v22, s[52:55], s65 offen offset:0 nt lds
  v_mfma_f32_16x16x32_bf16 v[48:51], a[160:163], a[16:19], 0
  v_exp_f32 v40, v40
  v_exp_f32 v41, v41
  v_exp_f32 v42, v42
  v_mfma_f32_16x16x32_bf16 v[48:51], a[164:167], a[20:23], v[48:51]
  v_exp_f32 v43, v43
  v_cvt_pk_bf16_f32 v64, v40, v41
  v_mfma_f32_16x16x32_bf16 v[48:51], a[168:171], a[24:27], v[48:51]
  v_cvt_pk_bf16_f32 v65, v42, v43
  v_exp_f32 v44, v44
  v_mfma_f32_16x16x32_bf16 v[48:51], a[172:175], a[28:31], v[48:51]
  v_exp_f32 v45, v45
  v_exp_f32 v46, v46
  v_mfma_f32_16x16x32_bf16 v[52:55], a[176:179], a[16:19], 0
  v_exp_f32 v47, v47
  v_cvt_pk_bf16_f32 v66, v44, v45
  v_cvt_pk_bf16_f32 v67, v46, v47
  v_mfma_f32_16x16x32_bf16 v[52:55], a[180:183], a[20:23], v[52:55]
  ds_read_b64_tr_b16 a[216:217], v20 offset:24576
  ds_read_b64_tr_b16 a[218:219], v20 offset:28672
  v_mfma_f32_16x16x32_bf16 v[52:55], a[184:187], a[24:27], v[52:55]
  ds_read_b64_tr_b16 a[220:221], v21 offset:24576
  ds_read_b64_tr_b16 a[222:223], v21 offset:28672
  v_mfma_f32_16x16x32_bf16 v[52:55], a[188:191], a[28:31], v[52:55]
  buffer_load_dwordx4 v23, s[52:55], s65 offen offset:1024 nt lds
  buffer_load_dwordx4 v24, s[52:55], s65 offen offset:2048 nt lds
  v_mfma_f32_16x16x32_bf16 v[56:59], a[160:163], a[32:35], 0
  v_exp_f32 v48, v48
  v_exp_f32 v49, v49
  v_mfma_f32_16x16x32_bf16 v[56:59], a[164:167], a[36:39], v[56:59]
  v_exp_f32 v50, v50
  v_exp_f32 v51, v51
  v_mfma_f32_16x16x32_bf16 v[56:59], a[168:171], a[40:43], v[56:59]
  v_cvt_pk_bf16_f32 v68, v48, v49
  v_cvt_pk_bf16_f32 v69, v50, v51
  v_mfma_f32_16x16x32_bf16 v[56:59], a[172:175], a[44:47], v[56:59]
  v_exp_f32 v52, v52
  v_exp_f32 v53, v53
  v_mfma_f32_16x16x32_bf16 v[60:63], a[176:179], a[32:35], 0
  v_exp_f32 v54, v54
  v_exp_f32 v55, v55
  v_mfma_f32_16x16x32_bf16 v[60:63], a[180:183], a[36:39], v[60:63]
  v_cvt_pk_bf16_f32 v70, v52, v53
  v_cvt_pk_bf16_f32 v71, v54, v55
  v_mfma_f32_16x16x32_bf16 v[60:63], a[184:187], a[40:43], v[60:63]
  buffer_load_dwordx4 v25, s[52:55], s65 offen offset:3072 nt lds
  s_add_u32 m0, s64, 20480
  v_mfma_f32_16x16x32_bf16 v[60:63], a[188:191], a[44:47], v[60:63]
  s_add_u32 s65, s69, 4096
  v_mfma_f32_16x16x32_bf16 v[40:43], a[160:163], a[48:51], 0
  v_exp_f32 v56, v56
  v_exp_f32 v57, v57
  v_mfma_f32_16x16x32_bf16 v[40:43], a[164:167], a[52:55], v[40:43]
  v_exp_f32 v58, v58
  v_exp_f32 v59, v59
  v_mfma_f32_16x16x32_bf16 v[40:43], a[168:171], a[56:59], v[40:43]
  v_cvt_pk_bf16_f32 v72, v56, v57
  v_cvt_pk_bf16_f32 v73, v58, v59
  v_mfma_f32_16x16x32_bf16 v[40:43], a[172:175], a[60:63], v[40:43]
  v_exp_f32 v60, v60
  v_mfma_f32_16x16x32_bf16 v[44:47], a[176:179], a[48:51], 0
  v_exp_f32 v61, v61
  v_exp_f32 v62, v62
  v_mfma_f32_16x16x32_bf16 v[44:47], a[180:183], a[52:55], v[44:47]
  v_exp_f32 v63, v63
  v_cvt_pk_bf16_f32 v74, v60, v61
  v_mfma_f32_16x16x32_bf16 v[44:47], a[184:187], a[56:59], v[44:47]
  v_cvt_pk_bf16_f32 v75, v62, v63
  buffer_load_dwordx4 v22, s[52:55], s65 offen offset:0 nt lds
  v_mfma_f32_16x16x32_bf16 v[44:47], a[188:191], a[60:63], v[44:47]
  buffer_load_dwordx4 v23, s[52:55], s65 offen offset:1024 nt lds
  v_mfma_f32_16x16x32_bf16 v[48:51], a[160:163], a[64:67], 0
  v_exp_f32 v40, v40
  v_exp_f32 v41, v41
  v_mfma_f32_16x16x32_bf16 v[48:51], a[164:167], a[68:71], v[48:51]
  v_exp_f32 v42, v42
  v_exp_f32 v43, v43
  v_mfma_f32_16x16x32_bf16 v[48:51], a[168:171], a[72:75], v[48:51]
  v_cvt_pk_bf16_f32 v76, v40, v41
  v_cvt_pk_bf16_f32 v77, v42, v43
  v_mfma_f32_16x16x32_bf16 v[48:51], a[172:175], a[76:79], v[48:51]
  v_exp_f32 v44, v44
  v_exp_f32 v45, v45
  v_mfma_f32_16x16x32_bf16 v[52:55], a[176:179], a[64:67], 0
  v_exp_f32 v46, v46
  v_exp_f32 v47, v47
  v_mfma_f32_16x16x32_bf16 v[52:55], a[180:183], a[68:71], v[52:55]
  v_cvt_pk_bf16_f32 v78, v44, v45
  v_cvt_pk_bf16_f32 v79, v46, v47
  v_mfma_f32_16x16x32_bf16 v[52:55], a[184:187], a[72:75], v[52:55]
  buffer_load_dwordx4 v24, s[52:55], s65 offen offset:2048 nt lds
  buffer_load_dwordx4 v25, s[52:55], s65 offen offset:3072 nt lds
  v_mfma_f32_16x16x32_bf16 v[52:55], a[188:191], a[76:79], v[52:55]
  s_add_u32 s69, s69, 32768
  s_waitcnt lgkmcnt(0)
  v_mfma_f32_16x16x32_bf16 v[96:99], a[192:195], v[64:67], v[96:99]
  v_exp_f32 v48, v48
  v_exp_f32 v49, v49
  v_mfma_f32_16x16x32_bf16 v[116:119], a[196:199], v[64:67], v[116:119]
  v_exp_f32 v50, v50
  v_mfma_f32_16x16x32_bf16 v[136:139], a[200:203], v[64:67], v[136:139]
  v_exp_f32 v51, v51
  v_mfma_f32_16x16x32_bf16 v[156:159], a[204:207], v[64:67], v[156:159]
  v_cvt_pk_bf16_f32 v80, v48, v49
  v_cvt_pk_bf16_f32 v81, v50, v51
  v_mfma_f32_16x16x32_bf16 v[176:179], a[208:211], v[64:67], v[176:179]
  v_exp_f32 v52, v52
  v_mfma_f32_16x16x32_bf16 v[196:199], a[212:215], v[64:67], v[196:199]
  v_exp_f32 v53, v53
  v_mfma_f32_16x16x32_bf16 v[216:219], a[216:219], v[64:67], v[216:219]
  v_exp_f32 v54, v54
  v_exp_f32 v55, v55
  v_mfma_f32_16x16x32_bf16 v[236:239], a[220:223], v[64:67], v[236:239]
  v_cvt_pk_bf16_f32 v82, v52, v53
  v_mfma_f32_16x16x32_bf16 a[224:227], a[244:247], v[64:67], a[224:227]
  v_cvt_pk_bf16_f32 v83, v54, v55
  s_waitcnt vmcnt(16)
  v_mfma_f32_16x16x32_bf16 v[100:103], a[192:195], v[68:71], v[100:103]
  ds_read_b128 a[160:163], v10 offset:0
  ds_read_b128 a[164:167], v11 offset:0
  v_mfma_f32_16x16x32_bf16 v[120:123], a[196:199], v[68:71], v[120:123]
  ds_read_b128 a[168:171], v12 offset:0
  v_mfma_f32_16x16x32_bf16 v[140:143], a[200:203], v[68:71], v[140:143]
  ds_read_b128 a[172:175], v13 offset:0
  v_mfma_f32_16x16x32_bf16 v[160:163], a[204:207], v[68:71], v[160:163]
  ds_read_b128 a[176:179], v10 offset:4096
  ds_read_b128 a[180:183], v11 offset:4096
  v_mfma_f32_16x16x32_bf16 v[180:183], a[208:211], v[68:71], v[180:183]
  ds_read_b128 a[184:187], v12 offset:4096
  v_mfma_f32_16x16x32_bf16 v[200:203], a[212:215], v[68:71], v[200:203]
  ds_read_b128 a[188:191], v13 offset:4096
  v_mfma_f32_16x16x32_bf16 v[220:223], a[216:219], v[68:71], v[220:223]
  s_add_u32 m0, s64, 24576
  s_add_u32 s66, s70, 0
  v_mfma_f32_16x16x32_bf16 v[240:243], a[220:223], v[68:71], v[240:243]
  buffer_load_dwordx4 v26, s[56:59], s66 offen offset:0 nt lds
  v_mfma_f32_16x16x32_bf16 a[228:231], a[244:247], v[68:71], a[228:231]
  buffer_load_dwordx4 v27, s[56:59], s66 offen offset:1024 nt lds
  v_mfma_f32_16x16x32_bf16 v[104:107], a[192:195], v[72:75], v[104:107]
  buffer_load_dwordx4 v26, s[56:59], s66 offen offset:2048 nt lds
  v_mfma_f32_16x16x32_bf16 v[124:127], a[196:199], v[72:75], v[124:127]
  v_mfma_f32_16x16x32_bf16 v[144:147], a[200:203], v[72:75], v[144:147]
  buffer_load_dwordx4 v27, s[56:59], s66 offen offset:3072 nt lds
  v_mfma_f32_16x16x32_bf16 v[164:167], a[204:207], v[72:75], v[164:167]
  v_mfma_f32_16x16x32_bf16 v[184:187], a[208:211], v[72:75], v[184:187]
  s_add_u32 m0, s64, 28672
  v_mfma_f32_16x16x32_bf16 v[204:207], a[212:215], v[72:75], v[204:207]
  v_mfma_f32_16x16x32_bf16 v[224:227], a[216:219], v[72:75], v[224:227]
  s_add_u32 s66, s70, 4096
  v_mfma_f32_16x16x32_bf16 v[244:247], a[220:223], v[72:75], v[244:247]
  v_mfma_f32_16x16x32_bf16 a[232:235], a[244:247], v[72:75], a[232:235]
  v_mfma_f32_16x16x32_bf16 v[108:111], a[192:195], v[76:79], v[108:111]
  buffer_load_dwordx4 v26, s[56:59], s66 offen offset:0 nt lds
  v_mfma_f32_16x16x32_bf16 v[128:131], a[196:199], v[76:79], v[128:131]
  buffer_load_dwordx4 v27, s[56:59], s66 offen offset:1024 nt lds
  v_mfma_f32_16x16x32_bf16 v[148:151], a[200:203], v[76:79], v[148:151]
  v_mfma_f32_16x16x32_bf16 v[168:171], a[204:207], v[76:79], v[168:171]
  buffer_load_dwordx4 v26, s[56:59], s66 offen offset:2048 nt lds
  v_mfma_f32_16x16x32_bf16 v[188:191], a[208:211], v[76:79], v[188:191]
  v_mfma_f32_16x16x32_bf16 v[208:211], a[212:215], v[76:79], v[208:211]
  buffer_load_dwordx4 v27, s[56:59], s66 offen offset:3072 nt lds
  v_mfma_f32_16x16x32_bf16 v[228:231], a[216:219], v[76:79], v[228:231]
  v_mfma_f32_16x16x32_bf16 v[248:251], a[220:223], v[76:79], v[248:251]
  s_add_u32 s70, s70, 32768
  v_mfma_f32_16x16x32_bf16 a[236:239], a[244:247], v[76:79], a[236:239]
  v_mfma_f32_16x16x32_bf16 v[112:115], a[192:195], v[80:83], v[112:115]
  v_mfma_f32_16x16x32_bf16 v[132:135], a[196:199], v[80:83], v[132:135]
  v_mfma_f32_16x16x32_bf16 v[152:155], a[200:203], v[80:83], v[152:155]
  v_mfma_f32_16x16x32_bf16 v[172:175], a[204:207], v[80:83], v[172:175]
  v_mfma_f32_16x16x32_bf16 v[192:195], a[208:211], v[80:83], v[192:195]
  v_mfma_f32_16x16x32_bf16 v[212:215], a[212:215], v[80:83], v[212:215]
  v_mfma_f32_16x16x32_bf16 v[232:235], a[216:219], v[80:83], v[232:235]
  v_mfma_f32_16x16x32_bf16 v[252:255], a[220:223], v[80:83], v[252:255]
  v_mfma_f32_16x16x32_bf16 a[240:243], a[244:247], v[80:83], a[240:243]
  s_waitcnt lgkmcnt(0)
  s_add_u32 s71, s71, 1
  s_cmp_lt_u32 s71, 7
  s_cbranch_scc1 L_attB_l
  s_setpc_b64 s[96:97]
L_textend:
.section .rodata,"a"
.p2align 6
.amdhsa_kernel concat_heads__gqa_block_cached__mha_block_cached__near_ridge_kernel
  .amdhsa_next_free_vgpr 512
  .amdhsa_next_free_sgpr 102
  .amdhsa_accum_offset 256
  .amdhsa_group_segment_fixed_size 0
  .amdhsa_kernarg_size 104
  .amdhsa_user_sgpr_count 2
  .amdhsa_user_sgpr_kernarg_segment_ptr 1
  .amdhsa_system_sgpr_workgroup_id_x 1
.end_amdhsa_kernel
```
